```python
import torch

def _softmax(x, axis=-1):
    return torch.softmax(x, dim=axis)
def _gelu(x):
    return torch.nn.functional.gelu(x, approximate="tanh")
def _silu(x):
    return torch.nn.functional.silu(x)
def _sigmoid(x):
    return torch.sigmoid(x)
def _layernorm(x, axis=-1, eps=1e-5):
    m = x.mean(dim=axis, keepdim=True)
    v = x.var(dim=axis, keepdim=True, unbiased=False)
    return (x - m) / torch.sqrt(v + eps)
def _scatter_add(tgt, idx, src, axis=0):
    return tgt.clone().index_add_(axis, idx, src)
def _segment_sum(src, seg, n):
    out = torch.zeros((n,) + src.shape[1:], dtype=src.dtype)
    return out.index_add_(0, seg, src)
def _pad(x, pw):
    flat = tuple(v for pair in reversed(pw) for v in pair)
    return torch.nn.functional.pad(x, flat)

kernel_name = 'sequential_preLN__linear_attn_block__dense_activation_relu__prompt'

def setup_inputs():

    _w = (lambda a: (lambda t: t.to(torch.bfloat16) if t.is_floating_point() else t)(torch.as_tensor(a)))
    def _A_setup():
        B, S, D = 1, 2048, 640
        return {
            "x": _w((lambda *s: torch.randn(*s, dtype=torch.bfloat16) * 0.05)(B, S, D)),
            "wqkv": _w((lambda *s: torch.randn(*s, dtype=torch.bfloat16) * 0.05)(D, 3 * D)),
            "wo": _w((lambda *s: torch.randn(*s, dtype=torch.bfloat16) * 0.05)(D, D)),
        }
    _A_in = _A_setup()

    def _B_setup():
        B, S, D, Dff = 1, 2048, 640, 1728
        return {
            "x": _w((lambda *s: torch.randn(*s, dtype=torch.bfloat16) * 0.05)(B, S, D)),
            "w1": _w((lambda *s: torch.randn(*s, dtype=torch.bfloat16) * 0.05)(D, Dff)),
            "w2": _w((lambda *s: torch.randn(*s, dtype=torch.bfloat16) * 0.05)(Dff, D)),
        }
    _B_in = _B_setup()

    return {
        "A_x": _A_in["x"],
        "A_wqkv": _A_in["wqkv"],
        "A_wo": _A_in["wo"],
        "B_x": _B_in["x"],
        "B_w1": _B_in["w1"],
        "B_w2": _B_in["w2"],
    }

def reference(A_x, A_wqkv, A_wo, B_x, B_w1, B_w2):
    def _A_ref(x, wqkv, wo):
        B, S, D = x.shape
        H = 32; Dh = D // H
        qkv = (lambda x, *d: x.permute(*d))((x @ wqkv).reshape(B, S, 3, H, Dh), 2, 0, 3, 1, 4)
        q, k, v = qkv[0], qkv[1], qkv[2]
        phi = lambda t: torch.where(t > 0, t + 1, torch.exp(t)) + 1e-6
        pq, pk = phi(q), phi(k)
        kv = torch.einsum("bhsd,bhse->bhde", pk, v)
        z = torch.einsum("bhsd->bhd", pk)
        num = torch.einsum("bhqd,bhde->bhqe", pq, kv)
        den = torch.einsum("bhqd,bhd->bhq", pq, z)[..., None] + 1e-6
        o = num / den
        return (lambda x, *d: x.permute(*d))(o, 0, 2, 1, 3).reshape(B, S, D) @ wo

    def _B_ref(x, w1, w2):
        h = torch.einsum("bsd,df->bsf", x, w1)
        zero = torch.zeros_like(h)
        h = torch.maximum(h, zero)
        return torch.einsum("bsf,fd->bsd", h, w2)

    x = A_x
    h = x + _A_ref(_layernorm(x, axis=-1), A_wqkv, A_wo)
    h2 = h + _B_ref(_layernorm(h, axis=-1), B_w1, B_w2)
    return h2
```

```asm
; @launch grid=(256,1,1) block=(512,1,1) lds=163840
.amdgcn_target "amdgcn-amd-amdhsa--gfx950"
.text
.globl sequential_preLN__linear_attn_block__dense_activation_relu__prompt_kernel
.p2align 8
.type sequential_preLN__linear_attn_block__dense_activation_relu__prompt_kernel,@function
sequential_preLN__linear_attn_block__dense_activation_relu__prompt_kernel:
    s_cmp_ge_u32 s2, 256
    s_cbranch_scc1 sequential_preLN__linear_attn_block__dense_activation_relu__prompt_kernel_end1
    s_load_dwordx16 s[4:19], s[0:1], 0
    s_load_dwordx2 s[20:21], s[0:1], 64
    v_lshrrev_b32 v1, 6, v0
    s_lshr_b32 s23, s2, 3
    v_readfirstlane_b32 s22, v1
    v_and_b32 v1, 63, v0
    s_bfe_u32 s24, s2, 0x20001
    s_and_b32 s25, s2, 1
    s_sub_u32 s26, s23, 8
    s_and_b32 s26, s26, 31
    s_mov_b32 s27, 0
    s_cmp_ge_u32 s26, 24
    s_cbranch_scc1 sequential_preLN__linear_attn_block__dense_activation_relu__prompt_kernel_svc4
    s_cmp_lt_u32 s22, 6
    s_cbranch_scc1 sequential_preLN__linear_attn_block__dense_activation_relu__prompt_kernel_role5
    s_cmp_eq_u32 s22, 7
    s_cbranch_scc1 sequential_preLN__linear_attn_block__dense_activation_relu__prompt_kernel_h16
    s_mul_i32 s28, s25, 640
    v_min_u32 v5, 59, v1
    v_mul_u32_u24 v4, 69, v5
    v_lshrrev_b32 v4, 10, v4
    v_mul_u32_u24 v3, 15, v4
    v_sub_u32 v5, v5, v3
    v_mul_u32_u24 v4, 3840, v4
    v_lshl_add_u32 v3, v5, 7, v4
    v_mul_u32_u24 v4, 205, v5
    v_lshrrev_b32 v4, 10, v4
    v_mul_u32_u24 v4, 640, v4
    v_add_u32 v3, v3, v4
    s_waitcnt lgkmcnt(0)
    s_add_u32 s30, s26, 0
    s_mul_i32 s30, s30, 4
    s_min_u32 s30, s30, 636
    s_mul_i32 s30, s30, 3840
    s_add_u32 s30, s30, s28
    s_add_u32 s32, s6, s30
    s_addc_u32 s33, s7, 0
    global_load_dword v2, v3, s[32:33]
sequential_preLN__linear_attn_block__dense_activation_relu__prompt_kernel_tsk7:
    s_add_u32 s30, s26, 24
    s_mul_i32 s30, s30, 4
    s_min_u32 s30, s30, 636
    s_mul_i32 s30, s30, 3840
    s_add_u32 s30, s30, s28
    s_add_u32 s32, s6, s30
    s_addc_u32 s33, s7, 0
    global_load_dword v2, v3, s[32:33]
sequential_preLN__linear_attn_block__dense_activation_relu__prompt_kernel_tsk8:
    s_add_u32 s30, s26, 48
    s_mul_i32 s30, s30, 4
    s_min_u32 s30, s30, 636
    s_mul_i32 s30, s30, 3840
    s_add_u32 s30, s30, s28
    s_add_u32 s32, s6, s30
    s_addc_u32 s33, s7, 0
    global_load_dword v2, v3, s[32:33]
sequential_preLN__linear_attn_block__dense_activation_relu__prompt_kernel_tsk9:
    s_endpgm
sequential_preLN__linear_attn_block__dense_activation_relu__prompt_kernel_h16:
    s_getpc_b64 s[34:35]
    sequential_preLN__linear_attn_block__dense_activation_relu__prompt_kernel_pc:
    s_sub_u32 s34, s34, sequential_preLN__linear_attn_block__dense_activation_relu__prompt_kernel_pc-sequential_preLN__linear_attn_block__dense_activation_relu__prompt_kernel
    s_subb_u32 s35, s35, 0
    s_lshl_b32 s29, s26, 11
    v_lshlrev_b32 v6, 7, v1
    v_add_u32 v6, s29, v6
    v_min_u32 v6, sequential_preLN__linear_attn_block__dense_activation_relu__prompt_kernel_last-sequential_preLN__linear_attn_block__dense_activation_relu__prompt_kernel, v6
    v_mov_b32 v7, s35
    v_add_co_u32 v6, vcc, s34, v6
    s_nop 1
    v_addc_co_u32 v7, vcc, 0, v7, vcc
    s_mov_b64 exec, 0xffff
    global_load_dword v2, v[6:7], off
    s_mov_b64 exec, -1
    s_and_b32 s28, s2, 7
    s_xor_b32 s28, s28, 1
    s_mul_i32 s28, s28, 327680
    v_min_u32 v10, 63, v1
    v_mul_u32_u24 v9, 64, v10
    v_lshrrev_b32 v9, 10, v9
    v_mul_u32_u24 v8, 16, v9
    v_sub_u32 v10, v10, v8
    v_mul_u32_u24 v9, 2048, v9
    v_lshl_add_u32 v8, v10, 7, v9
    s_waitcnt lgkmcnt(0)
    s_add_u32 s30, s26, 0
    s_mul_i32 s30, s30, 4
    s_min_u32 s30, s30, 156
    s_mul_i32 s30, s30, 2048
    s_add_u32 s30, s30, s28
    s_add_u32 s32, s4, s30
    s_addc_u32 s33, s5, 0
    global_load_dword v2, v8, s[32:33]
sequential_preLN__linear_attn_block__dense_activation_relu__prompt_kernel_tsk10:
    s_cmp_ge_u32 s26, 16
    s_cbranch_scc1 sequential_preLN__linear_attn_block__dense_activation_relu__prompt_kernel_hx11
    s_add_u32 s30, s26, 24
    s_mul_i32 s30, s30, 4
    s_min_u32 s30, s30, 156
    s_mul_i32 s30, s30, 2048
    s_add_u32 s30, s30, s28
    s_add_u32 s32, s4, s30
    s_addc_u32 s33, s5, 0
    global_load_dword v2, v8, s[32:33]
sequential_preLN__linear_attn_block__dense_activation_relu__prompt_kernel_tsk12:
sequential_preLN__linear_attn_block__dense_activation_relu__prompt_kernel_hx11:
    s_endpgm
sequential_preLN__linear_attn_block__dense_activation_relu__prompt_kernel_role5:
    s_cmp_lt_u32 s22, 4
    s_cbranch_scc1 sequential_preLN__linear_attn_block__dense_activation_relu__prompt_kernel_cons2
    s_cmp_ge_u32 s22, 6
    s_cbranch_scc1 sequential_preLN__linear_attn_block__dense_activation_relu__prompt_kernel_end1
    s_sub_u32 s28, s22, 4
    s_and_b32 s49, s26, 3
    s_lshl_b32 s3, s24, 2
    s_add_u32 s49, s49, s3
    s_lshr_b32 s51, s26, 3
    s_sub_u32 s51, s51, 1
    s_max_i32 s51, s51, 0
    s_lshr_b32 s50, s26, 2
    s_lshl_b32 s3, s25, 2
    s_add_u32 s50, s50, s3
    s_lshl_b32 s3, s25, 1
    s_add_u32 s3, s3, 4
    s_cmp_eq_u32 s51, 1
    s_cselect_b32 s3, s3, 0
    s_sub_u32 s50, s50, s3
    s_and_b32 s3, s26, 7
    s_cmp_eq_u32 s51, 2
    s_cselect_b32 s50, s3, s50
    s_mul_i32 s29, s49, 163840
    s_mul_i32 s30, s50, 160
    s_add_u32 s3, s30, 1280
    s_lshl_b32 s30, s30, 1
    s_cmp_eq_u32 s51, 0
    s_cselect_b32 s30, s3, s30
    s_movk_i32 s34, 160
    s_cselect_b32 s34, 1280, s34
    s_cmp_eq_u32 s27, 1
    s_cbranch_scc1 sequential_preLN__linear_attn_block__dense_activation_relu__prompt_kernel_ldq13
    v_lshrrev_b32 v104, 3, v1
    v_and_b32 v105, 6, v104
    v_and_b32 v106, 7, v1
    v_xor_b32 v105, v105, v106
    v_lshlrev_b32 v105, 4, v105
    s_mov_b32 s59, 1280
    v_mad_u32_u24 v107, v104, s59, v105
    v_add_u32 v114, 72704, v107
    v_add_u32 v113, 63488, v107
    v_add_u32 v112, 54272, v107
    v_add_u32 v111, 45056, v107
    v_add_u32 v110, 31744, v107
    v_add_u32 v109, 22528, v107
    v_add_u32 v108, 13312, v107
    v_add_u32 v107, 4096, v107
    s_mul_i32 s59, s28, 81920
    s_add_u32 s61, s29, s59
    s_mul_i32 s59, s28, 122880
    s_add_u32 s62, s30, s59
    s_mul_i32 s63, s28, 8192
    s_mul_i32 s64, s28, 10240
    s_waitcnt lgkmcnt(0)
    s_sub_u32 s36, s4, 4096
    s_subb_u32 s37, s5, 0
    s_mov_b32 s38, 2625536
    s_mov_b32 s39, 0x20000
    s_sub_u32 s40, s6, 4096
    s_subb_u32 s41, s7, 0
    s_mov_b32 s42, 2461696
    s_mov_b32 s43, 0x20000
    s_add_u32 s59, s61, 0
    s_add_u32 m0, s63, 0
    s_nop 0
    buffer_load_dwordx4 v107, s[36:39], s59 offen offset:0  lds
    buffer_load_dwordx4 v108, s[36:39], s59 offen offset:1024  lds
    buffer_load_dwordx4 v109, s[36:39], s59 offen offset:2048  lds
    buffer_load_dwordx4 v110, s[36:39], s59 offen offset:3072  lds
    s_add_u32 m0, s63, 4096
    s_nop 0
    buffer_load_dwordx4 v111, s[36:39], s59 offen offset:0  lds
    buffer_load_dwordx4 v112, s[36:39], s59 offen offset:1024  lds
    buffer_load_dwordx4 v113, s[36:39], s59 offen offset:2048  lds
    buffer_load_dwordx4 v114, s[36:39], s59 offen offset:3072  lds
    s_mov_b32 s60, 3840
    v_add_u32 v104, 0, v1
    v_mul_u32_u24 v105, 205, v104
    v_lshrrev_b32 v105, 11, v105
    v_mul_u32_u24 v106, 10, v105
    v_sub_u32 v106, v104, v106
    v_lshlrev_b32 v115, 4, v106
    v_lshrrev_b32 v106, 4, v105
    v_mul_u32_u24 v106, s34, v106
    v_add_u32 v115, v115, v106
    v_and_b32 v106, 3, v105
    v_and_b32 v104, 4, v105
    v_lshl_or_b32 v106, v104, 1, v106
    v_and_b32 v104, 8, v105
    v_lshrrev_b32 v104, 1, v104
    v_or_b32 v106, v106, v104
    v_mad_u32_u24 v115, v106, s60, v115
    v_add_u32 v104, 64, v1
    v_mul_u32_u24 v105, 205, v104
    v_lshrrev_b32 v105, 11, v105
    v_mul_u32_u24 v106, 10, v105
    v_sub_u32 v106, v104, v106
    v_lshlrev_b32 v116, 4, v106
    v_lshrrev_b32 v106, 4, v105
    v_mul_u32_u24 v106, s34, v106
    v_add_u32 v116, v116, v106
    v_and_b32 v106, 3, v105
    v_and_b32 v104, 4, v105
    v_lshl_or_b32 v106, v104, 1, v106
    v_and_b32 v104, 8, v105
    v_lshrrev_b32 v104, 1, v104
    v_or_b32 v106, v106, v104
    v_mad_u32_u24 v116, v106, s60, v116
    v_add_u32 v104, 128, v1
    v_mul_u32_u24 v105, 205, v104
    v_lshrrev_b32 v105, 11, v105
    v_mul_u32_u24 v106, 10, v105
    v_sub_u32 v106, v104, v106
    v_lshlrev_b32 v117, 4, v106
    v_lshrrev_b32 v106, 4, v105
    v_mul_u32_u24 v106, s34, v106
    v_add_u32 v117, v117, v106
    v_and_b32 v106, 3, v105
    v_and_b32 v104, 4, v105
    v_lshl_or_b32 v106, v104, 1, v106
    v_and_b32 v104, 8, v105
    v_lshrrev_b32 v104, 1, v104
    v_or_b32 v106, v106, v104
    v_mad_u32_u24 v117, v106, s60, v117
    v_add_u32 v104, 192, v1
    v_mul_u32_u24 v105, 205, v104
    v_lshrrev_b32 v105, 11, v105
    v_mul_u32_u24 v106, 10, v105
    v_sub_u32 v106, v104, v106
    v_lshlrev_b32 v118, 4, v106
    v_lshrrev_b32 v106, 4, v105
    v_mul_u32_u24 v106, s34, v106
    v_add_u32 v118, v118, v106
    v_and_b32 v106, 3, v105
    v_and_b32 v104, 4, v105
    v_lshl_or_b32 v106, v104, 1, v106
    v_and_b32 v104, 8, v105
    v_lshrrev_b32 v104, 1, v104
    v_or_b32 v106, v106, v104
    v_mad_u32_u24 v118, v106, s60, v118
    v_add_u32 v104, 256, v1
    v_mul_u32_u24 v105, 205, v104
    v_lshrrev_b32 v105, 11, v105
    v_mul_u32_u24 v106, 10, v105
    v_sub_u32 v106, v104, v106
    v_lshlrev_b32 v119, 4, v106
    v_lshrrev_b32 v106, 4, v105
    v_mul_u32_u24 v106, s34, v106
    v_add_u32 v119, v119, v106
    v_and_b32 v106, 3, v105
    v_and_b32 v104, 4, v105
    v_lshl_or_b32 v106, v104, 1, v106
    v_and_b32 v104, 8, v105
    v_lshrrev_b32 v104, 1, v104
    v_or_b32 v106, v106, v104
    v_mad_u32_u24 v119, v106, s60, v119
    v_add_u32 v120, 4096, v115
    v_add_u32 v121, 3072, v116
    v_add_u32 v122, 2048, v117
    v_add_u32 v123, 1024, v118
    v_add_u32 v124, 4096, v119
    v_add_u32 v125, 64512, v115
    v_add_u32 v126, 63488, v116
    v_add_u32 v127, 62464, v117
    v_add_u32 v128, 65536, v118
    v_add_u32 v129, 64512, v119
    s_add_u32 s60, s62, 0
    s_add_u32 m0, s64, 65536
    s_nop 0
    buffer_load_dwordx4 v120, s[40:43], s60 offen offset:0 lds
    buffer_load_dwordx4 v121, s[40:43], s60 offen offset:1024 lds
    buffer_load_dwordx4 v122, s[40:43], s60 offen offset:2048 lds
    s_add_u32 s44, s20, 17825792
    s_addc_u32 s45, s21, 0
    s_mov_b32 s46, 737280
    s_mov_b32 s47, 0x20000
    v_mov_b32 v9, 1
    s_lshl_b32 s33, s23, 1
    s_add_u32 s33, s33, s28
    s_mul_i32 s32, s49, 6144
    s_add_u32 s32, s32, 540672
    s_lshl_b32 s3, s50, 2
    s_add_u32 s32, s32, s3
    s_and_b32 s3, s50, 3
    s_mul_i32 s3, s3, 320
    s_add_u32 s3, s3, 1280
    s_and_b32 s31, s50, 1
    s_mul_i32 s31, s31, 640
    s_cmp_eq_u32 s51, 0
    s_cselect_b32 s3, s3, s31
    s_cselect_b32 s31, 960, 0
    v_lshlrev_b32 v45, 4, v1
    v_add_u32 v45, s3, v45
    v_cmp_lt_u32 vcc, 19, v1
    v_mov_b32 v42, s31
    s_lshl_b32 s3, s25, 12
    v_cndmask_b32 v42, 0, v42, vcc
    s_add_u32 s3, s3, 16384
    v_add3_u32 v45, v45, v42, s3
    v_cmp_gt_u32 vcc, 40, v1
    v_mov_b32 v42, 2146435072
    s_nop 0
    v_cndmask_b32 v45, v42, v45, vcc
    s_and_b32 s3, s22, 1
    s_lshl_b32 s3, s3, 3
    v_add_u32 v42, 0, v1
    v_mul_u32_u24 v43, 205, v42
    v_lshrrev_b32 v43, 11, v43
    v_mul_u32_u24 v44, 10, v43
    v_sub_u32 v44, v42, v44
    v_lshlrev_b32 v51, 4, v44
    v_and_b32 v46, 3, v43
    v_bfe_u32 v42, v43, 3, 1
    v_lshl_or_b32 v46, v42, 2, v46
    v_add_u32 v46, s3, v46
    v_bfe_u32 v42, v43, 2, 1
    v_lshrrev_b32 v44, 4, v43
    v_lshl_or_b32 v42, v44, 1, v42
    v_mul_u32_u24 v42, 6400, v42
    v_add_u32 v51, v51, v42
    s_and_b32 s3, s22, 1
    s_lshl_b32 s3, s3, 3
    v_add_u32 v42, 64, v1
    v_mul_u32_u24 v43, 205, v42
    v_lshrrev_b32 v43, 11, v43
    v_mul_u32_u24 v44, 10, v43
    v_sub_u32 v44, v42, v44
    v_lshlrev_b32 v52, 4, v44
    v_and_b32 v47, 3, v43
    v_bfe_u32 v42, v43, 3, 1
    v_lshl_or_b32 v47, v42, 2, v47
    v_add_u32 v47, s3, v47
    v_bfe_u32 v42, v43, 2, 1
    v_lshrrev_b32 v44, 4, v43
    v_lshl_or_b32 v42, v44, 1, v42
    v_mul_u32_u24 v42, 6400, v42
    v_add_u32 v52, v52, v42
    s_and_b32 s3, s22, 1
    s_lshl_b32 s3, s3, 3
    v_add_u32 v42, 128, v1
    v_mul_u32_u24 v43, 205, v42
    v_lshrrev_b32 v43, 11, v43
    v_mul_u32_u24 v44, 10, v43
    v_sub_u32 v44, v42, v44
    v_lshlrev_b32 v53, 4, v44
    v_and_b32 v48, 3, v43
    v_bfe_u32 v42, v43, 3, 1
    v_lshl_or_b32 v48, v42, 2, v48
    v_add_u32 v48, s3, v48
    v_bfe_u32 v42, v43, 2, 1
    v_lshrrev_b32 v44, 4, v43
    v_lshl_or_b32 v42, v44, 1, v42
    v_mul_u32_u24 v42, 6400, v42
    v_add_u32 v53, v53, v42
    s_and_b32 s3, s22, 1
    s_lshl_b32 s3, s3, 3
    v_add_u32 v42, 192, v1
    v_mul_u32_u24 v43, 205, v42
    v_lshrrev_b32 v43, 11, v43
    v_mul_u32_u24 v44, 10, v43
    v_sub_u32 v44, v42, v44
    v_lshlrev_b32 v54, 4, v44
    v_and_b32 v49, 3, v43
    v_bfe_u32 v42, v43, 3, 1
    v_lshl_or_b32 v49, v42, 2, v49
    v_add_u32 v49, s3, v49
    v_bfe_u32 v42, v43, 2, 1
    v_lshrrev_b32 v44, 4, v43
    v_lshl_or_b32 v42, v44, 1, v42
    v_mul_u32_u24 v42, 6400, v42
    v_add_u32 v54, v54, v42
    s_and_b32 s3, s22, 1
    s_lshl_b32 s3, s3, 3
    v_add_u32 v42, 256, v1
    v_mul_u32_u24 v43, 205, v42
    v_lshrrev_b32 v43, 11, v43
    v_mul_u32_u24 v44, 10, v43
    v_sub_u32 v44, v42, v44
    v_lshlrev_b32 v55, 4, v44
    v_and_b32 v50, 3, v43
    v_bfe_u32 v42, v43, 3, 1
    v_lshl_or_b32 v50, v42, 2, v50
    v_add_u32 v50, s3, v50
    v_bfe_u32 v42, v43, 2, 1
    v_lshrrev_b32 v44, 4, v43
    v_lshl_or_b32 v42, v44, 1, v42
    v_mul_u32_u24 v42, 6400, v42
    v_add_u32 v55, v55, v42
    s_lshl_b32 s58, s26, 3
    s_and_b32 s3, s2, 7
    s_add_u32 s58, s58, s3
    s_lshl_b32 s58, s58, 1
    s_add_u32 s58, s58, s28
    s_min_u32 s56, s58, 359
    s_mul_i32 s57, s56, 1457
    s_lshr_b32 s57, s57, 16
    s_mul_i32 s3, s57, 45
    s_sub_u32 s65, s56, s3
    s_mul_i32 s65, s65, 6
    s_mul_i32 s56, s56, 6144
    s_movk_i32 s67, 1280
    s_mul_i32 s66, s65, 13108
    s_lshr_b32 s66, s66, 16
    s_mul_i32 s3, s66, 5
    s_sub_u32 s3, s65, s3
    s_lshl_b32 s3, s3, 6
    v_add_u32 v42, s3, v1
    s_mul_i32 s66, s66, 40960
    s_mul_i32 s3, s57, 160
    s_add_u32 s66, s66, s3
    v_mul_u32_u24 v43, 205, v42
    v_lshrrev_b32 v43, 11, v43
    v_mul_u32_u24 v44, 10, v43
    v_sub_u32 v44, v42, v44
    v_lshl_add_u32 v72, v44, 4, s66
    v_and_b32 v44, 19, v43
    v_and_b32 v42, 4, v43
    v_lshl_or_b32 v44, v42, 1, v44
    v_and_b32 v42, 8, v43
    v_lshrrev_b32 v42, 1, v42
    v_or_b32 v44, v44, v42
    v_mad_u32_u24 v72, v44, s67, v72
    s_add_u32 s65, s65, 1
    s_mul_i32 s66, s65, 13108
    s_lshr_b32 s66, s66, 16
    s_mul_i32 s3, s66, 5
    s_sub_u32 s3, s65, s3
    s_lshl_b32 s3, s3, 6
    v_add_u32 v42, s3, v1
    s_mul_i32 s66, s66, 40960
    s_mul_i32 s3, s57, 160
    s_add_u32 s66, s66, s3
    v_mul_u32_u24 v43, 205, v42
    v_lshrrev_b32 v43, 11, v43
    v_mul_u32_u24 v44, 10, v43
    v_sub_u32 v44, v42, v44
    v_lshl_add_u32 v73, v44, 4, s66
    v_and_b32 v44, 19, v43
    v_and_b32 v42, 4, v43
    v_lshl_or_b32 v44, v42, 1, v44
    v_and_b32 v42, 8, v43
    v_lshrrev_b32 v42, 1, v42
    v_or_b32 v44, v44, v42
    v_mad_u32_u24 v73, v44, s67, v73
    s_add_u32 s65, s65, 1
    s_mul_i32 s66, s65, 13108
    s_lshr_b32 s66, s66, 16
    s_mul_i32 s3, s66, 5
    s_sub_u32 s3, s65, s3
    s_lshl_b32 s3, s3, 6
    v_add_u32 v42, s3, v1
    s_mul_i32 s66, s66, 40960
    s_mul_i32 s3, s57, 160
    s_add_u32 s66, s66, s3
    v_mul_u32_u24 v43, 205, v42
    v_lshrrev_b32 v43, 11, v43
    v_mul_u32_u24 v44, 10, v43
    v_sub_u32 v44, v42, v44
    v_lshl_add_u32 v74, v44, 4, s66
    v_and_b32 v44, 19, v43
    v_and_b32 v42, 4, v43
    v_lshl_or_b32 v44, v42, 1, v44
    v_and_b32 v42, 8, v43
    v_lshrrev_b32 v42, 1, v42
    v_or_b32 v44, v44, v42
    v_mad_u32_u24 v74, v44, s67, v74
    s_add_u32 s65, s65, 1
    s_mul_i32 s66, s65, 13108
    s_lshr_b32 s66, s66, 16
    s_mul_i32 s3, s66, 5
    s_sub_u32 s3, s65, s3
    s_lshl_b32 s3, s3, 6
    v_add_u32 v42, s3, v1
    s_mul_i32 s66, s66, 40960
    s_mul_i32 s3, s57, 160
    s_add_u32 s66, s66, s3
    v_mul_u32_u24 v43, 205, v42
    v_lshrrev_b32 v43, 11, v43
    v_mul_u32_u24 v44, 10, v43
    v_sub_u32 v44, v42, v44
    v_lshl_add_u32 v75, v44, 4, s66
    v_and_b32 v44, 19, v43
    v_and_b32 v42, 4, v43
    v_lshl_or_b32 v44, v42, 1, v44
    v_and_b32 v42, 8, v43
    v_lshrrev_b32 v42, 1, v42
    v_or_b32 v44, v44, v42
    v_mad_u32_u24 v75, v44, s67, v75
    s_add_u32 s65, s65, 1
    s_mul_i32 s66, s65, 13108
    s_lshr_b32 s66, s66, 16
    s_mul_i32 s3, s66, 5
    s_sub_u32 s3, s65, s3
    s_lshl_b32 s3, s3, 6
    v_add_u32 v42, s3, v1
    s_mul_i32 s66, s66, 40960
    s_mul_i32 s3, s57, 160
    s_add_u32 s66, s66, s3
    v_mul_u32_u24 v43, 205, v42
    v_lshrrev_b32 v43, 11, v43
    v_mul_u32_u24 v44, 10, v43
    v_sub_u32 v44, v42, v44
    v_lshl_add_u32 v76, v44, 4, s66
    v_and_b32 v44, 19, v43
    v_and_b32 v42, 4, v43
    v_lshl_or_b32 v44, v42, 1, v44
    v_and_b32 v42, 8, v43
    v_lshrrev_b32 v42, 1, v42
    v_or_b32 v44, v44, v42
    v_mad_u32_u24 v76, v44, s67, v76
    s_add_u32 s65, s65, 1
    s_mul_i32 s66, s65, 13108
    s_lshr_b32 s66, s66, 16
    s_mul_i32 s3, s66, 5
    s_sub_u32 s3, s65, s3
    s_lshl_b32 s3, s3, 6
    v_add_u32 v42, s3, v1
    s_mul_i32 s66, s66, 40960
    s_mul_i32 s3, s57, 160
    s_add_u32 s66, s66, s3
    v_mul_u32_u24 v43, 205, v42
    v_lshrrev_b32 v43, 11, v43
    v_mul_u32_u24 v44, 10, v43
    v_sub_u32 v44, v42, v44
    v_lshl_add_u32 v77, v44, 4, s66
    v_and_b32 v44, 19, v43
    v_and_b32 v42, 4, v43
    v_lshl_or_b32 v44, v42, 1, v44
    v_and_b32 v42, 8, v43
    v_lshrrev_b32 v42, 1, v42
    v_or_b32 v44, v44, v42
    v_mad_u32_u24 v77, v44, s67, v77
    s_add_u32 s65, s65, 1
    buffer_load_dwordx4 v123, s[40:43], s60 offen offset:3072 lds
    s_add_u32 m0, s64, 69632
    s_nop 0
    buffer_load_dwordx4 v124, s[40:43], s60 offen offset:0 lds
    buffer_load_dwordx4 v125, s[40:43], s60 offen offset:1024 lds
    buffer_load_dwordx4 v126, s[40:43], s60 offen offset:2048 lds
    buffer_load_dwordx4 v127, s[40:43], s60 offen offset:3072 lds
    s_add_u32 m0, s64, 73728
    s_nop 0
    buffer_load_dwordx4 v128, s[40:43], s60 offen offset:0 lds
    buffer_load_dwordx4 v129, s[40:43], s60 offen offset:1024 lds
    s_add_u32 s59, s61, 128
    s_add_u32 m0, s63, 16384
    s_nop 0
    buffer_load_dwordx4 v107, s[36:39], s59 offen offset:0  lds
    buffer_load_dwordx4 v108, s[36:39], s59 offen offset:1024  lds
    buffer_load_dwordx4 v109, s[36:39], s59 offen offset:2048  lds
    buffer_load_dwordx4 v110, s[36:39], s59 offen offset:3072  lds
    s_waitcnt vmcnt(4)
    s_barrier
    s_add_u32 m0, s63, 20480
    s_nop 0
    buffer_load_dwordx4 v111, s[36:39], s59 offen offset:0  lds
    buffer_load_dwordx4 v112, s[36:39], s59 offen offset:1024  lds
    buffer_load_dwordx4 v113, s[36:39], s59 offen offset:2048  lds
    buffer_load_dwordx4 v114, s[36:39], s59 offen offset:3072  lds
    s_add_u32 s60, s62, 245760
    s_add_u32 m0, s64, 86016
    s_nop 0
    buffer_load_dwordx4 v120, s[40:43], s60 offen offset:0 lds
    buffer_load_dwordx4 v121, s[40:43], s60 offen offset:1024 lds
    buffer_load_dwordx4 v122, s[40:43], s60 offen offset:2048 lds
    buffer_load_dwordx4 v123, s[40:43], s60 offen offset:3072 lds
    s_add_u32 m0, s64, 90112
    s_nop 0
    buffer_load_dwordx4 v124, s[40:43], s60 offen offset:0 lds
    buffer_load_dwordx4 v125, s[40:43], s60 offen offset:1024 lds
    buffer_load_dwordx4 v126, s[40:43], s60 offen offset:2048 lds
    buffer_load_dwordx4 v127, s[40:43], s60 offen offset:3072 lds
    s_add_u32 m0, s64, 94208
    s_nop 0
    buffer_load_dwordx4 v128, s[40:43], s60 offen offset:0 lds
    buffer_load_dwordx4 v129, s[40:43], s60 offen offset:1024 lds
    s_add_u32 s59, s61, 256
    s_add_u32 m0, s63, 32768
    s_nop 0
    buffer_load_dwordx4 v107, s[36:39], s59 offen offset:0  lds
    buffer_load_dwordx4 v108, s[36:39], s59 offen offset:1024  lds
    buffer_load_dwordx4 v109, s[36:39], s59 offen offset:2048  lds
    buffer_load_dwordx4 v110, s[36:39], s59 offen offset:3072  lds
    s_add_u32 m0, s63, 36864
    s_nop 0
    buffer_load_dwordx4 v111, s[36:39], s59 offen offset:0  lds
    buffer_load_dwordx4 v112, s[36:39], s59 offen offset:1024  lds
    buffer_load_dwordx4 v113, s[36:39], s59 offen offset:2048  lds
    buffer_load_dwordx4 v114, s[36:39], s59 offen offset:3072  lds
    s_add_u32 s60, s62, 491520
    s_add_u32 m0, s64, 106496
    s_nop 0
    buffer_load_dwordx4 v120, s[40:43], s60 offen offset:0 lds
    buffer_load_dwordx4 v121, s[40:43], s60 offen offset:1024 lds
    buffer_load_dwordx4 v122, s[40:43], s60 offen offset:2048 lds
    buffer_load_dwordx4 v123, s[40:43], s60 offen offset:3072 lds
    s_add_u32 m0, s64, 110592
    s_nop 0
    buffer_load_dwordx4 v124, s[40:43], s60 offen offset:0 lds
    buffer_load_dwordx4 v125, s[40:43], s60 offen offset:1024 lds
    buffer_load_dwordx4 v126, s[40:43], s60 offen offset:2048 lds
    buffer_load_dwordx4 v127, s[40:43], s60 offen offset:3072 lds
    s_waitcnt vmcnt(16)
    s_barrier
    s_add_u32 m0, s64, 114688
    s_nop 0
    buffer_load_dwordx4 v128, s[40:43], s60 offen offset:0 lds
    buffer_load_dwordx4 v129, s[40:43], s60 offen offset:1024 lds
    s_add_u32 s59, s61, 384
    s_add_u32 m0, s63, 49152
    s_nop 0
    buffer_load_dwordx4 v107, s[36:39], s59 offen offset:0  lds
    buffer_load_dwordx4 v108, s[36:39], s59 offen offset:1024  lds
    buffer_load_dwordx4 v109, s[36:39], s59 offen offset:2048  lds
    buffer_load_dwordx4 v110, s[36:39], s59 offen offset:3072  lds
    s_add_u32 m0, s63, 53248
    s_nop 0
    buffer_load_dwordx4 v111, s[36:39], s59 offen offset:0  lds
    buffer_load_dwordx4 v112, s[36:39], s59 offen offset:1024  lds
    buffer_load_dwordx4 v113, s[36:39], s59 offen offset:2048  lds
    buffer_load_dwordx4 v114, s[36:39], s59 offen offset:3072  lds
    s_add_u32 s60, s62, 737280
    s_add_u32 m0, s64, 126976
    s_nop 0
    buffer_load_dwordx4 v120, s[40:43], s60 offen offset:0 lds
    buffer_load_dwordx4 v121, s[40:43], s60 offen offset:1024 lds
    buffer_load_dwordx4 v122, s[40:43], s60 offen offset:2048 lds
    buffer_load_dwordx4 v123, s[40:43], s60 offen offset:3072 lds
    s_add_u32 m0, s64, 131072
    s_nop 0
    buffer_load_dwordx4 v124, s[40:43], s60 offen offset:0 lds
    buffer_load_dwordx4 v125, s[40:43], s60 offen offset:1024 lds
    buffer_load_dwordx4 v126, s[40:43], s60 offen offset:2048 lds
    buffer_load_dwordx4 v127, s[40:43], s60 offen offset:3072 lds
    s_waitcnt vmcnt(16)
    s_barrier
    s_add_u32 m0, s64, 135168
    s_nop 0
    buffer_load_dwordx4 v128, s[40:43], s60 offen offset:0 lds
    buffer_load_dwordx4 v129, s[40:43], s60 offen offset:1024 lds
    s_add_u32 s59, s61, 512
    s_add_u32 m0, s63, 0
    s_nop 0
    buffer_load_dwordx4 v107, s[36:39], s59 offen offset:0  lds
    buffer_load_dwordx4 v108, s[36:39], s59 offen offset:1024  lds
    buffer_load_dwordx4 v109, s[36:39], s59 offen offset:2048  lds
    buffer_load_dwordx4 v110, s[36:39], s59 offen offset:3072  lds
    s_add_u32 m0, s63, 4096
    s_nop 0
    buffer_load_dwordx4 v111, s[36:39], s59 offen offset:0  lds
    buffer_load_dwordx4 v112, s[36:39], s59 offen offset:1024  lds
    buffer_load_dwordx4 v113, s[36:39], s59 offen offset:2048  lds
    buffer_load_dwordx4 v114, s[36:39], s59 offen offset:3072  lds
    s_add_u32 s60, s62, 983040
    s_add_u32 m0, s64, 65536
    s_nop 0
    buffer_load_dwordx4 v120, s[40:43], s60 offen offset:0 lds
    buffer_load_dwordx4 v121, s[40:43], s60 offen offset:1024 lds
    buffer_load_dwordx4 v122, s[40:43], s60 offen offset:2048 lds
    buffer_load_dwordx4 v123, s[40:43], s60 offen offset:3072 lds
    s_add_u32 m0, s64, 69632
    s_nop 0
    buffer_load_dwordx4 v124, s[40:43], s60 offen offset:0 lds
    buffer_load_dwordx4 v125, s[40:43], s60 offen offset:1024 lds
    buffer_load_dwordx4 v126, s[40:43], s60 offen offset:2048 lds
    buffer_load_dwordx4 v127, s[40:43], s60 offen offset:3072 lds
    s_waitcnt vmcnt(16)
    s_barrier
    s_add_u32 m0, s64, 73728
    s_nop 0
    buffer_load_dwordx4 v128, s[40:43], s60 offen offset:0 lds
    buffer_load_dwordx4 v129, s[40:43], s60 offen offset:1024 lds
    s_add_u32 s59, s61, 640
    s_add_u32 m0, s63, 16384
    s_nop 0
    buffer_load_dwordx4 v107, s[36:39], s59 offen offset:0  lds
    buffer_load_dwordx4 v108, s[36:39], s59 offen offset:1024  lds
    buffer_load_dwordx4 v109, s[36:39], s59 offen offset:2048  lds
    buffer_load_dwordx4 v110, s[36:39], s59 offen offset:3072  lds
    s_add_u32 m0, s63, 20480
    s_nop 0
    buffer_load_dwordx4 v111, s[36:39], s59 offen offset:0  lds
    buffer_load_dwordx4 v112, s[36:39], s59 offen offset:1024  lds
    buffer_load_dwordx4 v113, s[36:39], s59 offen offset:2048  lds
    buffer_load_dwordx4 v114, s[36:39], s59 offen offset:3072  lds
    s_add_u32 s60, s62, 1228800
    s_add_u32 m0, s64, 86016
    s_nop 0
    buffer_load_dwordx4 v120, s[40:43], s60 offen offset:0 lds
    buffer_load_dwordx4 v121, s[40:43], s60 offen offset:1024 lds
    buffer_load_dwordx4 v122, s[40:43], s60 offen offset:2048 lds
    buffer_load_dwordx4 v123, s[40:43], s60 offen offset:3072 lds
    s_add_u32 m0, s64, 90112
    s_nop 0
    buffer_load_dwordx4 v124, s[40:43], s60 offen offset:0 lds
    buffer_load_dwordx4 v125, s[40:43], s60 offen offset:1024 lds
    buffer_load_dwordx4 v126, s[40:43], s60 offen offset:2048 lds
    buffer_load_dwordx4 v127, s[40:43], s60 offen offset:3072 lds
    s_waitcnt vmcnt(16)
    s_barrier
    s_add_u32 m0, s64, 94208
    s_nop 0
    buffer_load_dwordx4 v128, s[40:43], s60 offen offset:0 lds
    buffer_load_dwordx4 v129, s[40:43], s60 offen offset:1024 lds
    s_add_u32 s59, s61, 768
    s_add_u32 m0, s63, 32768
    s_nop 0
    buffer_load_dwordx4 v107, s[36:39], s59 offen offset:0  lds
    buffer_load_dwordx4 v108, s[36:39], s59 offen offset:1024  lds
    buffer_load_dwordx4 v109, s[36:39], s59 offen offset:2048  lds
    buffer_load_dwordx4 v110, s[36:39], s59 offen offset:3072  lds
    s_add_u32 m0, s63, 36864
    s_nop 0
    buffer_load_dwordx4 v111, s[36:39], s59 offen offset:0  lds
    buffer_load_dwordx4 v112, s[36:39], s59 offen offset:1024  lds
    buffer_load_dwordx4 v113, s[36:39], s59 offen offset:2048  lds
    buffer_load_dwordx4 v114, s[36:39], s59 offen offset:3072  lds
    s_add_u32 s60, s62, 1474560
    s_add_u32 m0, s64, 106496
    s_nop 0
    buffer_load_dwordx4 v120, s[40:43], s60 offen offset:0 lds
    buffer_load_dwordx4 v121, s[40:43], s60 offen offset:1024 lds
    buffer_load_dwordx4 v122, s[40:43], s60 offen offset:2048 lds
    buffer_load_dwordx4 v123, s[40:43], s60 offen offset:3072 lds
    s_add_u32 m0, s64, 110592
    s_nop 0
    buffer_load_dwordx4 v124, s[40:43], s60 offen offset:0 lds
    buffer_load_dwordx4 v125, s[40:43], s60 offen offset:1024 lds
    buffer_load_dwordx4 v126, s[40:43], s60 offen offset:2048 lds
    buffer_load_dwordx4 v127, s[40:43], s60 offen offset:3072 lds
    s_waitcnt vmcnt(16)
    s_barrier
    s_add_u32 m0, s64, 114688
    s_nop 0
    buffer_load_dwordx4 v128, s[40:43], s60 offen offset:0 lds
    buffer_load_dwordx4 v129, s[40:43], s60 offen offset:1024 lds
    s_add_u32 s59, s61, 896
    s_add_u32 m0, s63, 49152
    s_nop 0
    buffer_load_dwordx4 v107, s[36:39], s59 offen offset:0  lds
    buffer_load_dwordx4 v108, s[36:39], s59 offen offset:1024  lds
    buffer_load_dwordx4 v109, s[36:39], s59 offen offset:2048  lds
    buffer_load_dwordx4 v110, s[36:39], s59 offen offset:3072  lds
    s_add_u32 m0, s63, 53248
    s_nop 0
    buffer_load_dwordx4 v111, s[36:39], s59 offen offset:0  lds
    buffer_load_dwordx4 v112, s[36:39], s59 offen offset:1024  lds
    buffer_load_dwordx4 v113, s[36:39], s59 offen offset:2048  lds
    buffer_load_dwordx4 v114, s[36:39], s59 offen offset:3072  lds
    s_add_u32 s60, s62, 1720320
    s_add_u32 m0, s64, 126976
    s_nop 0
    buffer_load_dwordx4 v120, s[40:43], s60 offen offset:0 lds
    buffer_load_dwordx4 v121, s[40:43], s60 offen offset:1024 lds
    buffer_load_dwordx4 v122, s[40:43], s60 offen offset:2048 lds
    buffer_load_dwordx4 v123, s[40:43], s60 offen offset:3072 lds
    s_add_u32 m0, s64, 131072
    s_nop 0
    buffer_load_dwordx4 v124, s[40:43], s60 offen offset:0 lds
    buffer_load_dwordx4 v125, s[40:43], s60 offen offset:1024 lds
    buffer_load_dwordx4 v126, s[40:43], s60 offen offset:2048 lds
    buffer_load_dwordx4 v127, s[40:43], s60 offen offset:3072 lds
    s_waitcnt vmcnt(16)
    s_barrier
    s_add_u32 m0, s64, 135168
    s_nop 0
    buffer_load_dwordx4 v128, s[40:43], s60 offen offset:0 lds
    buffer_load_dwordx4 v129, s[40:43], s60 offen offset:1024 lds
    s_add_u32 s59, s61, 1024
    s_add_u32 m0, s63, 0
    s_nop 0
    buffer_load_dwordx4 v107, s[36:39], s59 offen offset:0  lds
    buffer_load_dwordx4 v108, s[36:39], s59 offen offset:1024  lds
    buffer_load_dwordx4 v109, s[36:39], s59 offen offset:2048  lds
    buffer_load_dwordx4 v110, s[36:39], s59 offen offset:3072  lds
    s_add_u32 m0, s63, 4096
    s_nop 0
    buffer_load_dwordx4 v111, s[36:39], s59 offen offset:0  lds
    buffer_load_dwordx4 v112, s[36:39], s59 offen offset:1024  lds
    buffer_load_dwordx4 v113, s[36:39], s59 offen offset:2048  lds
    buffer_load_dwordx4 v114, s[36:39], s59 offen offset:3072  lds
    s_add_u32 s60, s62, 1966080
    s_add_u32 m0, s64, 65536
    s_nop 0
    buffer_load_dwordx4 v120, s[40:43], s60 offen offset:0 lds
    buffer_load_dwordx4 v121, s[40:43], s60 offen offset:1024 lds
    buffer_load_dwordx4 v122, s[40:43], s60 offen offset:2048 lds
    buffer_load_dwordx4 v123, s[40:43], s60 offen offset:3072 lds
    s_add_u32 m0, s64, 69632
    s_nop 0
    buffer_load_dwordx4 v124, s[40:43], s60 offen offset:0 lds
    buffer_load_dwordx4 v125, s[40:43], s60 offen offset:1024 lds
    buffer_load_dwordx4 v126, s[40:43], s60 offen offset:2048 lds
    buffer_load_dwordx4 v127, s[40:43], s60 offen offset:3072 lds
    s_waitcnt vmcnt(16)
    s_barrier
    s_add_u32 m0, s64, 73728
    s_nop 0
    buffer_load_dwordx4 v128, s[40:43], s60 offen offset:0 lds
    buffer_load_dwordx4 v129, s[40:43], s60 offen offset:1024 lds
    s_add_u32 s59, s61, 1152
    s_add_u32 m0, s63, 16384
    s_nop 0
    buffer_load_dwordx4 v107, s[36:39], s59 offen offset:0  lds
    buffer_load_dwordx4 v108, s[36:39], s59 offen offset:1024  lds
    buffer_load_dwordx4 v109, s[36:39], s59 offen offset:2048  lds
    buffer_load_dwordx4 v110, s[36:39], s59 offen offset:3072  lds
    s_add_u32 m0, s63, 20480
    s_nop 0
    buffer_load_dwordx4 v111, s[36:39], s59 offen offset:0  lds
    buffer_load_dwordx4 v112, s[36:39], s59 offen offset:1024  lds
    buffer_load_dwordx4 v113, s[36:39], s59 offen offset:2048  lds
    buffer_load_dwordx4 v114, s[36:39], s59 offen offset:3072  lds
    s_add_u32 s60, s62, 2211840
    s_add_u32 m0, s64, 86016
    s_nop 0
    buffer_load_dwordx4 v120, s[40:43], s60 offen offset:0 lds
    buffer_load_dwordx4 v121, s[40:43], s60 offen offset:1024 lds
    buffer_load_dwordx4 v122, s[40:43], s60 offen offset:2048 lds
    buffer_load_dwordx4 v123, s[40:43], s60 offen offset:3072 lds
    s_add_u32 m0, s64, 90112
    s_nop 0
    buffer_load_dwordx4 v124, s[40:43], s60 offen offset:0 lds
    buffer_load_dwordx4 v125, s[40:43], s60 offen offset:1024 lds
    buffer_load_dwordx4 v126, s[40:43], s60 offen offset:2048 lds
    buffer_load_dwordx4 v127, s[40:43], s60 offen offset:3072 lds
    s_waitcnt vmcnt(16)
    s_barrier
    s_add_u32 m0, s64, 94208
    s_nop 0
    buffer_load_dwordx4 v128, s[40:43], s60 offen offset:0 lds
    buffer_load_dwordx4 v129, s[40:43], s60 offen offset:1024 lds
    s_mov_b64 s[52:53], s[18:19]
    s_mov_b32 s54, 256
    s_mov_b32 s55, 0x20000
    v_lshlrev_b32 v8, 2, v1
    v_or_b32 v8, 0, v8
    s_lshl_b32 s3, s28, 12
    buffer_load_dword v4, v8, s[52:55], s3 offen sc1
    s_mov_b64 s[36:37], s[14:15]
    s_mov_b32 s38, 2211840
    s_mov_b32 s39, 0x20000
    buffer_load_dwordx4 v[80:83], v72, s[36:39], 0 offen
    buffer_load_dwordx4 v[84:87], v73, s[36:39], 0 offen
    buffer_load_dwordx4 v[88:91], v74, s[36:39], 0 offen
    buffer_load_dwordx4 v[92:95], v75, s[36:39], 0 offen
    buffer_load_dwordx4 v[96:99], v76, s[36:39], 0 offen
    buffer_load_dwordx4 v[100:103], v77, s[36:39], 0 offen
    s_waitcnt vmcnt(7)
    s_barrier
    s_cmp_eq_u32 s28, 1
    s_cbranch_scc1 sequential_preLN__linear_attn_block__dense_activation_relu__prompt_kernel_pollok16
    s_mov_b32 s31, 0
    s_waitcnt vmcnt(6)
    s_branch sequential_preLN__linear_attn_block__dense_activation_relu__prompt_kernel_poll15_c
sequential_preLN__linear_attn_block__dense_activation_relu__prompt_kernel_poll15:
    s_waitcnt vmcnt(0)
sequential_preLN__linear_attn_block__dense_activation_relu__prompt_kernel_poll15_c:
    v_cmp_ne_u32 vcc, 1, v4
    s_add_u32 s31, s31, 1
    s_nop 3
    s_cbranch_vccz sequential_preLN__linear_attn_block__dense_activation_relu__prompt_kernel_pollok16
    s_cmp_gt_u32 s31, 0x40000
    s_cbranch_scc1 sequential_preLN__linear_attn_block__dense_activation_relu__prompt_kernel_end1
    s_sleep 8
    buffer_load_dword v4, v8, s[52:55], 0 offen sc1
    s_branch sequential_preLN__linear_attn_block__dense_activation_relu__prompt_kernel_poll15
sequential_preLN__linear_attn_block__dense_activation_relu__prompt_kernel_pollok16:
    s_add_u32 s36, s20, 16908288
    s_addc_u32 s37, s21, 0
    s_mov_b32 s38, 49152
    s_mov_b32 s39, 0x20000
    s_cmp_eq_u32 s28, 1
    s_cbranch_scc1 sequential_preLN__linear_attn_block__dense_activation_relu__prompt_kernel_std17
    s_mov_b32 m0, 147456
    s_lshl_b32 s3, s49, 10
    v_lshlrev_b32 v8, 4, v1
    buffer_load_dwordx4 v8, s[36:39], s3 offen sc1 lds
    s_movk_i32 s3, 8192
    buffer_load_dwordx4 v[56:59], v45, s[36:39], 0 offen sc1
    buffer_load_dwordx4 v[60:63], v45, s[36:39], s3 offen sc1
    s_movk_i32 s3, 16384
    buffer_load_dwordx4 v[64:67], v45, s[36:39], s3 offen sc1
    s_movk_i32 s3, 24576
    buffer_load_dwordx4 v[68:71], v45, s[36:39], s3 offen sc1
    v_add_u32 v8, 148480, v8
sequential_preLN__linear_attn_block__dense_activation_relu__prompt_kernel_std17:
    s_barrier
    s_branch sequential_preLN__linear_attn_block__dense_activation_relu__prompt_kernel_ldtail14
sequential_preLN__linear_attn_block__dense_activation_relu__prompt_kernel_ldq13:
    s_add_u32 s44, s20, 17825792
    s_addc_u32 s45, s21, 0
    s_mov_b32 s46, 737280
    s_mov_b32 s47, 0x20000
    v_mov_b32 v9, 1
    s_lshl_b32 s33, s23, 1
    s_add_u32 s33, s33, s28
    s_mul_i32 s32, s49, 6144
    s_add_u32 s32, s32, 540672
    s_lshl_b32 s3, s50, 2
    s_add_u32 s32, s32, s3
    s_and_b32 s3, s50, 3
    s_mul_i32 s3, s3, 320
    s_add_u32 s3, s3, 1280
    s_and_b32 s31, s50, 1
    s_mul_i32 s31, s31, 640
    s_cmp_eq_u32 s51, 0
    s_cselect_b32 s3, s3, s31
    s_cselect_b32 s31, 960, 0
    v_lshlrev_b32 v45, 4, v1
    v_add_u32 v45, s3, v45
    v_cmp_lt_u32 vcc, 19, v1
    v_mov_b32 v42, s31
    s_lshl_b32 s3, s25, 12
    v_cndmask_b32 v42, 0, v42, vcc
    s_add_u32 s3, s3, 16384
    v_add3_u32 v45, v45, v42, s3
    v_cmp_gt_u32 vcc, 40, v1
    v_mov_b32 v42, 2146435072
    s_nop 0
    v_cndmask_b32 v45, v42, v45, vcc
    s_movk_i32 s58, 1000
    s_mov_b32 s56, 0
    s_mov_b32 s57, 0
    s_lshl_b32 s32, s25, 3
    s_add_u32 s32, s32, s50
    s_mul_i32 s32, s32, 4224
    s_lshl_b32 s3, s24, 2
    s_add_u32 s32, s32, s3
    s_add_u32 s32, s32, 405504
    s_mov_b64 s[52:53], s[18:19]
    s_mov_b32 s54, 256
    s_mov_b32 s55, 0x20000
    s_branch sequential_preLN__linear_attn_block__dense_activation_relu__prompt_kernel_ldtail14_s
sequential_preLN__linear_attn_block__dense_activation_relu__prompt_kernel_ldtail14:
    s_cmp_eq_u32 s28, 1
    s_cbranch_scc1 sequential_preLN__linear_attn_block__dense_activation_relu__prompt_kernel_std18
    s_waitcnt vmcnt(2)
    v_pk_add_f32 v[56:57], v[56:57], v[60:61]
    v_pk_add_f32 v[58:59], v[58:59], v[62:63]
    s_waitcnt vmcnt(0)
    v_pk_add_f32 v[64:65], v[64:65], v[68:69]
    v_pk_add_f32 v[66:67], v[66:67], v[70:71]
    v_pk_add_f32 v[56:57], v[56:57], v[64:65]
    v_pk_add_f32 v[58:59], v[58:59], v[66:67]
    ds_write_b128 v8, v[56:59]
    s_waitcnt lgkmcnt(0)
sequential_preLN__linear_attn_block__dense_activation_relu__prompt_kernel_std18:
sequential_preLN__linear_attn_block__dense_activation_relu__prompt_kernel_ldtail14_s:
    s_and_b32 s59, s23, 7
    s_lshl_b32 s3, s24, 3
    s_add_u32 s59, s59, s3
    s_lshr_b32 s60, s23, 3
    s_lshl_b32 s3, s25, 2
    s_add_u32 s60, s60, s3
    s_mov_b64 s[40:41], s[8:9]
    s_mov_b32 s42, 819200
    s_mov_b32 s43, 0x20000
    s_mul_i32 s62, s60, 160
    s_movk_i32 s34, 1280
    s_mul_i32 s63, s28, 5120
    s_waitcnt vmcnt(0)
    s_barrier
    s_add_u32 s36, s20, 18874368
    s_addc_u32 s37, s21, 0
    s_mov_b32 s38, 2211840
    s_mov_b32 s39, 0x20000
    s_cmp_ge_u32 s58, 360
    s_cbranch_scc1 sequential_preLN__linear_attn_block__dense_activation_relu__prompt_kernel_rp19
    v_lshlrev_b32 v72, 4, v1
    s_add_u32 s3, s56, 4096
    buffer_store_dwordx4 v[80:83], v72, s[36:39], s56 offen offset:0 sc1
    buffer_store_dwordx4 v[84:87], v72, s[36:39], s56 offen offset:1024 sc1
    buffer_store_dwordx4 v[88:91], v72, s[36:39], s56 offen offset:2048 sc1
    buffer_store_dwordx4 v[92:95], v72, s[36:39], s56 offen offset:3072 sc1
    buffer_store_dwordx4 v[96:99], v72, s[36:39], s3 offen offset:0 sc1
    buffer_store_dwordx4 v[100:103], v72, s[36:39], s3 offen offset:1024 sc1
sequential_preLN__linear_attn_block__dense_activation_relu__prompt_kernel_rp19:
    s_add_u32 s61, s62, 0
    v_add_u32 v42, 0, v46
    v_mul_u32_u24 v43, 205, v42
    v_lshrrev_b32 v43, 10, v43
    v_mad_u32_u24 v42, v43, 15, v42
    v_mad_u32_u24 v17, v42, s34, v51
    s_add_u32 m0, s63, 40960
    s_nop 0
    buffer_load_dwordx4 v17, s[40:43], s61 offen lds
    v_add_u32 v42, 0, v47
    v_mul_u32_u24 v43, 205, v42
    v_lshrrev_b32 v43, 10, v43
    v_mad_u32_u24 v42, v43, 15, v42
    v_mad_u32_u24 v18, v42, s34, v52
    s_add_u32 m0, s63, 41984
    s_nop 0
    buffer_load_dwordx4 v18, s[40:43], s61 offen lds
    v_add_u32 v42, 0, v48
    v_mul_u32_u24 v43, 205, v42
    v_lshrrev_b32 v43, 10, v43
    v_mad_u32_u24 v42, v43, 15, v42
    v_mad_u32_u24 v19, v42, s34, v53
    s_add_u32 m0, s63, 43008
    s_nop 0
    buffer_load_dwordx4 v19, s[40:43], s61 offen lds
    v_add_u32 v42, 0, v49
    v_mul_u32_u24 v43, 205, v42
    v_lshrrev_b32 v43, 10, v43
    v_mad_u32_u24 v42, v43, 15, v42
    v_mad_u32_u24 v20, v42, s34, v54
    s_add_u32 m0, s63, 44032
    s_nop 0
    buffer_load_dwordx4 v20, s[40:43], s61 offen lds
    v_add_u32 v42, 0, v50
    v_mul_u32_u24 v43, 205, v42
    v_lshrrev_b32 v43, 10, v43
    v_mad_u32_u24 v42, v43, 15, v42
    v_mad_u32_u24 v21, v42, s34, v55
    s_add_u32 m0, s63, 45056
    s_nop 0
    buffer_load_dwordx4 v21, s[40:43], s61 offen lds
    s_add_u32 s61, s62, 409600
    s_add_u32 m0, s63, 92160
    s_nop 0
    buffer_load_dwordx4 v17, s[40:43], s61 offen lds
    s_add_u32 m0, s63, 93184
    s_nop 0
    buffer_load_dwordx4 v18, s[40:43], s61 offen lds
    s_add_u32 m0, s63, 94208
    s_nop 0
    buffer_load_dwordx4 v19, s[40:43], s61 offen lds
    s_add_u32 m0, s63, 95232
    s_nop 0
    buffer_load_dwordx4 v20, s[40:43], s61 offen lds
    s_add_u32 m0, s63, 96256
    s_nop 0
    buffer_load_dwordx4 v21, s[40:43], s61 offen lds
    s_add_u32 s61, s62, 0
    v_add_u32 v42, 16, v46
    v_mul_u32_u24 v43, 205, v42
    v_lshrrev_b32 v43, 10, v43
    v_mad_u32_u24 v42, v43, 15, v42
    v_mad_u32_u24 v22, v42, s34, v51
    s_add_u32 m0, s63, 51200
    s_nop 0
    buffer_load_dwordx4 v22, s[40:43], s61 offen lds
    v_add_u32 v42, 16, v47
    v_mul_u32_u24 v43, 205, v42
    v_lshrrev_b32 v43, 10, v43
    v_mad_u32_u24 v42, v43, 15, v42
    v_mad_u32_u24 v23, v42, s34, v52
    s_add_u32 m0, s63, 52224
    s_nop 0
    buffer_load_dwordx4 v23, s[40:43], s61 offen lds
    v_add_u32 v42, 16, v48
    v_mul_u32_u24 v43, 205, v42
    v_lshrrev_b32 v43, 10, v43
    v_mad_u32_u24 v42, v43, 15, v42
    v_mad_u32_u24 v24, v42, s34, v53
    s_add_u32 m0, s63, 53248
    s_nop 0
    buffer_load_dwordx4 v24, s[40:43], s61 offen lds
    v_add_u32 v42, 16, v49
    v_mul_u32_u24 v43, 205, v42
    v_lshrrev_b32 v43, 10, v43
    v_mad_u32_u24 v42, v43, 15, v42
    v_mad_u32_u24 v25, v42, s34, v54
    s_add_u32 m0, s63, 54272
    s_nop 0
    buffer_load_dwordx4 v25, s[40:43], s61 offen lds
    v_add_u32 v42, 16, v50
    v_mul_u32_u24 v43, 205, v42
    v_lshrrev_b32 v43, 10, v43
    v_mad_u32_u24 v42, v43, 15, v42
    v_mad_u32_u24 v26, v42, s34, v55
    s_add_u32 m0, s63, 55296
    s_nop 0
    buffer_load_dwordx4 v26, s[40:43], s61 offen lds
    s_add_u32 s61, s62, 409600
    s_add_u32 m0, s63, 102400
    s_nop 0
    buffer_load_dwordx4 v22, s[40:43], s61 offen lds
    s_add_u32 m0, s63, 103424
    s_nop 0
    buffer_load_dwordx4 v23, s[40:43], s61 offen lds
    s_add_u32 m0, s63, 104448
    s_nop 0
    buffer_load_dwordx4 v24, s[40:43], s61 offen lds
    s_add_u32 m0, s63, 105472
    s_nop 0
    buffer_load_dwordx4 v25, s[40:43], s61 offen lds
    s_add_u32 m0, s63, 106496
    s_nop 0
    buffer_load_dwordx4 v26, s[40:43], s61 offen lds
    s_add_u32 s61, s62, 0
    v_add_u32 v42, 32, v46
    v_mul_u32_u24 v43, 205, v42
    v_lshrrev_b32 v43, 10, v43
    v_mad_u32_u24 v42, v43, 15, v42
    v_mad_u32_u24 v27, v42, s34, v51
    s_add_u32 m0, s63, 61440
    s_nop 0
    buffer_load_dwordx4 v27, s[40:43], s61 offen lds
    v_add_u32 v42, 32, v47
    v_mul_u32_u24 v43, 205, v42
    v_lshrrev_b32 v43, 10, v43
    v_mad_u32_u24 v42, v43, 15, v42
    v_mad_u32_u24 v28, v42, s34, v52
    s_add_u32 m0, s63, 62464
    s_nop 0
    buffer_load_dwordx4 v28, s[40:43], s61 offen lds
    v_add_u32 v42, 32, v48
    v_mul_u32_u24 v43, 205, v42
    v_lshrrev_b32 v43, 10, v43
    v_mad_u32_u24 v42, v43, 15, v42
    v_mad_u32_u24 v29, v42, s34, v53
    s_add_u32 m0, s63, 63488
    s_nop 0
    buffer_load_dwordx4 v29, s[40:43], s61 offen lds
    v_add_u32 v42, 32, v49
    v_mul_u32_u24 v43, 205, v42
    v_lshrrev_b32 v43, 10, v43
    v_mad_u32_u24 v42, v43, 15, v42
    v_mad_u32_u24 v30, v42, s34, v54
    s_add_u32 m0, s63, 64512
    s_nop 0
    buffer_load_dwordx4 v30, s[40:43], s61 offen lds
    v_add_u32 v42, 32, v50
    v_mul_u32_u24 v43, 205, v42
    v_lshrrev_b32 v43, 10, v43
    v_mad_u32_u24 v42, v43, 15, v42
    v_mad_u32_u24 v31, v42, s34, v55
    s_add_u32 m0, s63, 65536
    s_nop 0
    buffer_load_dwordx4 v31, s[40:43], s61 offen lds
    s_add_u32 s61, s62, 409600
    s_add_u32 m0, s63, 112640
    s_nop 0
    buffer_load_dwordx4 v27, s[40:43], s61 offen lds
    s_add_u32 m0, s63, 113664
    s_nop 0
    buffer_load_dwordx4 v28, s[40:43], s61 offen lds
    s_add_u32 m0, s63, 114688
    s_nop 0
    buffer_load_dwordx4 v29, s[40:43], s61 offen lds
    s_add_u32 m0, s63, 115712
    s_nop 0
    buffer_load_dwordx4 v30, s[40:43], s61 offen lds
    s_add_u32 m0, s63, 116736
    s_nop 0
    buffer_load_dwordx4 v31, s[40:43], s61 offen lds
    s_cmp_eq_u32 s27, 0
    s_cbranch_scc1 sequential_preLN__linear_attn_block__dense_activation_relu__prompt_kernel_svp20
    v_lshlrev_b32 v8, 2, v1
    v_or_b32 v8, 0, v8
    s_cmp_eq_u32 s28, 1
    s_cbranch_scc1 sequential_preLN__linear_attn_block__dense_activation_relu__prompt_kernel_pollok22
    s_mov_b32 s31, 0
    buffer_load_dword v4, v8, s[52:55], 0 offen sc1
sequential_preLN__linear_attn_block__dense_activation_relu__prompt_kernel_poll21:
    s_waitcnt vmcnt(0)
sequential_preLN__linear_attn_block__dense_activation_relu__prompt_kernel_poll21_c:
    v_cmp_ne_u32 vcc, 1, v4
    s_add_u32 s31, s31, 1
    s_nop 3
    s_cbranch_vccz sequential_preLN__linear_attn_block__dense_activation_relu__prompt_kernel_pollok22
    s_cmp_gt_u32 s31, 0x40000
    s_cbranch_scc1 sequential_preLN__linear_attn_block__dense_activation_relu__prompt_kernel_end1
    s_sleep 8
    buffer_load_dword v4, v8, s[52:55], 0 offen sc1
    s_branch sequential_preLN__linear_attn_block__dense_activation_relu__prompt_kernel_poll21
sequential_preLN__linear_attn_block__dense_activation_relu__prompt_kernel_pollok22:
sequential_preLN__linear_attn_block__dense_activation_relu__prompt_kernel_svp20:
    s_mul_i32 s64, s25, 1792
    s_min_u32 s64, s64, 1664
    v_min_u32 v106, 55, v1
    v_mul_u32_u24 v105, 74, v106
    v_lshrrev_b32 v105, 10, v105
    v_mul_u32_u24 v104, 14, v105
    v_sub_u32 v106, v106, v104
    v_mul_u32_u24 v105, 3456, v105
    v_lshl_add_u32 v104, v106, 7, v105
    s_add_u32 s65, s33, 0
    s_mul_i32 s65, s65, 4
    s_min_u32 s65, s65, 636
    s_mul_i32 s65, s65, 3456
    s_add_u32 s65, s65, s64
    s_add_u32 s66, s12, s65
    s_addc_u32 s67, s13, 0
    global_load_dword v2, v104, s[66:67]
sequential_preLN__linear_attn_block__dense_activation_relu__prompt_kernel_tsk23:
    s_barrier
    s_getpc_b64 s[64:65]
    sequential_preLN__linear_attn_block__dense_activation_relu__prompt_kernel_pc2:
    s_lshl_b32 s3, s33, 10
    v_lshlrev_b32 v104, 7, v1
    v_add_u32 v104, s3, v104
    v_min_u32 v104, sequential_preLN__linear_attn_block__dense_activation_relu__prompt_kernel_last-sequential_preLN__linear_attn_block__dense_activation_relu__prompt_kernel_pc2, v104
    v_mov_b32 v105, s65
    v_add_co_u32 v104, vcc, s64, v104
    s_nop 1
    v_addc_co_u32 v105, vcc, 0, v105, vcc
    s_mov_b64 exec, 0xff
    global_load_dword v2, v[104:105], off
    s_mov_b64 exec, -1
    s_barrier
    s_cmp_eq_u32 s51, 0
    s_cbranch_scc1 sequential_preLN__linear_attn_block__dense_activation_relu__prompt_kernel_f1kv24
    s_cmp_eq_u32 s51, 1
    s_cselect_b32 s31, 0xffff, 1
    s_cmp_eq_u32 s28, 1
    s_cbranch_scc0 sequential_preLN__linear_attn_block__dense_activation_relu__prompt_kernel_fl26
    v_mul_u32_u24 v8, 384, v1
    v_add_u32 v8, 0, v8
    s_mov_b32 exec_hi, 0
    s_mov_b32 exec_lo, s31
    buffer_store_dword v9, v8, s[44:47], s32 offen sc1
    s_mov_b64 exec, -1
sequential_preLN__linear_attn_block__dense_activation_relu__prompt_kernel_fl26:
    s_branch sequential_preLN__linear_attn_block__dense_activation_relu__prompt_kernel_f1d25
sequential_preLN__linear_attn_block__dense_activation_relu__prompt_kernel_f1kv24:
    s_cmp_eq_u32 s28, 1
    s_cbranch_scc0 sequential_preLN__linear_attn_block__dense_activation_relu__prompt_kernel_f1d25
    v_mul_u32_u24 v8, 8448, v1
    v_add_u32 v8, 270336, v8
    s_and_b32 s3, s50, 1
    s_mul_i32 s3, s3, 4224
    s_mov_b64 exec, 0xffff
    buffer_atomic_add v9, v8, s[44:47], s3 offen sc1
    s_mov_b64 exec, -1
sequential_preLN__linear_attn_block__dense_activation_relu__prompt_kernel_f1d25:
    s_add_u32 s61, s62, 0
    v_add_u32 v42, 48, v46
    v_mul_u32_u24 v43, 205, v42
    v_lshrrev_b32 v43, 10, v43
    v_mad_u32_u24 v42, v43, 15, v42
    v_mad_u32_u24 v32, v42, s34, v51
    s_add_u32 m0, s63, 71680
    s_nop 0
    buffer_load_dwordx4 v32, s[40:43], s61 offen lds
    v_add_u32 v42, 48, v47
    v_mul_u32_u24 v43, 205, v42
    v_lshrrev_b32 v43, 10, v43
    v_mad_u32_u24 v42, v43, 15, v42
    v_mad_u32_u24 v33, v42, s34, v52
    s_add_u32 m0, s63, 72704
    s_nop 0
    buffer_load_dwordx4 v33, s[40:43], s61 offen lds
    v_add_u32 v42, 48, v48
    v_mul_u32_u24 v43, 205, v42
    v_lshrrev_b32 v43, 10, v43
    v_mad_u32_u24 v42, v43, 15, v42
    v_mad_u32_u24 v34, v42, s34, v53
    s_add_u32 m0, s63, 73728
    s_nop 0
    buffer_load_dwordx4 v34, s[40:43], s61 offen lds
    v_add_u32 v42, 48, v49
    v_mul_u32_u24 v43, 205, v42
    v_lshrrev_b32 v43, 10, v43
    v_mad_u32_u24 v42, v43, 15, v42
    v_mad_u32_u24 v35, v42, s34, v54
    s_add_u32 m0, s63, 74752
    s_nop 0
    buffer_load_dwordx4 v35, s[40:43], s61 offen lds
    v_add_u32 v42, 48, v50
    v_mul_u32_u24 v43, 205, v42
    v_lshrrev_b32 v43, 10, v43
    v_mad_u32_u24 v42, v43, 15, v42
    v_mad_u32_u24 v36, v42, s34, v55
    s_add_u32 m0, s63, 75776
    s_nop 0
    buffer_load_dwordx4 v36, s[40:43], s61 offen lds
    s_add_u32 s61, s62, 409600
    s_add_u32 m0, s63, 122880
    s_nop 0
    buffer_load_dwordx4 v32, s[40:43], s61 offen lds
    s_add_u32 m0, s63, 123904
    s_nop 0
    buffer_load_dwordx4 v33, s[40:43], s61 offen lds
    s_add_u32 m0, s63, 124928
    s_nop 0
    buffer_load_dwordx4 v34, s[40:43], s61 offen lds
    s_add_u32 m0, s63, 125952
    s_nop 0
    buffer_load_dwordx4 v35, s[40:43], s61 offen lds
    s_add_u32 m0, s63, 126976
    s_nop 0
    buffer_load_dwordx4 v36, s[40:43], s61 offen lds
    s_add_u32 s61, s62, 0
    v_add_u32 v42, 64, v46
    v_mul_u32_u24 v43, 205, v42
    v_lshrrev_b32 v43, 10, v43
    v_mad_u32_u24 v42, v43, 15, v42
    v_mad_u32_u24 v37, v42, s34, v51
    s_add_u32 m0, s63, 81920
    s_nop 0
    buffer_load_dwordx4 v37, s[40:43], s61 offen lds
    v_add_u32 v42, 64, v47
    v_mul_u32_u24 v43, 205, v42
    v_lshrrev_b32 v43, 10, v43
    v_mad_u32_u24 v42, v43, 15, v42
    v_mad_u32_u24 v38, v42, s34, v52
    s_add_u32 m0, s63, 82944
    s_nop 0
    buffer_load_dwordx4 v38, s[40:43], s61 offen lds
    v_add_u32 v42, 64, v48
    v_mul_u32_u24 v43, 205, v42
    v_lshrrev_b32 v43, 10, v43
    v_mad_u32_u24 v42, v43, 15, v42
    v_mad_u32_u24 v39, v42, s34, v53
    s_add_u32 m0, s63, 83968
    s_nop 0
    buffer_load_dwordx4 v39, s[40:43], s61 offen lds
    v_add_u32 v42, 64, v49
    v_mul_u32_u24 v43, 205, v42
    v_lshrrev_b32 v43, 10, v43
    v_mad_u32_u24 v42, v43, 15, v42
    v_mad_u32_u24 v40, v42, s34, v54
    s_add_u32 m0, s63, 84992
    s_nop 0
    buffer_load_dwordx4 v40, s[40:43], s61 offen lds
    v_add_u32 v42, 64, v50
    v_mul_u32_u24 v43, 205, v42
    v_lshrrev_b32 v43, 10, v43
    v_mad_u32_u24 v42, v43, 15, v42
    v_mad_u32_u24 v41, v42, s34, v55
    s_add_u32 m0, s63, 86016
    s_nop 0
    buffer_load_dwordx4 v41, s[40:43], s61 offen lds
    s_add_u32 s61, s62, 409600
    s_add_u32 m0, s63, 133120
    s_nop 0
    buffer_load_dwordx4 v37, s[40:43], s61 offen lds
    s_add_u32 m0, s63, 134144
    s_nop 0
    buffer_load_dwordx4 v38, s[40:43], s61 offen lds
    s_add_u32 m0, s63, 135168
    s_nop 0
    buffer_load_dwordx4 v39, s[40:43], s61 offen lds
    s_add_u32 m0, s63, 136192
    s_nop 0
    buffer_load_dwordx4 v40, s[40:43], s61 offen lds
    s_add_u32 m0, s63, 137216
    s_nop 0
    buffer_load_dwordx4 v41, s[40:43], s61 offen lds
    s_lshl_b32 s3, s59, 3
    s_add_u32 s3, s3, s60
    s_mul_i32 s3, s3, 384
    s_add_u32 s3, s3, 540672
    v_and_b32 v42, 7, v1
    v_lshlrev_b32 v42, 2, v42
    v_and_b32 v8, 12, v42
    v_add_u32 v8, s3, v8
    s_cmp_eq_u32 s28, 1
    s_cbranch_scc1 sequential_preLN__linear_attn_block__dense_activation_relu__prompt_kernel_pollok28
    s_mov_b32 s31, 0
    buffer_load_dword v4, v8, s[44:47], 0 offen sc1
sequential_preLN__linear_attn_block__dense_activation_relu__prompt_kernel_poll27:
    s_waitcnt vmcnt(0)
sequential_preLN__linear_attn_block__dense_activation_relu__prompt_kernel_poll27_c:
    v_cmp_ne_u32 vcc, 1, v4
    s_add_u32 s31, s31, 1
    s_nop 3
    s_cbranch_vccz sequential_preLN__linear_attn_block__dense_activation_relu__prompt_kernel_pollok28
    s_cmp_gt_u32 s31, 0x40000
    s_cbranch_scc1 sequential_preLN__linear_attn_block__dense_activation_relu__prompt_kernel_end1
    s_sleep 8
    buffer_load_dword v4, v8, s[44:47], 0 offen sc1
    s_branch sequential_preLN__linear_attn_block__dense_activation_relu__prompt_kernel_poll27
sequential_preLN__linear_attn_block__dense_activation_relu__prompt_kernel_pollok28:
    s_and_b32 s3, s2, 15
    s_mul_i32 s3, s3, 8448
    s_add_u32 s3, s3, 270336
    v_add_u32 v8, s3, v42
    v_and_b32 v8, 1, v1
    v_mul_u32_u24 v8, 4224, v8
    v_add_u32 v8, s3, v8
    s_cmp_eq_u32 s28, 1
    s_cbranch_scc1 sequential_preLN__linear_attn_block__dense_activation_relu__prompt_kernel_q129
    buffer_load_dword v4, v8, s[44:47], 0 offen sc1
sequential_preLN__linear_attn_block__dense_activation_relu__prompt_kernel_q129:
    s_barrier
    s_cmp_eq_u32 s28, 1
    s_cbranch_scc1 sequential_preLN__linear_attn_block__dense_activation_relu__prompt_kernel_pollok31
    s_mov_b32 s31, 0
sequential_preLN__linear_attn_block__dense_activation_relu__prompt_kernel_poll30:
    s_waitcnt vmcnt(0)
sequential_preLN__linear_attn_block__dense_activation_relu__prompt_kernel_poll30_c:
    v_cmp_ne_u32 vcc, 64, v4
    s_add_u32 s31, s31, 1
    s_nop 3
    s_cbranch_vccz sequential_preLN__linear_attn_block__dense_activation_relu__prompt_kernel_pollok31
    s_cmp_gt_u32 s31, 0x40000
    s_cbranch_scc1 sequential_preLN__linear_attn_block__dense_activation_relu__prompt_kernel_end1
    s_sleep 8
    buffer_load_dword v4, v8, s[44:47], 0 offen sc1
    s_branch sequential_preLN__linear_attn_block__dense_activation_relu__prompt_kernel_poll30
sequential_preLN__linear_attn_block__dense_activation_relu__prompt_kernel_pollok31:
    s_barrier
    s_lshr_b32 s32, s59, 1
    s_mul_i32 s32, s32, 6144
    s_and_b32 s3, s59, 1
    s_lshl_b32 s3, s3, 5
    s_add_u32 s32, s32, s3
    s_lshl_b32 s3, s60, 2
    s_add_u32 s32, s32, s3
    s_waitcnt vmcnt(0)
    s_barrier
    s_barrier
    s_cmp_ge_u32 s58, 360
    s_cbranch_scc1 sequential_preLN__linear_attn_block__dense_activation_relu__prompt_kernel_rp32
    s_mul_i32 s3, s57, 4224
    v_mov_b32 v72, 473088
    s_waitcnt vmcnt(0)
    s_mov_b64 exec, 1
    buffer_atomic_add v9, v72, s[44:47], s3 offen sc1
    s_mov_b64 exec, -1
sequential_preLN__linear_attn_block__dense_activation_relu__prompt_kernel_rp32:
    s_add_u32 s36, s20, 4190208
    s_addc_u32 s37, s21, 0
    s_mov_b32 s38, 2625536
    s_mov_b32 s39, 0x20000
    s_mul_i32 s29, s59, 81920
    s_add_u32 s29, s29, 4096
    s_add_u32 s29, s29, s62
    s_mul_i32 s3, s28, 156
    s_add_u32 s29, s29, s3
    v_mul_u32_u24 v8, 1280, v1
    s_and_b32 s49, s23, 3
    s_lshl_b32 s3, s24, 2
    s_add_u32 s49, s49, s3
    s_lshr_b32 s50, s23, 2
    s_mul_i32 s3, s25, 7
    s_add_u32 s50, s50, s3
    buffer_load_dword v2, v8, s[36:39], s29 offen sc1
    s_mul_i32 s51, s25, 1792
    s_min_u32 s51, s51, 1664
    v_min_u32 v19, 55, v1
    v_mul_u32_u24 v18, 74, v19
    v_lshrrev_b32 v18, 10, v18
    v_mul_u32_u24 v17, 14, v18
    v_sub_u32 v19, v19, v17
    v_mul_u32_u24 v18, 3456, v18
    v_lshl_add_u32 v17, v19, 7, v18
    s_add_u32 s52, s33, 64
    s_mul_i32 s52, s52, 4
    s_min_u32 s52, s52, 636
    s_mul_i32 s52, s52, 3456
    s_add_u32 s52, s52, s51
    s_add_u32 s54, s12, s52
    s_addc_u32 s55, s13, 0
    global_load_dword v2, v17, s[54:55]
sequential_preLN__linear_attn_block__dense_activation_relu__prompt_kernel_tsk34:
    s_lshl_b32 s3, s25, 3
    s_lshr_b32 s31, s23, 2
    s_add_u32 s3, s3, s31
    s_mul_i32 s3, s3, 4224
    s_add_u32 s3, s3, 405504
    v_and_b32 v8, 3, v1
    v_lshlrev_b32 v8, 2, v8
    v_add_u32 v8, s3, v8
    s_cmp_eq_u32 s28, 1
    s_cbranch_scc1 sequential_preLN__linear_attn_block__dense_activation_relu__prompt_kernel_pollok36
    s_mov_b32 s31, 0
    buffer_load_dword v4, v8, s[44:47], 0 offen sc1
sequential_preLN__linear_attn_block__dense_activation_relu__prompt_kernel_poll35:
    s_waitcnt vmcnt(0)
sequential_preLN__linear_attn_block__dense_activation_relu__prompt_kernel_poll35_c:
    v_cmp_ne_u32 vcc, 1, v4
    s_add_u32 s31, s31, 1
    s_nop 3
    s_cbranch_vccz sequential_preLN__linear_attn_block__dense_activation_relu__prompt_kernel_pollok36
    s_cmp_gt_u32 s31, 0x40000
    s_cbranch_scc1 sequential_preLN__linear_attn_block__dense_activation_relu__prompt_kernel_end1
    s_sleep 8
    buffer_load_dword v4, v8, s[44:47], 0 offen sc1
    s_branch sequential_preLN__linear_attn_block__dense_activation_relu__prompt_kernel_poll35
sequential_preLN__linear_attn_block__dense_activation_relu__prompt_kernel_pollok36:
    s_add_u32 s40, s20, 16957440
    s_addc_u32 s41, s21, 0
    s_mov_b32 s42, 32768
    s_mov_b32 s43, 0x20000
    s_lshl_b32 s3, s25, 12
    s_lshr_b32 s31, s23, 2
    s_lshl_b32 s31, s31, 9
    s_add_u32 s3, s3, s31
    s_lshl_b32 s31, s28, 20
    s_add_u32 s3, s3, s31
    v_and_b32 v8, 31, v1
    v_lshlrev_b32 v8, 4, v8
    buffer_load_dwordx4 v[20:23], v8, s[40:43], s3 offen sc1
    s_add_u32 s3, s3, 8192
    buffer_load_dwordx4 v[24:27], v8, s[40:43], s3 offen sc1
    s_add_u32 s3, s3, 8192
    buffer_load_dwordx4 v[28:31], v8, s[40:43], s3 offen sc1
    s_add_u32 s3, s3, 8192
    buffer_load_dwordx4 v[32:35], v8, s[40:43], s3 offen sc1
    s_add_u32 s3, s3, 8192
    s_mul_i32 s51, s25, 1792
    s_min_u32 s51, s51, 1664
    v_min_u32 v38, 55, v1
    v_mul_u32_u24 v37, 74, v38
    v_lshrrev_b32 v37, 10, v37
    v_mul_u32_u24 v36, 14, v37
    v_sub_u32 v38, v38, v36
    v_mul_u32_u24 v37, 3456, v37
    v_lshl_add_u32 v36, v38, 7, v37
    s_add_u32 s52, s33, 128
    s_mul_i32 s52, s52, 4
    s_min_u32 s52, s52, 636
    s_mul_i32 s52, s52, 3456
    s_add_u32 s52, s52, s51
    s_add_u32 s54, s12, s52
    s_addc_u32 s55, s13, 0
    global_load_dword v2, v36, s[54:55]
sequential_preLN__linear_attn_block__dense_activation_relu__prompt_kernel_tsk37:
    v_lshrrev_b32 v36, 3, v1
    v_and_b32 v37, 6, v36
    v_and_b32 v38, 7, v1
    v_xor_b32 v37, v37, v38
    v_lshlrev_b32 v37, 4, v37
    s_mov_b32 s51, 1280
    v_mad_u32_u24 v39, v36, s51, v37
    v_add_u32 v46, 72704, v39
    v_add_u32 v45, 63488, v39
    v_add_u32 v44, 54272, v39
    v_add_u32 v43, 45056, v39
    v_add_u32 v42, 31744, v39
    v_add_u32 v41, 22528, v39
    v_add_u32 v40, 13312, v39
    v_add_u32 v39, 4096, v39
    s_mov_b32 s52, 3456
    v_bfe_u32 v37, v1, 1, 2
    v_lshrrev_b32 v36, 4, v1
    v_xor_b32 v37, v37, v36
    v_and_b32 v38, 1, v1
    v_lshl_or_b32 v37, v37, 1, v38
    v_lshlrev_b32 v37, 4, v37
    v_lshrrev_b32 v36, 5, v1
    v_bfe_u32 v38, v1, 3, 2
    v_lshl_or_b32 v36, v36, 3, v38
    v_mad_u32_u24 v47, v36, s52, v37
    v_add_u32 v48, 4096, v47
    v_add_u32 v49, 16896, v47
    v_add_u32 v50, 57344, v47
    v_add_u32 v51, 70144, v47
    s_mul_i32 s29, s49, 163840
    s_lshl_b32 s30, s50, 8
    s_mul_i32 s51, s28, 81920
    s_add_u32 s53, s29, s51
    s_mul_i32 s51, s28, 110592
    s_add_u32 s54, s30, s51
    s_mul_i32 s55, s28, 8192
    s_mul_i32 s56, s28, 4096
    s_sub_u32 s40, s12, 4096
    s_subb_u32 s41, s13, 0
    s_mov_b32 s42, 2215936
    s_mov_b32 s43, 0x20000
    s_lshr_b32 s34, s23, 2
    s_mul_i32 s34, s34, 23
    s_lshr_b32 s34, s34, 4
    s_min_u32 s34, s34, 9
    s_barrier
    s_waitcnt vmcnt(1)
    v_pk_add_f32 v[20:21], v[20:21], v[24:25]
    v_pk_add_f32 v[28:29], v[28:29], v[32:33]
    v_pk_add_f32 v[12:13], v[20:21], v[28:29]
    v_pk_add_f32 v[22:23], v[22:23], v[26:27]
    v_pk_add_f32 v[30:31], v[30:31], v[34:35]
    v_pk_add_f32 v[14:15], v[22:23], v[30:31]
    s_cmp_eq_u32 s28, 0
    s_cbranch_scc1 sequential_preLN__linear_attn_block__dense_activation_relu__prompt_kernel_rc38
    s_mul_i32 s3, s25, 16896
    s_add_u32 s3, s3, 473088
    v_and_b32 v8, 3, v1
    v_mul_u32_u24 v8, 4224, v8
    v_add_u32 v8, s3, v8
    s_mov_b32 s31, 0
sequential_preLN__linear_attn_block__dense_activation_relu__prompt_kernel_rchk39:
    buffer_load_dword v4, v8, s[44:47], 0 offen sc1
    s_waitcnt vmcnt(0)
    v_cmp_ne_u32 vcc, 45, v4
    s_add_u32 s31, s31, 1
    s_nop 3
    s_cbranch_vccz sequential_preLN__linear_attn_block__dense_activation_relu__prompt_kernel_rok40
    s_cmp_gt_u32 s31, 0x40000
    s_cbranch_scc1 sequential_preLN__linear_attn_block__dense_activation_relu__prompt_kernel_end1
    s_sleep 16
    s_branch sequential_preLN__linear_attn_block__dense_activation_relu__prompt_kernel_rchk39
sequential_preLN__linear_attn_block__dense_activation_relu__prompt_kernel_rok40:
sequential_preLN__linear_attn_block__dense_activation_relu__prompt_kernel_rc38:
    s_barrier
    s_cmp_eq_u32 s28, 1
    s_cbranch_scc0 sequential_preLN__linear_attn_block__dense_activation_relu__prompt_kernel_fl41
    v_mul_u32_u24 v8, 384, v1
    v_add_u32 v8, 638976, v8
    s_mov_b32 exec_hi, 0
    s_mov_b32 exec_lo, 0x3fff
    buffer_store_dword v9, v8, s[44:47], s32 offen sc1
    s_mov_b64 exec, -1
sequential_preLN__linear_attn_block__dense_activation_relu__prompt_kernel_fl41:
    s_cmp_ge_u32 s23, 28
    s_cbranch_scc1 sequential_preLN__linear_attn_block__dense_activation_relu__prompt_kernel_ldidle342
    v_and_b32 v52, 31, v1
    v_lshlrev_b32 v52, 4, v52
    s_lshl_b32 s3, s28, 9
    s_add_u32 s3, s3, 148480
    v_add_u32 v52, s3, v52
    ds_write_b128 v52, v[12:15]
    s_waitcnt lgkmcnt(0)
    s_lshl_b32 s3, s49, 4
    s_add_u32 s3, s3, s50
    s_mul_i32 s3, s3, 384
    s_add_u32 s3, s3, 638976
    v_and_b32 v8, 15, v1
    v_lshlrev_b32 v8, 2, v8
    v_add_u32 v8, s3, v8
    s_add_u32 s52, s34, 0
    s_cmp_ge_u32 s52, 10
    s_cselect_b32 s3, 10, 0
    s_sub_u32 s52, s52, s3
    s_mul_i32 s52, s52, 221184
    s_add_u32 s52, s52, s54
    s_add_u32 m0, s56, 0
    s_nop 0
    buffer_load_dwordx4 v48, s[40:43], s52 offen offset:0 lds
    buffer_load_dwordx4 v49, s[40:43], s52 offen offset:1024 lds
    buffer_load_dwordx4 v50, s[40:43], s52 offen offset:2048 lds
    buffer_load_dwordx4 v51, s[40:43], s52 offen offset:3072 lds
    s_add_u32 s52, s34, 1
    s_cmp_ge_u32 s52, 10
    s_cselect_b32 s3, 10, 0
    s_sub_u32 s52, s52, s3
    s_mul_i32 s52, s52, 221184
    s_add_u32 s52, s52, s54
    s_add_u32 m0, s56, 8192
    s_nop 0
    buffer_load_dwordx4 v48, s[40:43], s52 offen offset:0 lds
    buffer_load_dwordx4 v49, s[40:43], s52 offen offset:1024 lds
    buffer_load_dwordx4 v50, s[40:43], s52 offen offset:2048 lds
    buffer_load_dwordx4 v51, s[40:43], s52 offen offset:3072 lds
    s_add_u32 s52, s34, 2
    s_cmp_ge_u32 s52, 10
    s_cselect_b32 s3, 10, 0
    s_sub_u32 s52, s52, s3
    s_mul_i32 s52, s52, 221184
    s_add_u32 s52, s52, s54
    s_add_u32 m0, s56, 16384
    s_nop 0
    buffer_load_dwordx4 v48, s[40:43], s52 offen offset:0 lds
    buffer_load_dwordx4 v49, s[40:43], s52 offen offset:1024 lds
    buffer_load_dwordx4 v50, s[40:43], s52 offen offset:2048 lds
    buffer_load_dwordx4 v51, s[40:43], s52 offen offset:3072 lds
    s_add_u32 s52, s34, 3
    s_cmp_ge_u32 s52, 10
    s_cselect_b32 s3, 10, 0
    s_sub_u32 s52, s52, s3
    s_mul_i32 s52, s52, 221184
    s_add_u32 s52, s52, s54
    s_add_u32 m0, s56, 24576
    s_nop 0
    buffer_load_dwordx4 v48, s[40:43], s52 offen offset:0 lds
    buffer_load_dwordx4 v49, s[40:43], s52 offen offset:1024 lds
    buffer_load_dwordx4 v50, s[40:43], s52 offen offset:2048 lds
    buffer_load_dwordx4 v51, s[40:43], s52 offen offset:3072 lds
    s_add_u32 s52, s34, 4
    s_cmp_ge_u32 s52, 10
    s_cselect_b32 s3, 10, 0
    s_sub_u32 s52, s52, s3
    s_mul_i32 s52, s52, 221184
    s_add_u32 s52, s52, s54
    s_add_u32 m0, s56, 32768
    s_nop 0
    buffer_load_dwordx4 v48, s[40:43], s52 offen offset:0 lds
    buffer_load_dwordx4 v49, s[40:43], s52 offen offset:1024 lds
    buffer_load_dwordx4 v50, s[40:43], s52 offen offset:2048 lds
    buffer_load_dwordx4 v51, s[40:43], s52 offen offset:3072 lds
    s_add_u32 s52, s34, 5
    s_cmp_ge_u32 s52, 10
    s_cselect_b32 s3, 10, 0
    s_sub_u32 s52, s52, s3
    s_mul_i32 s52, s52, 221184
    s_add_u32 s52, s52, s54
    s_add_u32 m0, s56, 40960
    s_nop 0
    buffer_load_dwordx4 v48, s[40:43], s52 offen offset:0 lds
    buffer_load_dwordx4 v49, s[40:43], s52 offen offset:1024 lds
    buffer_load_dwordx4 v50, s[40:43], s52 offen offset:2048 lds
    buffer_load_dwordx4 v51, s[40:43], s52 offen offset:3072 lds
    s_add_u32 s52, s34, 6
    s_cmp_ge_u32 s52, 10
    s_cselect_b32 s3, 10, 0
    s_sub_u32 s52, s52, s3
    s_mul_i32 s52, s52, 221184
    s_add_u32 s52, s52, s54
    s_add_u32 m0, s56, 49152
    s_nop 0
    buffer_load_dwordx4 v48, s[40:43], s52 offen offset:0 lds
    buffer_load_dwordx4 v49, s[40:43], s52 offen offset:1024 lds
    buffer_load_dwordx4 v50, s[40:43], s52 offen offset:2048 lds
    buffer_load_dwordx4 v51, s[40:43], s52 offen offset:3072 lds
    s_lshl_b32 s3, s28, 24
    buffer_load_dword v4, v8, s[44:47], s3 offen sc1
    s_add_u32 s52, s34, 7
    s_cmp_ge_u32 s52, 10
    s_cselect_b32 s3, 10, 0
    s_sub_u32 s52, s52, s3
    s_mul_i32 s52, s52, 221184
    s_add_u32 s52, s52, s54
    s_add_u32 m0, s56, 57344
    s_nop 0
    buffer_load_dwordx4 v48, s[40:43], s52 offen offset:0 lds
    buffer_load_dwordx4 v49, s[40:43], s52 offen offset:1024 lds
    buffer_load_dwordx4 v50, s[40:43], s52 offen offset:2048 lds
    buffer_load_dwordx4 v51, s[40:43], s52 offen offset:3072 lds
    s_add_u32 s52, s34, 8
    s_cmp_ge_u32 s52, 10
    s_cselect_b32 s3, 10, 0
    s_sub_u32 s52, s52, s3
    s_mul_i32 s52, s52, 221184
    s_add_u32 s52, s52, s54
    s_add_u32 m0, s56, 65536
    s_nop 0
    buffer_load_dwordx4 v48, s[40:43], s52 offen offset:0 lds
    buffer_load_dwordx4 v49, s[40:43], s52 offen offset:1024 lds
    buffer_load_dwordx4 v50, s[40:43], s52 offen offset:2048 lds
    buffer_load_dwordx4 v51, s[40:43], s52 offen offset:3072 lds
    s_add_u32 s52, s34, 9
    s_cmp_ge_u32 s52, 10
    s_cselect_b32 s3, 10, 0
    s_sub_u32 s52, s52, s3
    s_mul_i32 s52, s52, 221184
    s_add_u32 s52, s52, s54
    s_add_u32 m0, s56, 73728
    s_nop 0
    buffer_load_dwordx4 v48, s[40:43], s52 offen offset:0 lds
    buffer_load_dwordx4 v49, s[40:43], s52 offen offset:1024 lds
    buffer_load_dwordx4 v50, s[40:43], s52 offen offset:2048 lds
    buffer_load_dwordx4 v51, s[40:43], s52 offen offset:3072 lds
    s_cmp_eq_u32 s28, 1
    s_cbranch_scc1 sequential_preLN__linear_attn_block__dense_activation_relu__prompt_kernel_pollok44
    s_mov_b32 s31, 0
    s_waitcnt vmcnt(12)
    s_branch sequential_preLN__linear_attn_block__dense_activation_relu__prompt_kernel_poll43_c
sequential_preLN__linear_attn_block__dense_activation_relu__prompt_kernel_poll43:
    s_waitcnt vmcnt(0)
sequential_preLN__linear_attn_block__dense_activation_relu__prompt_kernel_poll43_c:
    v_cmp_ne_u32 vcc, 1, v4
    s_add_u32 s31, s31, 1
    s_nop 3
    s_cbranch_vccz sequential_preLN__linear_attn_block__dense_activation_relu__prompt_kernel_pollok44
    s_cmp_gt_u32 s31, 0x40000
    s_cbranch_scc1 sequential_preLN__linear_attn_block__dense_activation_relu__prompt_kernel_end1
    s_sleep 8
    buffer_load_dword v4, v8, s[44:47], 0 offen sc1
    s_branch sequential_preLN__linear_attn_block__dense_activation_relu__prompt_kernel_poll43
sequential_preLN__linear_attn_block__dense_activation_relu__prompt_kernel_pollok44:
    s_barrier
    s_add_u32 s51, s34, 0
    s_cmp_ge_u32 s51, 10
    s_cselect_b32 s3, 10, 0
    s_sub_u32 s51, s51, s3
    s_mul_i32 s51, s51, 128
    s_add_u32 s51, s51, s53
    s_add_u32 m0, s55, 81920
    s_nop 0
    buffer_load_dwordx4 v39, s[36:39], s51 offen offset:0 sc1 lds
    buffer_load_dwordx4 v40, s[36:39], s51 offen offset:1024 sc1 lds
    buffer_load_dwordx4 v41, s[36:39], s51 offen offset:2048 sc1 lds
    buffer_load_dwordx4 v42, s[36:39], s51 offen offset:3072 sc1 lds
    s_add_u32 m0, s55, 86016
    s_nop 0
    buffer_load_dwordx4 v43, s[36:39], s51 offen offset:0 sc1 lds
    buffer_load_dwordx4 v44, s[36:39], s51 offen offset:1024 sc1 lds
    buffer_load_dwordx4 v45, s[36:39], s51 offen offset:2048 sc1 lds
    buffer_load_dwordx4 v46, s[36:39], s51 offen offset:3072 sc1 lds
    s_add_u32 s51, s34, 1
    s_cmp_ge_u32 s51, 10
    s_cselect_b32 s3, 10, 0
    s_sub_u32 s51, s51, s3
    s_mul_i32 s51, s51, 128
    s_add_u32 s51, s51, s53
    s_add_u32 m0, s55, 98304
    s_nop 0
    buffer_load_dwordx4 v39, s[36:39], s51 offen offset:0 sc1 lds
    buffer_load_dwordx4 v40, s[36:39], s51 offen offset:1024 sc1 lds
    buffer_load_dwordx4 v41, s[36:39], s51 offen offset:2048 sc1 lds
    buffer_load_dwordx4 v42, s[36:39], s51 offen offset:3072 sc1 lds
    s_add_u32 m0, s55, 102400
    s_nop 0
    buffer_load_dwordx4 v43, s[36:39], s51 offen offset:0 sc1 lds
    buffer_load_dwordx4 v44, s[36:39], s51 offen offset:1024 sc1 lds
    buffer_load_dwordx4 v45, s[36:39], s51 offen offset:2048 sc1 lds
    buffer_load_dwordx4 v46, s[36:39], s51 offen offset:3072 sc1 lds
    s_waitcnt vmcnt(8)
    s_barrier
    s_add_u32 s51, s34, 2
    s_cmp_ge_u32 s51, 10
    s_cselect_b32 s3, 10, 0
    s_sub_u32 s51, s51, s3
    s_mul_i32 s51, s51, 128
    s_add_u32 s51, s51, s53
    s_add_u32 m0, s55, 114688
    s_nop 0
    buffer_load_dwordx4 v39, s[36:39], s51 offen offset:0 sc1 lds
    buffer_load_dwordx4 v40, s[36:39], s51 offen offset:1024 sc1 lds
    buffer_load_dwordx4 v41, s[36:39], s51 offen offset:2048 sc1 lds
    buffer_load_dwordx4 v42, s[36:39], s51 offen offset:3072 sc1 lds
    s_add_u32 m0, s55, 118784
    s_nop 0
    buffer_load_dwordx4 v43, s[36:39], s51 offen offset:0 sc1 lds
    buffer_load_dwordx4 v44, s[36:39], s51 offen offset:1024 sc1 lds
    buffer_load_dwordx4 v45, s[36:39], s51 offen offset:2048 sc1 lds
    buffer_load_dwordx4 v46, s[36:39], s51 offen offset:3072 sc1 lds
    s_add_u32 s51, s34, 3
    s_cmp_ge_u32 s51, 10
    s_cselect_b32 s3, 10, 0
    s_sub_u32 s51, s51, s3
    s_mul_i32 s51, s51, 128
    s_add_u32 s51, s51, s53
    s_add_u32 m0, s55, 131072
    s_nop 0
    buffer_load_dwordx4 v39, s[36:39], s51 offen offset:0 sc1 lds
    buffer_load_dwordx4 v40, s[36:39], s51 offen offset:1024 sc1 lds
    buffer_load_dwordx4 v41, s[36:39], s51 offen offset:2048 sc1 lds
    buffer_load_dwordx4 v42, s[36:39], s51 offen offset:3072 sc1 lds
    s_add_u32 m0, s55, 135168
    s_nop 0
    buffer_load_dwordx4 v43, s[36:39], s51 offen offset:0 sc1 lds
    buffer_load_dwordx4 v44, s[36:39], s51 offen offset:1024 sc1 lds
    buffer_load_dwordx4 v45, s[36:39], s51 offen offset:2048 sc1 lds
    buffer_load_dwordx4 v46, s[36:39], s51 offen offset:3072 sc1 lds
    s_waitcnt vmcnt(16)
    s_barrier
    s_add_u32 s51, s34, 4
    s_cmp_ge_u32 s51, 10
    s_cselect_b32 s3, 10, 0
    s_sub_u32 s51, s51, s3
    s_mul_i32 s51, s51, 128
    s_add_u32 s51, s51, s53
    s_add_u32 m0, s55, 81920
    s_nop 0
    buffer_load_dwordx4 v39, s[36:39], s51 offen offset:0 sc1 lds
    buffer_load_dwordx4 v40, s[36:39], s51 offen offset:1024 sc1 lds
    buffer_load_dwordx4 v41, s[36:39], s51 offen offset:2048 sc1 lds
    buffer_load_dwordx4 v42, s[36:39], s51 offen offset:3072 sc1 lds
    s_add_u32 m0, s55, 86016
    s_nop 0
    buffer_load_dwordx4 v43, s[36:39], s51 offen offset:0 sc1 lds
    buffer_load_dwordx4 v44, s[36:39], s51 offen offset:1024 sc1 lds
    buffer_load_dwordx4 v45, s[36:39], s51 offen offset:2048 sc1 lds
    buffer_load_dwordx4 v46, s[36:39], s51 offen offset:3072 sc1 lds
    s_waitcnt vmcnt(16)
    s_barrier
    s_add_u32 s51, s34, 5
    s_cmp_ge_u32 s51, 10
    s_cselect_b32 s3, 10, 0
    s_sub_u32 s51, s51, s3
    s_mul_i32 s51, s51, 128
    s_add_u32 s51, s51, s53
    s_add_u32 m0, s55, 98304
    s_nop 0
    buffer_load_dwordx4 v39, s[36:39], s51 offen offset:0 sc1 lds
    buffer_load_dwordx4 v40, s[36:39], s51 offen offset:1024 sc1 lds
    buffer_load_dwordx4 v41, s[36:39], s51 offen offset:2048 sc1 lds
    buffer_load_dwordx4 v42, s[36:39], s51 offen offset:3072 sc1 lds
    s_add_u32 m0, s55, 102400
    s_nop 0
    buffer_load_dwordx4 v43, s[36:39], s51 offen offset:0 sc1 lds
    buffer_load_dwordx4 v44, s[36:39], s51 offen offset:1024 sc1 lds
    buffer_load_dwordx4 v45, s[36:39], s51 offen offset:2048 sc1 lds
    buffer_load_dwordx4 v46, s[36:39], s51 offen offset:3072 sc1 lds
    s_waitcnt vmcnt(16)
    s_barrier
    s_add_u32 s51, s34, 6
    s_cmp_ge_u32 s51, 10
    s_cselect_b32 s3, 10, 0
    s_sub_u32 s51, s51, s3
    s_mul_i32 s51, s51, 128
    s_add_u32 s51, s51, s53
    s_add_u32 m0, s55, 114688
    s_nop 0
    buffer_load_dwordx4 v39, s[36:39], s51 offen offset:0 sc1 lds
    buffer_load_dwordx4 v40, s[36:39], s51 offen offset:1024 sc1 lds
    buffer_load_dwordx4 v41, s[36:39], s51 offen offset:2048 sc1 lds
    buffer_load_dwordx4 v42, s[36:39], s51 offen offset:3072 sc1 lds
    s_add_u32 m0, s55, 118784
    s_nop 0
    buffer_load_dwordx4 v43, s[36:39], s51 offen offset:0 sc1 lds
    buffer_load_dwordx4 v44, s[36:39], s51 offen offset:1024 sc1 lds
    buffer_load_dwordx4 v45, s[36:39], s51 offen offset:2048 sc1 lds
    buffer_load_dwordx4 v46, s[36:39], s51 offen offset:3072 sc1 lds
    s_waitcnt vmcnt(16)
    s_barrier
    s_add_u32 s51, s34, 7
    s_cmp_ge_u32 s51, 10
    s_cselect_b32 s3, 10, 0
    s_sub_u32 s51, s51, s3
    s_mul_i32 s51, s51, 128
    s_add_u32 s51, s51, s53
    s_add_u32 m0, s55, 131072
    s_nop 0
    buffer_load_dwordx4 v39, s[36:39], s51 offen offset:0 sc1 lds
    buffer_load_dwordx4 v40, s[36:39], s51 offen offset:1024 sc1 lds
    buffer_load_dwordx4 v41, s[36:39], s51 offen offset:2048 sc1 lds
    buffer_load_dwordx4 v42, s[36:39], s51 offen offset:3072 sc1 lds
    s_add_u32 m0, s55, 135168
    s_nop 0
    buffer_load_dwordx4 v43, s[36:39], s51 offen offset:0 sc1 lds
    buffer_load_dwordx4 v44, s[36:39], s51 offen offset:1024 sc1 lds
    buffer_load_dwordx4 v45, s[36:39], s51 offen offset:2048 sc1 lds
    buffer_load_dwordx4 v46, s[36:39], s51 offen offset:3072 sc1 lds
    s_waitcnt vmcnt(16)
    s_barrier
    s_add_u32 s51, s34, 8
    s_cmp_ge_u32 s51, 10
    s_cselect_b32 s3, 10, 0
    s_sub_u32 s51, s51, s3
    s_mul_i32 s51, s51, 128
    s_add_u32 s51, s51, s53
    s_add_u32 m0, s55, 81920
    s_nop 0
    buffer_load_dwordx4 v39, s[36:39], s51 offen offset:0 sc1 lds
    buffer_load_dwordx4 v40, s[36:39], s51 offen offset:1024 sc1 lds
    buffer_load_dwordx4 v41, s[36:39], s51 offen offset:2048 sc1 lds
    buffer_load_dwordx4 v42, s[36:39], s51 offen offset:3072 sc1 lds
    s_add_u32 m0, s55, 86016
    s_nop 0
    buffer_load_dwordx4 v43, s[36:39], s51 offen offset:0 sc1 lds
    buffer_load_dwordx4 v44, s[36:39], s51 offen offset:1024 sc1 lds
    buffer_load_dwordx4 v45, s[36:39], s51 offen offset:2048 sc1 lds
    buffer_load_dwordx4 v46, s[36:39], s51 offen offset:3072 sc1 lds
    s_waitcnt vmcnt(16)
    s_barrier
    s_add_u32 s51, s34, 9
    s_cmp_ge_u32 s51, 10
    s_cselect_b32 s3, 10, 0
    s_sub_u32 s51, s51, s3
    s_mul_i32 s51, s51, 128
    s_add_u32 s51, s51, s53
    s_add_u32 m0, s55, 98304
    s_nop 0
    buffer_load_dwordx4 v39, s[36:39], s51 offen offset:0 sc1 lds
    buffer_load_dwordx4 v40, s[36:39], s51 offen offset:1024 sc1 lds
    buffer_load_dwordx4 v41, s[36:39], s51 offen offset:2048 sc1 lds
    buffer_load_dwordx4 v42, s[36:39], s51 offen offset:3072 sc1 lds
    s_add_u32 m0, s55, 102400
    s_nop 0
    buffer_load_dwordx4 v43, s[36:39], s51 offen offset:0 sc1 lds
    buffer_load_dwordx4 v44, s[36:39], s51 offen offset:1024 sc1 lds
    buffer_load_dwordx4 v45, s[36:39], s51 offen offset:2048 sc1 lds
    buffer_load_dwordx4 v46, s[36:39], s51 offen offset:3072 sc1 lds
    s_waitcnt vmcnt(16)
    s_barrier
    s_add_u32 s52, s34, 0
    s_cmp_ge_u32 s52, 10
    s_cselect_b32 s3, 10, 0
    s_sub_u32 s52, s52, s3
    s_mul_i32 s52, s52, 221184
    s_add_u32 s52, s52, s54
    s_add_u32 s52, s52, 128
    s_add_u32 m0, s56, 0
    s_nop 0
    buffer_load_dwordx4 v48, s[40:43], s52 offen offset:0 lds
    buffer_load_dwordx4 v49, s[40:43], s52 offen offset:1024 lds
    buffer_load_dwordx4 v50, s[40:43], s52 offen offset:2048 lds
    buffer_load_dwordx4 v51, s[40:43], s52 offen offset:3072 lds
    s_add_u32 s52, s34, 1
    s_cmp_ge_u32 s52, 10
    s_cselect_b32 s3, 10, 0
    s_sub_u32 s52, s52, s3
    s_mul_i32 s52, s52, 221184
    s_add_u32 s52, s52, s54
    s_add_u32 s52, s52, 128
    s_add_u32 m0, s56, 8192
    s_nop 0
    buffer_load_dwordx4 v48, s[40:43], s52 offen offset:0 lds
    buffer_load_dwordx4 v49, s[40:43], s52 offen offset:1024 lds
    buffer_load_dwordx4 v50, s[40:43], s52 offen offset:2048 lds
    buffer_load_dwordx4 v51, s[40:43], s52 offen offset:3072 lds
    s_add_u32 s52, s34, 2
    s_cmp_ge_u32 s52, 10
    s_cselect_b32 s3, 10, 0
    s_sub_u32 s52, s52, s3
    s_mul_i32 s52, s52, 221184
    s_add_u32 s52, s52, s54
    s_add_u32 s52, s52, 128
    s_add_u32 m0, s56, 16384
    s_nop 0
    buffer_load_dwordx4 v48, s[40:43], s52 offen offset:0 lds
    buffer_load_dwordx4 v49, s[40:43], s52 offen offset:1024 lds
    buffer_load_dwordx4 v50, s[40:43], s52 offen offset:2048 lds
    buffer_load_dwordx4 v51, s[40:43], s52 offen offset:3072 lds
    s_waitcnt vmcnt(20)
    s_barrier
    s_add_u32 s52, s34, 3
    s_cmp_ge_u32 s52, 10
    s_cselect_b32 s3, 10, 0
    s_sub_u32 s52, s52, s3
    s_mul_i32 s52, s52, 221184
    s_add_u32 s52, s52, s54
    s_add_u32 s52, s52, 128
    s_add_u32 m0, s56, 24576
    s_nop 0
    buffer_load_dwordx4 v48, s[40:43], s52 offen offset:0 lds
    buffer_load_dwordx4 v49, s[40:43], s52 offen offset:1024 lds
    buffer_load_dwordx4 v50, s[40:43], s52 offen offset:2048 lds
    buffer_load_dwordx4 v51, s[40:43], s52 offen offset:3072 lds
    s_add_u32 s52, s34, 4
    s_cmp_ge_u32 s52, 10
    s_cselect_b32 s3, 10, 0
    s_sub_u32 s52, s52, s3
    s_mul_i32 s52, s52, 221184
    s_add_u32 s52, s52, s54
    s_add_u32 s52, s52, 128
    s_add_u32 m0, s56, 32768
    s_nop 0
    buffer_load_dwordx4 v48, s[40:43], s52 offen offset:0 lds
    buffer_load_dwordx4 v49, s[40:43], s52 offen offset:1024 lds
    buffer_load_dwordx4 v50, s[40:43], s52 offen offset:2048 lds
    buffer_load_dwordx4 v51, s[40:43], s52 offen offset:3072 lds
    s_add_u32 s52, s34, 5
    s_cmp_ge_u32 s52, 10
    s_cselect_b32 s3, 10, 0
    s_sub_u32 s52, s52, s3
    s_mul_i32 s52, s52, 221184
    s_add_u32 s52, s52, s54
    s_add_u32 s52, s52, 128
    s_add_u32 m0, s56, 40960
    s_nop 0
    buffer_load_dwordx4 v48, s[40:43], s52 offen offset:0 lds
    buffer_load_dwordx4 v49, s[40:43], s52 offen offset:1024 lds
    buffer_load_dwordx4 v50, s[40:43], s52 offen offset:2048 lds
    buffer_load_dwordx4 v51, s[40:43], s52 offen offset:3072 lds
    s_waitcnt vmcnt(24)
    s_barrier
    s_add_u32 s52, s34, 6
    s_cmp_ge_u32 s52, 10
    s_cselect_b32 s3, 10, 0
    s_sub_u32 s52, s52, s3
    s_mul_i32 s52, s52, 221184
    s_add_u32 s52, s52, s54
    s_add_u32 s52, s52, 128
    s_add_u32 m0, s56, 49152
    s_nop 0
    buffer_load_dwordx4 v48, s[40:43], s52 offen offset:0 lds
    buffer_load_dwordx4 v49, s[40:43], s52 offen offset:1024 lds
    buffer_load_dwordx4 v50, s[40:43], s52 offen offset:2048 lds
    buffer_load_dwordx4 v51, s[40:43], s52 offen offset:3072 lds
    s_add_u32 s52, s34, 7
    s_cmp_ge_u32 s52, 10
    s_cselect_b32 s3, 10, 0
    s_sub_u32 s52, s52, s3
    s_mul_i32 s52, s52, 221184
    s_add_u32 s52, s52, s54
    s_add_u32 s52, s52, 128
    s_add_u32 m0, s56, 57344
    s_nop 0
    buffer_load_dwordx4 v48, s[40:43], s52 offen offset:0 lds
    buffer_load_dwordx4 v49, s[40:43], s52 offen offset:1024 lds
    buffer_load_dwordx4 v50, s[40:43], s52 offen offset:2048 lds
    buffer_load_dwordx4 v51, s[40:43], s52 offen offset:3072 lds
    s_barrier
    s_add_u32 s52, s34, 8
    s_cmp_ge_u32 s52, 10
    s_cselect_b32 s3, 10, 0
    s_sub_u32 s52, s52, s3
    s_mul_i32 s52, s52, 221184
    s_add_u32 s52, s52, s54
    s_add_u32 s52, s52, 128
    s_add_u32 m0, s56, 65536
    s_nop 0
    buffer_load_dwordx4 v48, s[40:43], s52 offen offset:0 lds
    buffer_load_dwordx4 v49, s[40:43], s52 offen offset:1024 lds
    buffer_load_dwordx4 v50, s[40:43], s52 offen offset:2048 lds
    buffer_load_dwordx4 v51, s[40:43], s52 offen offset:3072 lds
    s_barrier
    s_add_u32 s52, s34, 9
    s_cmp_ge_u32 s52, 10
    s_cselect_b32 s3, 10, 0
    s_sub_u32 s52, s52, s3
    s_mul_i32 s52, s52, 221184
    s_add_u32 s52, s52, s54
    s_add_u32 s52, s52, 128
    s_add_u32 m0, s56, 73728
    s_nop 0
    buffer_load_dwordx4 v48, s[40:43], s52 offen offset:0 lds
    buffer_load_dwordx4 v49, s[40:43], s52 offen offset:1024 lds
    buffer_load_dwordx4 v50, s[40:43], s52 offen offset:2048 lds
    buffer_load_dwordx4 v51, s[40:43], s52 offen offset:3072 lds
    s_mul_i32 s32, s49, 6144
    s_lshl_b32 s3, s50, 2
    s_add_u32 s32, s32, s3
    s_add_u32 s32, s32, 540688
    s_mov_b32 s48, 1
    s_waitcnt vmcnt(20)
    s_barrier
    s_branch sequential_preLN__linear_attn_block__dense_activation_relu__prompt_kernel_ldskip333
sequential_preLN__linear_attn_block__dense_activation_relu__prompt_kernel_ldidle342:
    s_mov_b32 s48, 0
    s_lshl_b32 s49, s25, 2
    s_add_u32 s49, s49, s23
    s_sub_u32 s49, s49, 28
    s_mul_i32 s49, s49, 276480
    s_add_u32 s49, s49, 18874368
    v_min_u32 v19, 63, v1
    v_mul_u32_u24 v18, 64, v19
    v_lshrrev_b32 v18, 10, v18
    v_mul_u32_u24 v17, 16, v18
    v_sub_u32 v19, v19, v17
    v_mul_u32_u24 v18, 2048, v18
    v_lshl_add_u32 v17, v19, 7, v18
    s_add_u32 s50, s28, 0
    s_mul_i32 s50, s50, 4
    s_min_u32 s50, s50, 131
    s_mul_i32 s50, s50, 2048
    s_add_u32 s50, s50, s49
    s_add_u32 s52, s20, s50
    s_addc_u32 s53, s21, 0
    global_load_dword v2, v17, s[52:53]
sequential_preLN__linear_attn_block__dense_activation_relu__prompt_kernel_tsk45:
    s_add_u32 s50, s28, 2
    s_mul_i32 s50, s50, 4
    s_min_u32 s50, s50, 131
    s_mul_i32 s50, s50, 2048
    s_add_u32 s50, s50, s49
    s_add_u32 s52, s20, s50
    s_addc_u32 s53, s21, 0
    global_load_dword v2, v17, s[52:53]
sequential_preLN__linear_attn_block__dense_activation_relu__prompt_kernel_tsk46:
    s_add_u32 s50, s28, 4
    s_mul_i32 s50, s50, 4
    s_min_u32 s50, s50, 131
    s_mul_i32 s50, s50, 2048
    s_add_u32 s50, s50, s49
    s_add_u32 s52, s20, s50
    s_addc_u32 s53, s21, 0
    global_load_dword v2, v17, s[52:53]
sequential_preLN__linear_attn_block__dense_activation_relu__prompt_kernel_tsk47:
    s_add_u32 s50, s28, 6
    s_mul_i32 s50, s50, 4
    s_min_u32 s50, s50, 131
    s_mul_i32 s50, s50, 2048
    s_add_u32 s50, s50, s49
    s_add_u32 s52, s20, s50
    s_addc_u32 s53, s21, 0
    global_load_dword v2, v17, s[52:53]
sequential_preLN__linear_attn_block__dense_activation_relu__prompt_kernel_tsk48:
    s_add_u32 s50, s28, 8
    s_mul_i32 s50, s50, 4
    s_min_u32 s50, s50, 131
    s_mul_i32 s50, s50, 2048
    s_add_u32 s50, s50, s49
    s_add_u32 s52, s20, s50
    s_addc_u32 s53, s21, 0
    global_load_dword v2, v17, s[52:53]
sequential_preLN__linear_attn_block__dense_activation_relu__prompt_kernel_tsk49:
    s_add_u32 s50, s28, 10
    s_mul_i32 s50, s50, 4
    s_min_u32 s50, s50, 131
    s_mul_i32 s50, s50, 2048
    s_add_u32 s50, s50, s49
    s_add_u32 s52, s20, s50
    s_addc_u32 s53, s21, 0
    global_load_dword v2, v17, s[52:53]
sequential_preLN__linear_attn_block__dense_activation_relu__prompt_kernel_tsk50:
    s_add_u32 s50, s28, 12
    s_mul_i32 s50, s50, 4
    s_min_u32 s50, s50, 131
    s_mul_i32 s50, s50, 2048
    s_add_u32 s50, s50, s49
    s_add_u32 s52, s20, s50
    s_addc_u32 s53, s21, 0
    global_load_dword v2, v17, s[52:53]
sequential_preLN__linear_attn_block__dense_activation_relu__prompt_kernel_tsk51:
    s_add_u32 s50, s28, 14
    s_mul_i32 s50, s50, 4
    s_min_u32 s50, s50, 131
    s_mul_i32 s50, s50, 2048
    s_add_u32 s50, s50, s49
    s_add_u32 s52, s20, s50
    s_addc_u32 s53, s21, 0
    global_load_dword v2, v17, s[52:53]
sequential_preLN__linear_attn_block__dense_activation_relu__prompt_kernel_tsk52:
    s_add_u32 s50, s28, 16
    s_mul_i32 s50, s50, 4
    s_min_u32 s50, s50, 131
    s_mul_i32 s50, s50, 2048
    s_add_u32 s50, s50, s49
    s_add_u32 s52, s20, s50
    s_addc_u32 s53, s21, 0
    global_load_dword v2, v17, s[52:53]
sequential_preLN__linear_attn_block__dense_activation_relu__prompt_kernel_tsk53:
    s_add_u32 s50, s28, 18
    s_mul_i32 s50, s50, 4
    s_min_u32 s50, s50, 131
    s_mul_i32 s50, s50, 2048
    s_add_u32 s50, s50, s49
    s_add_u32 s52, s20, s50
    s_addc_u32 s53, s21, 0
    global_load_dword v2, v17, s[52:53]
sequential_preLN__linear_attn_block__dense_activation_relu__prompt_kernel_tsk54:
    s_add_u32 s50, s28, 20
    s_mul_i32 s50, s50, 4
    s_min_u32 s50, s50, 131
    s_mul_i32 s50, s50, 2048
    s_add_u32 s50, s50, s49
    s_add_u32 s52, s20, s50
    s_addc_u32 s53, s21, 0
    global_load_dword v2, v17, s[52:53]
sequential_preLN__linear_attn_block__dense_activation_relu__prompt_kernel_tsk55:
    s_add_u32 s50, s28, 22
    s_mul_i32 s50, s50, 4
    s_min_u32 s50, s50, 131
    s_mul_i32 s50, s50, 2048
    s_add_u32 s50, s50, s49
    s_add_u32 s52, s20, s50
    s_addc_u32 s53, s21, 0
    global_load_dword v2, v17, s[52:53]
sequential_preLN__linear_attn_block__dense_activation_relu__prompt_kernel_tsk56:
    s_add_u32 s50, s28, 24
    s_mul_i32 s50, s50, 4
    s_min_u32 s50, s50, 131
    s_mul_i32 s50, s50, 2048
    s_add_u32 s50, s50, s49
    s_add_u32 s52, s20, s50
    s_addc_u32 s53, s21, 0
    global_load_dword v2, v17, s[52:53]
sequential_preLN__linear_attn_block__dense_activation_relu__prompt_kernel_tsk57:
    s_add_u32 s50, s28, 26
    s_mul_i32 s50, s50, 4
    s_min_u32 s50, s50, 131
    s_mul_i32 s50, s50, 2048
    s_add_u32 s50, s50, s49
    s_add_u32 s52, s20, s50
    s_addc_u32 s53, s21, 0
    global_load_dword v2, v17, s[52:53]
sequential_preLN__linear_attn_block__dense_activation_relu__prompt_kernel_tsk58:
    s_add_u32 s50, s28, 28
    s_mul_i32 s50, s50, 4
    s_min_u32 s50, s50, 131
    s_mul_i32 s50, s50, 2048
    s_add_u32 s50, s50, s49
    s_add_u32 s52, s20, s50
    s_addc_u32 s53, s21, 0
    global_load_dword v2, v17, s[52:53]
sequential_preLN__linear_attn_block__dense_activation_relu__prompt_kernel_tsk59:
    s_add_u32 s50, s28, 30
    s_mul_i32 s50, s50, 4
    s_min_u32 s50, s50, 131
    s_mul_i32 s50, s50, 2048
    s_add_u32 s50, s50, s49
    s_add_u32 s52, s20, s50
    s_addc_u32 s53, s21, 0
    global_load_dword v2, v17, s[52:53]
sequential_preLN__linear_attn_block__dense_activation_relu__prompt_kernel_tsk60:
    s_add_u32 s50, s28, 32
    s_mul_i32 s50, s50, 4
    s_min_u32 s50, s50, 131
    s_mul_i32 s50, s50, 2048
    s_add_u32 s50, s50, s49
    s_add_u32 s52, s20, s50
    s_addc_u32 s53, s21, 0
    global_load_dword v2, v17, s[52:53]
sequential_preLN__linear_attn_block__dense_activation_relu__prompt_kernel_tsk61:
sequential_preLN__linear_attn_block__dense_activation_relu__prompt_kernel_ldskip333:
    s_and_b32 s49, s23, 7
    s_lshl_b32 s3, s24, 3
    s_add_u32 s49, s49, s3
    s_lshr_b32 s50, s23, 3
    s_lshl_b32 s3, s25, 2
    s_add_u32 s50, s50, s3
    v_lshrrev_b32 v17, 3, v1
    v_and_b32 v18, 6, v17
    v_and_b32 v19, 7, v1
    v_xor_b32 v18, v18, v19
    v_lshlrev_b32 v18, 4, v18
    s_mov_b32 s51, 3456
    v_mad_u32_u24 v20, v17, s51, v18
    v_add_u32 v23, 83968, v20
    v_add_u32 v22, 57344, v20
    v_add_u32 v21, 30720, v20
    v_add_u32 v20, 4096, v20
    s_mov_b32 s52, 160
    v_lshlrev_b32 v24, 4, v1
    s_mul_i32 s29, s49, 221184
    s_mul_i32 s30, s50, 276480
    s_mul_i32 s51, s28, 110592
    s_add_u32 s53, s29, s51
    s_mul_i32 s51, s28, 5120
    s_add_u32 s54, s30, s51
    s_mul_i32 s55, s28, 4096
    s_mul_i32 s56, s28, 5120
    s_add_u32 s36, s20, 8384512
    s_addc_u32 s37, s21, 0
    s_mov_b32 s38, 7081984
    s_mov_b32 s39, 0x20000
    s_add_u32 s40, s20, 18874368
    s_addc_u32 s41, s21, 0
    s_mov_b32 s42, 2211840
    s_mov_b32 s43, 0x20000
    s_lshr_b32 s34, s23, 3
    s_mul_i32 s34, s34, 7
    s_lshr_b32 s34, s34, 1
    s_add_u32 m0, s56, 81920
    s_add_u32 s52, s54, 0
    buffer_load_dwordx4 v24, s[40:43], s52 offen offset:0 sc1 lds
    buffer_load_dwordx4 v24, s[40:43], s52 offen offset:1024 sc1 lds
    buffer_load_dwordx4 v24, s[40:43], s52 offen offset:2048 sc1 lds
    buffer_load_dwordx4 v24, s[40:43], s52 offen offset:3072 sc1 lds
    s_add_u32 m0, s56, 86016
    s_add_u32 s52, s54, 4096
    buffer_load_dwordx4 v24, s[40:43], s52 offen offset:0 sc1 lds
    s_add_u32 m0, s56, 92160
    s_add_u32 s52, s54, 20480
    buffer_load_dwordx4 v24, s[40:43], s52 offen offset:0 sc1 lds
    buffer_load_dwordx4 v24, s[40:43], s52 offen offset:1024 sc1 lds
    buffer_load_dwordx4 v24, s[40:43], s52 offen offset:2048 sc1 lds
    buffer_load_dwordx4 v24, s[40:43], s52 offen offset:3072 sc1 lds
    s_add_u32 m0, s56, 96256
    s_add_u32 s52, s54, 24576
    buffer_load_dwordx4 v24, s[40:43], s52 offen offset:0 sc1 lds
    s_cmp_eq_u32 s48, 0
    s_cbranch_scc1 sequential_preLN__linear_attn_block__dense_activation_relu__prompt_kernel_ldno363
    s_waitcnt vmcnt(10)
    s_barrier
    s_cmp_eq_u32 s28, 1
    s_cbranch_scc0 sequential_preLN__linear_attn_block__dense_activation_relu__prompt_kernel_fl65
    v_mul_u32_u24 v8, 384, v1
    v_add_u32 v8, 0, v8
    s_mov_b32 exec_hi, 0
    s_mov_b32 exec_lo, 0xffff
    buffer_store_dword v9, v8, s[44:47], s32 offen sc1
    s_mov_b64 exec, -1
sequential_preLN__linear_attn_block__dense_activation_relu__prompt_kernel_fl65:
sequential_preLN__linear_attn_block__dense_activation_relu__prompt_kernel_ldno363:
    s_add_u32 m0, s56, 102400
    s_add_u32 s52, s54, 40960
    buffer_load_dwordx4 v24, s[40:43], s52 offen offset:0 sc1 lds
    buffer_load_dwordx4 v24, s[40:43], s52 offen offset:1024 sc1 lds
    buffer_load_dwordx4 v24, s[40:43], s52 offen offset:2048 sc1 lds
    buffer_load_dwordx4 v24, s[40:43], s52 offen offset:3072 sc1 lds
    s_add_u32 m0, s56, 106496
    s_add_u32 s52, s54, 45056
    buffer_load_dwordx4 v24, s[40:43], s52 offen offset:0 sc1 lds
    s_add_u32 m0, s56, 112640
    s_add_u32 s52, s54, 61440
    buffer_load_dwordx4 v24, s[40:43], s52 offen offset:0 sc1 lds
    buffer_load_dwordx4 v24, s[40:43], s52 offen offset:1024 sc1 lds
    buffer_load_dwordx4 v24, s[40:43], s52 offen offset:2048 sc1 lds
    buffer_load_dwordx4 v24, s[40:43], s52 offen offset:3072 sc1 lds
    s_add_u32 m0, s56, 116736
    s_add_u32 s52, s54, 65536
    buffer_load_dwordx4 v24, s[40:43], s52 offen offset:0 sc1 lds
    s_add_u32 m0, s56, 122880
    s_add_u32 s52, s54, 81920
    buffer_load_dwordx4 v24, s[40:43], s52 offen offset:0 sc1 lds
    buffer_load_dwordx4 v24, s[40:43], s52 offen offset:1024 sc1 lds
    buffer_load_dwordx4 v24, s[40:43], s52 offen offset:2048 sc1 lds
    buffer_load_dwordx4 v24, s[40:43], s52 offen offset:3072 sc1 lds
    s_add_u32 m0, s56, 126976
    s_add_u32 s52, s54, 86016
    buffer_load_dwordx4 v24, s[40:43], s52 offen offset:0 sc1 lds
    s_add_u32 m0, s56, 133120
    s_add_u32 s52, s54, 102400
    buffer_load_dwordx4 v24, s[40:43], s52 offen offset:0 sc1 lds
    buffer_load_dwordx4 v24, s[40:43], s52 offen offset:1024 sc1 lds
    buffer_load_dwordx4 v24, s[40:43], s52 offen offset:2048 sc1 lds
    buffer_load_dwordx4 v24, s[40:43], s52 offen offset:3072 sc1 lds
    s_add_u32 m0, s56, 137216
    s_add_u32 s52, s54, 106496
    buffer_load_dwordx4 v24, s[40:43], s52 offen offset:0 sc1 lds
    s_cmp_eq_u32 s48, 0
    s_cbranch_scc1 sequential_preLN__linear_attn_block__dense_activation_relu__prompt_kernel_ldno464
    s_barrier
sequential_preLN__linear_attn_block__dense_activation_relu__prompt_kernel_ldno464:
    s_lshl_b32 s3, s49, 3
    s_add_u32 s3, s3, s50
    s_mul_i32 s3, s3, 384
    s_add_u32 s3, s3, 540688
    v_and_b32 v8, 15, v1
    v_min_u32 v16, 12, v8
    v_min_u32 v8, 13, v8
    v_lshlrev_b32 v8, 2, v8
    v_add_u32 v8, s3, v8
    v_lshlrev_b32 v16, 2, v16
    v_add_u32 v16, s3, v16
    v_add_u32 v16, 56, v16
    s_mov_b32 s31, 0
    buffer_load_dword v4, v8, s[44:47], 0 offen sc1
sequential_preLN__linear_attn_block__dense_activation_relu__prompt_kernel_poll66:
    s_waitcnt vmcnt(0)
sequential_preLN__linear_attn_block__dense_activation_relu__prompt_kernel_poll66_c:
    v_cmp_ne_u32 vcc, 1, v4
    s_add_u32 s31, s31, 1
    s_nop 3
    s_cbranch_vccz sequential_preLN__linear_attn_block__dense_activation_relu__prompt_kernel_pollok67
    s_cmp_gt_u32 s31, 0x40000
    s_cbranch_scc1 sequential_preLN__linear_attn_block__dense_activation_relu__prompt_kernel_end1
    s_sleep 8
    buffer_load_dword v4, v8, s[44:47], 0 offen sc1
    s_branch sequential_preLN__linear_attn_block__dense_activation_relu__prompt_kernel_poll66
sequential_preLN__linear_attn_block__dense_activation_relu__prompt_kernel_pollok67:
    s_add_u32 s51, s53, 0
    s_add_u32 m0, s55, 0
    s_nop 0
    buffer_load_dwordx4 v20, s[36:39], s51 offen offset:0 sc1 lds
    buffer_load_dwordx4 v21, s[36:39], s51 offen offset:1024 sc1 lds
    buffer_load_dwordx4 v22, s[36:39], s51 offen offset:2048 sc1 lds
    buffer_load_dwordx4 v23, s[36:39], s51 offen offset:3072 sc1 lds
    s_add_u32 s51, s53, 256
    s_add_u32 m0, s55, 8192
    s_nop 0
    buffer_load_dwordx4 v20, s[36:39], s51 offen offset:0 sc1 lds
    buffer_load_dwordx4 v21, s[36:39], s51 offen offset:1024 sc1 lds
    buffer_load_dwordx4 v22, s[36:39], s51 offen offset:2048 sc1 lds
    buffer_load_dwordx4 v23, s[36:39], s51 offen offset:3072 sc1 lds
    s_add_u32 s51, s53, 512
    s_add_u32 m0, s55, 16384
    s_nop 0
    buffer_load_dwordx4 v20, s[36:39], s51 offen offset:0 sc1 lds
    buffer_load_dwordx4 v21, s[36:39], s51 offen offset:1024 sc1 lds
    buffer_load_dwordx4 v22, s[36:39], s51 offen offset:2048 sc1 lds
    buffer_load_dwordx4 v23, s[36:39], s51 offen offset:3072 sc1 lds
    s_add_u32 s51, s53, 768
    s_add_u32 m0, s55, 24576
    s_nop 0
    buffer_load_dwordx4 v20, s[36:39], s51 offen offset:0 sc1 lds
    buffer_load_dwordx4 v21, s[36:39], s51 offen offset:1024 sc1 lds
    buffer_load_dwordx4 v22, s[36:39], s51 offen offset:2048 sc1 lds
    buffer_load_dwordx4 v23, s[36:39], s51 offen offset:3072 sc1 lds
    s_add_u32 s51, s53, 1024
    s_add_u32 m0, s55, 32768
    s_nop 0
    buffer_load_dwordx4 v20, s[36:39], s51 offen offset:0 sc1 lds
    buffer_load_dwordx4 v21, s[36:39], s51 offen offset:1024 sc1 lds
    buffer_load_dwordx4 v22, s[36:39], s51 offen offset:2048 sc1 lds
    buffer_load_dwordx4 v23, s[36:39], s51 offen offset:3072 sc1 lds
    s_add_u32 s51, s53, 1280
    s_add_u32 m0, s55, 40960
    s_nop 0
    buffer_load_dwordx4 v20, s[36:39], s51 offen offset:0 sc1 lds
    buffer_load_dwordx4 v21, s[36:39], s51 offen offset:1024 sc1 lds
    buffer_load_dwordx4 v22, s[36:39], s51 offen offset:2048 sc1 lds
    buffer_load_dwordx4 v23, s[36:39], s51 offen offset:3072 sc1 lds
    s_waitcnt vmcnt(20)
    s_barrier
    s_add_u32 m0, s56, 143360
    s_add_u32 s52, s54, 122880
    buffer_load_dwordx4 v24, s[40:43], s52 offen offset:0 sc1 lds
    buffer_load_dwordx4 v24, s[40:43], s52 offen offset:1024 sc1 lds
    buffer_load_dwordx4 v24, s[40:43], s52 offen offset:2048 sc1 lds
    buffer_load_dwordx4 v24, s[40:43], s52 offen offset:3072 sc1 lds
    s_add_u32 m0, s56, 147456
    s_add_u32 s52, s54, 126976
    buffer_load_dwordx4 v24, s[40:43], s52 offen offset:0 sc1 lds
    s_waitcnt vmcnt(21)
    s_barrier
    s_and_b32 s3, s48, s28
    s_cmp_eq_u32 s3, 1
    s_cselect_b32 s3, 56, 2146435072
    v_mul_u32_u24 v8, 384, v1
    v_add_u32 v8, s3, v8
    s_mov_b64 exec, 0xffff
    buffer_store_dword v9, v8, s[44:47], s32 offen sc1
    s_mov_b64 exec, -1
    s_add_u32 m0, s56, 153600
    s_add_u32 s52, s54, 143360
    buffer_load_dwordx4 v24, s[40:43], s52 offen offset:0 sc1 lds
    buffer_load_dwordx4 v24, s[40:43], s52 offen offset:1024 sc1 lds
    buffer_load_dwordx4 v24, s[40:43], s52 offen offset:2048 sc1 lds
    buffer_load_dwordx4 v24, s[40:43], s52 offen offset:3072 sc1 lds
    s_add_u32 m0, s56, 157696
    s_add_u32 s52, s54, 147456
    buffer_load_dwordx4 v24, s[40:43], s52 offen offset:0 sc1 lds
    s_waitcnt vmcnt(23)
    s_barrier
    s_add_u32 m0, s56, 81920
    s_add_u32 s52, s54, 163840
    buffer_load_dwordx4 v24, s[40:43], s52 offen offset:0 sc1 lds
    buffer_load_dwordx4 v24, s[40:43], s52 offen offset:1024 sc1 lds
    buffer_load_dwordx4 v24, s[40:43], s52 offen offset:2048 sc1 lds
    buffer_load_dwordx4 v24, s[40:43], s52 offen offset:3072 sc1 lds
    s_add_u32 m0, s56, 86016
    s_add_u32 s52, s54, 167936
    buffer_load_dwordx4 v24, s[40:43], s52 offen offset:0 sc1 lds
    s_waitcnt vmcnt(24)
    s_barrier
    s_add_u32 m0, s56, 92160
    s_add_u32 s52, s54, 184320
    buffer_load_dwordx4 v24, s[40:43], s52 offen offset:0 sc1 lds
    buffer_load_dwordx4 v24, s[40:43], s52 offen offset:1024 sc1 lds
    buffer_load_dwordx4 v24, s[40:43], s52 offen offset:2048 sc1 lds
    buffer_load_dwordx4 v24, s[40:43], s52 offen offset:3072 sc1 lds
    s_add_u32 m0, s56, 96256
    s_add_u32 s52, s54, 188416
    buffer_load_dwordx4 v24, s[40:43], s52 offen offset:0 sc1 lds
    s_waitcnt vmcnt(25)
    s_barrier
    s_add_u32 s51, s53, 1536
    s_add_u32 m0, s55, 49152
    s_nop 0
    buffer_load_dwordx4 v20, s[36:39], s51 offen offset:0 sc1 lds
    buffer_load_dwordx4 v21, s[36:39], s51 offen offset:1024 sc1 lds
    buffer_load_dwordx4 v22, s[36:39], s51 offen offset:2048 sc1 lds
    buffer_load_dwordx4 v23, s[36:39], s51 offen offset:3072 sc1 lds
    s_waitcnt vmcnt(25)
    s_barrier
    s_add_u32 m0, s56, 102400
    s_add_u32 s52, s54, 204800
    buffer_load_dwordx4 v24, s[40:43], s52 offen offset:0 sc1 lds
    buffer_load_dwordx4 v24, s[40:43], s52 offen offset:1024 sc1 lds
    buffer_load_dwordx4 v24, s[40:43], s52 offen offset:2048 sc1 lds
    buffer_load_dwordx4 v24, s[40:43], s52 offen offset:3072 sc1 lds
    s_add_u32 m0, s56, 106496
    s_add_u32 s52, s54, 208896
    buffer_load_dwordx4 v24, s[40:43], s52 offen offset:0 sc1 lds
    s_add_u32 s51, s53, 1792
    s_add_u32 m0, s55, 57344
    s_nop 0
    buffer_load_dwordx4 v20, s[36:39], s51 offen offset:0 sc1 lds
    buffer_load_dwordx4 v21, s[36:39], s51 offen offset:1024 sc1 lds
    buffer_load_dwordx4 v22, s[36:39], s51 offen offset:2048 sc1 lds
    buffer_load_dwordx4 v23, s[36:39], s51 offen offset:3072 sc1 lds
    s_add_u32 m0, s56, 112640
    s_add_u32 s52, s54, 225280
    buffer_load_dwordx4 v24, s[40:43], s52 offen offset:0 sc1 lds
    buffer_load_dwordx4 v24, s[40:43], s52 offen offset:1024 sc1 lds
    buffer_load_dwordx4 v24, s[40:43], s52 offen offset:2048 sc1 lds
    buffer_load_dwordx4 v24, s[40:43], s52 offen offset:3072 sc1 lds
    s_add_u32 m0, s56, 116736
    s_add_u32 s52, s54, 229376
    buffer_load_dwordx4 v24, s[40:43], s52 offen offset:0 sc1 lds
    s_add_u32 s51, s53, 2048
    s_add_u32 m0, s55, 65536
    s_nop 0
    buffer_load_dwordx4 v20, s[36:39], s51 offen offset:0 sc1 lds
    buffer_load_dwordx4 v21, s[36:39], s51 offen offset:1024 sc1 lds
    buffer_load_dwordx4 v22, s[36:39], s51 offen offset:2048 sc1 lds
    buffer_load_dwordx4 v23, s[36:39], s51 offen offset:3072 sc1 lds
    s_waitcnt vmcnt(18)
    s_barrier
    s_add_u32 m0, s56, 122880
    s_add_u32 s52, s54, 245760
    buffer_load_dwordx4 v24, s[40:43], s52 offen offset:0 sc1 lds
    buffer_load_dwordx4 v24, s[40:43], s52 offen offset:1024 sc1 lds
    buffer_load_dwordx4 v24, s[40:43], s52 offen offset:2048 sc1 lds
    buffer_load_dwordx4 v24, s[40:43], s52 offen offset:3072 sc1 lds
    s_add_u32 m0, s56, 126976
    s_add_u32 s52, s54, 249856
    buffer_load_dwordx4 v24, s[40:43], s52 offen offset:0 sc1 lds
    s_add_u32 s51, s53, 2304
    s_add_u32 m0, s55, 73728
    s_nop 0
    buffer_load_dwordx4 v20, s[36:39], s51 offen offset:0 sc1 lds
    buffer_load_dwordx4 v21, s[36:39], s51 offen offset:1024 sc1 lds
    buffer_load_dwordx4 v22, s[36:39], s51 offen offset:2048 sc1 lds
    buffer_load_dwordx4 v23, s[36:39], s51 offen offset:3072 sc1 lds
    s_waitcnt vmcnt(18)
    s_barrier
    s_add_u32 m0, s56, 133120
    s_add_u32 s52, s54, 266240
    buffer_load_dwordx4 v24, s[40:43], s52 offen offset:0 sc1 lds
    buffer_load_dwordx4 v24, s[40:43], s52 offen offset:1024 sc1 lds
    buffer_load_dwordx4 v24, s[40:43], s52 offen offset:2048 sc1 lds
    buffer_load_dwordx4 v24, s[40:43], s52 offen offset:3072 sc1 lds
    s_add_u32 m0, s56, 137216
    s_add_u32 s52, s54, 270336
    buffer_load_dwordx4 v24, s[40:43], s52 offen offset:0 sc1 lds
    s_add_u32 s51, s53, 2560
    s_add_u32 m0, s55, 0
    s_nop 0
    buffer_load_dwordx4 v20, s[36:39], s51 offen offset:0 sc1 lds
    buffer_load_dwordx4 v21, s[36:39], s51 offen offset:1024 sc1 lds
    buffer_load_dwordx4 v22, s[36:39], s51 offen offset:2048 sc1 lds
    buffer_load_dwordx4 v23, s[36:39], s51 offen offset:3072 sc1 lds
    s_waitcnt vmcnt(18)
    s_barrier
    s_add_u32 m0, s56, 143360
    s_add_u32 s52, s54, 10240
    buffer_load_dwordx4 v24, s[40:43], s52 offen offset:0 sc1 lds
    buffer_load_dwordx4 v24, s[40:43], s52 offen offset:1024 sc1 lds
    buffer_load_dwordx4 v24, s[40:43], s52 offen offset:2048 sc1 lds
    buffer_load_dwordx4 v24, s[40:43], s52 offen offset:3072 sc1 lds
    s_add_u32 m0, s56, 147456
    s_add_u32 s52, s54, 14336
    buffer_load_dwordx4 v24, s[40:43], s52 offen offset:0 sc1 lds
    s_add_u32 s51, s53, 2816
    s_add_u32 m0, s55, 8192
    s_nop 0
    buffer_load_dwordx4 v20, s[36:39], s51 offen offset:0 sc1 lds
    buffer_load_dwordx4 v21, s[36:39], s51 offen offset:1024 sc1 lds
    buffer_load_dwordx4 v22, s[36:39], s51 offen offset:2048 sc1 lds
    buffer_load_dwordx4 v23, s[36:39], s51 offen offset:3072 sc1 lds
    s_waitcnt vmcnt(18)
    s_barrier
    buffer_load_dword v4, v16, s[44:47], 0 offen sc1
    s_add_u32 m0, s56, 153600
    s_add_u32 s52, s54, 30720
    buffer_load_dwordx4 v24, s[40:43], s52 offen offset:0 sc1 lds
    buffer_load_dwordx4 v24, s[40:43], s52 offen offset:1024 sc1 lds
    buffer_load_dwordx4 v24, s[40:43], s52 offen offset:2048 sc1 lds
    buffer_load_dwordx4 v24, s[40:43], s52 offen offset:3072 sc1 lds
    s_add_u32 m0, s56, 157696
    s_add_u32 s52, s54, 34816
    buffer_load_dwordx4 v24, s[40:43], s52 offen offset:0 sc1 lds
    s_add_u32 s51, s53, 3072
    s_add_u32 m0, s55, 16384
    s_nop 0
    buffer_load_dwordx4 v20, s[36:39], s51 offen offset:0 sc1 lds
    buffer_load_dwordx4 v21, s[36:39], s51 offen offset:1024 sc1 lds
    buffer_load_dwordx4 v22, s[36:39], s51 offen offset:2048 sc1 lds
    buffer_load_dwordx4 v23, s[36:39], s51 offen offset:3072 sc1 lds
    s_waitcnt vmcnt(19)
    s_barrier
    s_add_u32 m0, s56, 81920
    s_add_u32 s52, s54, 51200
    buffer_load_dwordx4 v24, s[40:43], s52 offen offset:0 sc1 lds
    buffer_load_dwordx4 v24, s[40:43], s52 offen offset:1024 sc1 lds
    buffer_load_dwordx4 v24, s[40:43], s52 offen offset:2048 sc1 lds
    buffer_load_dwordx4 v24, s[40:43], s52 offen offset:3072 sc1 lds
    s_add_u32 m0, s56, 86016
    s_add_u32 s52, s54, 55296
    buffer_load_dwordx4 v24, s[40:43], s52 offen offset:0 sc1 lds
    s_add_u32 s51, s53, 3328
    s_add_u32 m0, s55, 24576
    s_nop 0
    buffer_load_dwordx4 v20, s[36:39], s51 offen offset:0 sc1 lds
    buffer_load_dwordx4 v21, s[36:39], s51 offen offset:1024 sc1 lds
    buffer_load_dwordx4 v22, s[36:39], s51 offen offset:2048 sc1 lds
    buffer_load_dwordx4 v23, s[36:39], s51 offen offset:3072 sc1 lds
    s_waitcnt vmcnt(19)
    s_barrier
    v_mov_b32 v8, v16
    s_mov_b32 s31, 0
    s_waitcnt vmcnt(18)
    s_branch sequential_preLN__linear_attn_block__dense_activation_relu__prompt_kernel_poll68_c
sequential_preLN__linear_attn_block__dense_activation_relu__prompt_kernel_poll68:
    s_waitcnt vmcnt(0)
sequential_preLN__linear_attn_block__dense_activation_relu__prompt_kernel_poll68_c:
    v_cmp_ne_u32 vcc, 1, v4
    s_add_u32 s31, s31, 1
    s_nop 3
    s_cbranch_vccz sequential_preLN__linear_attn_block__dense_activation_relu__prompt_kernel_pollok69
    s_cmp_gt_u32 s31, 0x40000
    s_cbranch_scc1 sequential_preLN__linear_attn_block__dense_activation_relu__prompt_kernel_end1
    s_sleep 8
    buffer_load_dword v4, v8, s[44:47], 0 offen sc1
    s_branch sequential_preLN__linear_attn_block__dense_activation_relu__prompt_kernel_poll68
sequential_preLN__linear_attn_block__dense_activation_relu__prompt_kernel_pollok69:
    s_add_u32 m0, s56, 92160
    s_add_u32 s52, s54, 71680
    buffer_load_dwordx4 v24, s[40:43], s52 offen offset:0 sc1 lds
    buffer_load_dwordx4 v24, s[40:43], s52 offen offset:1024 sc1 lds
    buffer_load_dwordx4 v24, s[40:43], s52 offen offset:2048 sc1 lds
    buffer_load_dwordx4 v24, s[40:43], s52 offen offset:3072 sc1 lds
    s_add_u32 m0, s56, 96256
    s_add_u32 s52, s54, 75776
    buffer_load_dwordx4 v24, s[40:43], s52 offen offset:0 sc1 lds
    s_add_u32 s51, s53, 128
    s_add_u32 m0, s55, 32768
    s_nop 0
    buffer_load_dwordx4 v20, s[36:39], s51 offen offset:0 sc1 lds
    buffer_load_dwordx4 v21, s[36:39], s51 offen offset:1024 sc1 lds
    buffer_load_dwordx4 v22, s[36:39], s51 offen offset:2048 sc1 lds
    buffer_load_dwordx4 v23, s[36:39], s51 offen offset:3072 sc1 lds
    s_waitcnt vmcnt(18)
    s_barrier
    s_add_u32 m0, s56, 102400
    s_add_u32 s52, s54, 92160
    buffer_load_dwordx4 v24, s[40:43], s52 offen offset:0 sc1 lds
    buffer_load_dwordx4 v24, s[40:43], s52 offen offset:1024 sc1 lds
    buffer_load_dwordx4 v24, s[40:43], s52 offen offset:2048 sc1 lds
    buffer_load_dwordx4 v24, s[40:43], s52 offen offset:3072 sc1 lds
    s_add_u32 m0, s56, 106496
    s_add_u32 s52, s54, 96256
    buffer_load_dwordx4 v24, s[40:43], s52 offen offset:0 sc1 lds
    s_add_u32 s51, s53, 384
    s_add_u32 m0, s55, 40960
    s_nop 0
    buffer_load_dwordx4 v20, s[36:39], s51 offen offset:0 sc1 lds
    buffer_load_dwordx4 v21, s[36:39], s51 offen offset:1024 sc1 lds
    buffer_load_dwordx4 v22, s[36:39], s51 offen offset:2048 sc1 lds
    buffer_load_dwordx4 v23, s[36:39], s51 offen offset:3072 sc1 lds
    s_waitcnt vmcnt(18)
    s_barrier
    s_add_u32 m0, s56, 112640
    s_add_u32 s52, s54, 112640
    buffer_load_dwordx4 v24, s[40:43], s52 offen offset:0 sc1 lds
    buffer_load_dwordx4 v24, s[40:43], s52 offen offset:1024 sc1 lds
    buffer_load_dwordx4 v24, s[40:43], s52 offen offset:2048 sc1 lds
    buffer_load_dwordx4 v24, s[40:43], s52 offen offset:3072 sc1 lds
    s_add_u32 m0, s56, 116736
    s_add_u32 s52, s54, 116736
    buffer_load_dwordx4 v24, s[40:43], s52 offen offset:0 sc1 lds
    s_add_u32 s51, s53, 640
    s_add_u32 m0, s55, 49152
    s_nop 0
    buffer_load_dwordx4 v20, s[36:39], s51 offen offset:0 sc1 lds
    buffer_load_dwordx4 v21, s[36:39], s51 offen offset:1024 sc1 lds
    buffer_load_dwordx4 v22, s[36:39], s51 offen offset:2048 sc1 lds
    buffer_load_dwordx4 v23, s[36:39], s51 offen offset:3072 sc1 lds
    s_waitcnt vmcnt(18)
    s_barrier
    s_add_u32 m0, s56, 122880
    s_add_u32 s52, s54, 133120
    buffer_load_dwordx4 v24, s[40:43], s52 offen offset:0 sc1 lds
    buffer_load_dwordx4 v24, s[40:43], s52 offen offset:1024 sc1 lds
    buffer_load_dwordx4 v24, s[40:43], s52 offen offset:2048 sc1 lds
    buffer_load_dwordx4 v24, s[40:43], s52 offen offset:3072 sc1 lds
    s_add_u32 m0, s56, 126976
    s_add_u32 s52, s54, 137216
    buffer_load_dwordx4 v24, s[40:43], s52 offen offset:0 sc1 lds
    s_add_u32 s51, s53, 896
    s_add_u32 m0, s55, 57344
    s_nop 0
    buffer_load_dwordx4 v20, s[36:39], s51 offen offset:0 sc1 lds
    buffer_load_dwordx4 v21, s[36:39], s51 offen offset:1024 sc1 lds
    buffer_load_dwordx4 v22, s[36:39], s51 offen offset:2048 sc1 lds
    buffer_load_dwordx4 v23, s[36:39], s51 offen offset:3072 sc1 lds
    s_waitcnt vmcnt(18)
    s_barrier
    s_add_u32 m0, s56, 133120
    s_add_u32 s52, s54, 153600
    buffer_load_dwordx4 v24, s[40:43], s52 offen offset:0 sc1 lds
    buffer_load_dwordx4 v24, s[40:43], s52 offen offset:1024 sc1 lds
    buffer_load_dwordx4 v24, s[40:43], s52 offen offset:2048 sc1 lds
    buffer_load_dwordx4 v24, s[40:43], s52 offen offset:3072 sc1 lds
    s_add_u32 m0, s56, 137216
    s_add_u32 s52, s54, 157696
    buffer_load_dwordx4 v24, s[40:43], s52 offen offset:0 sc1 lds
    s_add_u32 s51, s53, 1152
    s_add_u32 m0, s55, 65536
    s_nop 0
    buffer_load_dwordx4 v20, s[36:39], s51 offen offset:0 sc1 lds
    buffer_load_dwordx4 v21, s[36:39], s51 offen offset:1024 sc1 lds
    buffer_load_dwordx4 v22, s[36:39], s51 offen offset:2048 sc1 lds
    buffer_load_dwordx4 v23, s[36:39], s51 offen offset:3072 sc1 lds
    s_waitcnt vmcnt(18)
    s_barrier
    s_add_u32 m0, s56, 143360
    s_add_u32 s52, s54, 174080
    buffer_load_dwordx4 v24, s[40:43], s52 offen offset:0 sc1 lds
    buffer_load_dwordx4 v24, s[40:43], s52 offen offset:1024 sc1 lds
    buffer_load_dwordx4 v24, s[40:43], s52 offen offset:2048 sc1 lds
    buffer_load_dwordx4 v24, s[40:43], s52 offen offset:3072 sc1 lds
    s_add_u32 m0, s56, 147456
    s_add_u32 s52, s54, 178176
    buffer_load_dwordx4 v24, s[40:43], s52 offen offset:0 sc1 lds
    s_add_u32 s51, s53, 1408
    s_add_u32 m0, s55, 73728
    s_nop 0
    buffer_load_dwordx4 v20, s[36:39], s51 offen offset:0 sc1 lds
    buffer_load_dwordx4 v21, s[36:39], s51 offen offset:1024 sc1 lds
    buffer_load_dwordx4 v22, s[36:39], s51 offen offset:2048 sc1 lds
    buffer_load_dwordx4 v23, s[36:39], s51 offen offset:3072 sc1 lds
    s_waitcnt vmcnt(18)
    s_barrier
    s_add_u32 m0, s56, 153600
    s_add_u32 s52, s54, 194560
    buffer_load_dwordx4 v24, s[40:43], s52 offen offset:0 sc1 lds
    buffer_load_dwordx4 v24, s[40:43], s52 offen offset:1024 sc1 lds
    buffer_load_dwordx4 v24, s[40:43], s52 offen offset:2048 sc1 lds
    buffer_load_dwordx4 v24, s[40:43], s52 offen offset:3072 sc1 lds
    s_add_u32 m0, s56, 157696
    s_add_u32 s52, s54, 198656
    buffer_load_dwordx4 v24, s[40:43], s52 offen offset:0 sc1 lds
    s_add_u32 s51, s53, 1664
    s_add_u32 m0, s55, 0
    s_nop 0
    buffer_load_dwordx4 v20, s[36:39], s51 offen offset:0 sc1 lds
    buffer_load_dwordx4 v21, s[36:39], s51 offen offset:1024 sc1 lds
    buffer_load_dwordx4 v22, s[36:39], s51 offen offset:2048 sc1 lds
    buffer_load_dwordx4 v23, s[36:39], s51 offen offset:3072 sc1 lds
    s_waitcnt vmcnt(18)
    s_barrier
    s_add_u32 m0, s56, 81920
    s_add_u32 s52, s54, 215040
    buffer_load_dwordx4 v24, s[40:43], s52 offen offset:0 sc1 lds
    buffer_load_dwordx4 v24, s[40:43], s52 offen offset:1024 sc1 lds
    buffer_load_dwordx4 v24, s[40:43], s52 offen offset:2048 sc1 lds
    buffer_load_dwordx4 v24, s[40:43], s52 offen offset:3072 sc1 lds
    s_add_u32 m0, s56, 86016
    s_add_u32 s52, s54, 219136
    buffer_load_dwordx4 v24, s[40:43], s52 offen offset:0 sc1 lds
    s_add_u32 s51, s53, 1920
    s_add_u32 m0, s55, 8192
    s_nop 0
    buffer_load_dwordx4 v20, s[36:39], s51 offen offset:0 sc1 lds
    buffer_load_dwordx4 v21, s[36:39], s51 offen offset:1024 sc1 lds
    buffer_load_dwordx4 v22, s[36:39], s51 offen offset:2048 sc1 lds
    buffer_load_dwordx4 v23, s[36:39], s51 offen offset:3072 sc1 lds
    s_waitcnt vmcnt(18)
    s_barrier
    s_add_u32 m0, s56, 92160
    s_add_u32 s52, s54, 235520
    buffer_load_dwordx4 v24, s[40:43], s52 offen offset:0 sc1 lds
    buffer_load_dwordx4 v24, s[40:43], s52 offen offset:1024 sc1 lds
    buffer_load_dwordx4 v24, s[40:43], s52 offen offset:2048 sc1 lds
    buffer_load_dwordx4 v24, s[40:43], s52 offen offset:3072 sc1 lds
    s_add_u32 m0, s56, 96256
    s_add_u32 s52, s54, 239616
    buffer_load_dwordx4 v24, s[40:43], s52 offen offset:0 sc1 lds
    s_add_u32 s51, s53, 2176
    s_add_u32 m0, s55, 16384
    s_nop 0
    buffer_load_dwordx4 v20, s[36:39], s51 offen offset:0 sc1 lds
    buffer_load_dwordx4 v21, s[36:39], s51 offen offset:1024 sc1 lds
    buffer_load_dwordx4 v22, s[36:39], s51 offen offset:2048 sc1 lds
    buffer_load_dwordx4 v23, s[36:39], s51 offen offset:3072 sc1 lds
    s_waitcnt vmcnt(18)
    s_barrier
    s_add_u32 m0, s56, 102400
    s_add_u32 s52, s54, 256000
    buffer_load_dwordx4 v24, s[40:43], s52 offen offset:0 sc1 lds
    buffer_load_dwordx4 v24, s[40:43], s52 offen offset:1024 sc1 lds
    buffer_load_dwordx4 v24, s[40:43], s52 offen offset:2048 sc1 lds
    buffer_load_dwordx4 v24, s[40:43], s52 offen offset:3072 sc1 lds
    s_add_u32 m0, s56, 106496
    s_add_u32 s52, s54, 260096
    buffer_load_dwordx4 v24, s[40:43], s52 offen offset:0 sc1 lds
    s_add_u32 s51, s53, 2432
    s_add_u32 m0, s55, 24576
    s_nop 0
    buffer_load_dwordx4 v20, s[36:39], s51 offen offset:0 sc1 lds
    buffer_load_dwordx4 v21, s[36:39], s51 offen offset:1024 sc1 lds
    buffer_load_dwordx4 v22, s[36:39], s51 offen offset:2048 sc1 lds
    buffer_load_dwordx4 v23, s[36:39], s51 offen offset:3072 sc1 lds
    s_add_u32 s51, s53, 2688
    s_add_u32 m0, s55, 32768
    s_nop 0
    buffer_load_dwordx4 v20, s[36:39], s51 offen offset:0 sc1 lds
    buffer_load_dwordx4 v21, s[36:39], s51 offen offset:1024 sc1 lds
    buffer_load_dwordx4 v22, s[36:39], s51 offen offset:2048 sc1 lds
    buffer_load_dwordx4 v23, s[36:39], s51 offen offset:3072 sc1 lds
    s_add_u32 s51, s53, 2944
    s_add_u32 m0, s55, 40960
    s_nop 0
    buffer_load_dwordx4 v20, s[36:39], s51 offen offset:0 sc1 lds
    buffer_load_dwordx4 v21, s[36:39], s51 offen offset:1024 sc1 lds
    s_waitcnt vmcnt(24)
    s_barrier
    buffer_load_dwordx4 v22, s[36:39], s51 offen offset:2048 sc1 lds
    buffer_load_dwordx4 v23, s[36:39], s51 offen offset:3072 sc1 lds
    s_add_u32 s51, s53, 3200
    s_add_u32 m0, s55, 49152
    s_nop 0
    buffer_load_dwordx4 v20, s[36:39], s51 offen offset:0 sc1 lds
    buffer_load_dwordx4 v21, s[36:39], s51 offen offset:1024 sc1 lds
    buffer_load_dwordx4 v22, s[36:39], s51 offen offset:2048 sc1 lds
    buffer_load_dwordx4 v23, s[36:39], s51 offen offset:3072 sc1 lds
    s_waitcnt vmcnt(21)
    s_barrier
    s_waitcnt vmcnt(12)
    s_barrier
    s_waitcnt vmcnt(8)
    s_barrier
    s_waitcnt vmcnt(4)
    s_barrier
    s_waitcnt vmcnt(0)
    s_barrier
    s_barrier
sequential_preLN__linear_attn_block__dense_activation_relu__prompt_kernel_ldend62:
    s_endpgm
sequential_preLN__linear_attn_block__dense_activation_relu__prompt_kernel_svc4:
    s_and_b32 s28, s26, 7
    s_and_b32 s31, s2, 7
    s_lshl_b32 s32, s31, 3
    s_add_u32 s32, s32, s28
    s_lshl_b32 s29, s32, 3
    s_add_u32 s29, s29, s22
    s_lshl_b32 s29, s29, 2
    v_lshrrev_b32 v164, 4, v1
    v_add_u32 v164, s29, v164
    v_mul_u32_u24 v165, 1280, v164
    v_and_b32 v166, 15, v1
    v_lshl_add_u32 v165, v166, 4, v165
    s_waitcnt lgkmcnt(0)
    s_mov_b64 s[36:37], s[4:5]
    s_mov_b32 s38, 2621440
    s_mov_b32 s39, 0x20000
    buffer_load_dwordx4 v[104:107], v165, s[36:39], 0 offen offset:0
    buffer_load_dwordx4 v[108:111], v165, s[36:39], 0 offen offset:256
    buffer_load_dwordx4 v[112:115], v165, s[36:39], 0 offen offset:512
    buffer_load_dwordx4 v[116:119], v165, s[36:39], 0 offen offset:768
    buffer_load_dwordx4 v[120:123], v165, s[36:39], 0 offen offset:1024
    s_add_u32 s40, s20, 16908288
    s_addc_u32 s41, s21, 0
    s_mov_b32 s42, 1654784
    s_mov_b32 s43, 0x20000
    s_add_u32 s44, s20, 16777216
    s_addc_u32 s45, s21, 0
    s_mov_b32 s46, 65536
    s_mov_b32 s47, 0x20000
    s_mov_b64 s[48:49], s[6:7]
    s_mov_b32 s50, 2457600
    s_mov_b32 s51, 0x20000
    v_mov_b64 v[172:173], 0
    v_mov_b64 v[174:175], 0
    s_lshl_b32 s30, s29, 5
    v_lshlrev_b32 v165, 4, v1
    s_mov_b64 exec, 0xff
    buffer_store_dwordx4 v[172:175], v165, s[44:47], s30 offen sc1
    s_mul_i32 s30, s29, 96
    s_add_u32 s30, s30, 1458176
    buffer_store_dwordx4 v[172:175], v165, s[40:43], s30 offen sc1
    s_mov_b64 exec, 3
    s_lshr_b32 s30, s29, 4
    s_mul_i32 s30, s30, 4224
    s_and_b32 s3, s22, 3
    s_lshl_b32 s3, s3, 5
    s_add_u32 s30, s30, s3
    s_add_u32 s30, s30, 917504
    buffer_store_dwordx4 v[172:175], v165, s[40:43], s30 offen sc1
    s_mov_b64 exec, -1
    v_mov_b64 v[166:167], 0
    v_mov_b64 v[168:169], 0
    s_mov_b64 s[56:57], s[12:13]
    s_mov_b32 s58, 2211840
    s_mov_b32 s59, 0x20000
    s_lshl_b32 s3, s28, 1
    v_bfe_u32 v238, v1, 3, 1
    v_add_u32 v238, s3, v238
    v_min_u32 v238, 14, v238
    v_mul_u32_u24 v234, 205, v238
    v_lshrrev_b32 v234, 10, v234
    v_mul_u32_u24 v234, 640, v234
    v_lshl_add_u32 v234, v238, 7, v234
    v_and_b32 v238, 7, v1
    v_lshl_add_u32 v234, v238, 4, v234
    v_lshrrev_b32 v238, 4, v1
    v_mul_u32_u24 v235, 3840, v238
    v_add_u32 v234, v234, v235
    s_mul_i32 s30, s24, 40
    s_add_u32 s30, s30, s22
    s_mul_i32 s52, s30, 15360
    s_mul_i32 s3, s25, 640
    s_add_u32 s52, s52, s3
    buffer_load_dwordx4 v[176:179], v234, s[48:51], s52 offen
    s_add_u32 s52, s52, 122880
    buffer_load_dwordx4 v[180:183], v234, s[48:51], s52 offen
    s_add_u32 s52, s52, 122880
    buffer_load_dwordx4 v[184:187], v234, s[48:51], s52 offen
    s_add_u32 s52, s52, 122880
    buffer_load_dwordx4 v[188:191], v234, s[48:51], s52 offen
    s_add_u32 s52, s52, 122880
    buffer_load_dwordx4 v[192:195], v234, s[48:51], s52 offen
    s_add_u32 s52, s52, 122880
    v_mul_u32_u24 v235, 3456, v238
    v_and_b32 v238, 15, v1
    v_lshl_add_u32 v235, v238, 4, v235
    s_mul_i32 s53, s30, 13824
    s_min_u32 s3, s28, 6
    s_mul_i32 s30, s25, 7
    s_add_u32 s3, s3, s30
    s_lshl_b32 s3, s3, 8
    s_add_u32 s53, s53, s3
    v_lshlrev_b32 v236, 5, v238
    s_lshl_b32 s3, s22, 9
    v_add_u32 v236, s3, v236
    v_lshlrev_b32 v237, 4, v1
    s_lshl_b32 s60, s22, 3
    s_add_u32 s60, s60, s28
    s_mul_i32 s61, s25, 640
    v_min_u32 v241, 59, v1
    v_mul_u32_u24 v240, 69, v241
    v_lshrrev_b32 v240, 10, v240
    v_mul_u32_u24 v239, 15, v240
    v_sub_u32 v241, v241, v239
    v_mul_u32_u24 v240, 3840, v240
    v_lshl_add_u32 v239, v241, 7, v240
    v_mul_u32_u24 v240, 205, v241
    v_lshrrev_b32 v240, 10, v240
    v_mul_u32_u24 v240, 640, v240
    v_add_u32 v239, v239, v240
    s_add_u32 s62, s60, 72
    s_mul_i32 s62, s62, 4
    s_min_u32 s62, s62, 636
    s_mul_i32 s62, s62, 3840
    s_add_u32 s62, s62, s61
    s_add_u32 s64, s6, s62
    s_addc_u32 s65, s7, 0
    global_load_dword v2, v239, s[64:65]
sequential_preLN__linear_attn_block__dense_activation_relu__prompt_kernel_tsk70:
    s_and_b32 s3, s22, 1
    s_lshl_b32 s3, s3, 3
    v_add_u32 v42, 0, v1
    v_mul_u32_u24 v43, 205, v42
    v_lshrrev_b32 v43, 11, v43
    v_mul_u32_u24 v44, 10, v43
    v_sub_u32 v44, v42, v44
    v_lshlrev_b32 v51, 4, v44
    v_and_b32 v46, 3, v43
    v_bfe_u32 v42, v43, 3, 1
    v_lshl_or_b32 v46, v42, 2, v46
    v_add_u32 v46, s3, v46
    v_bfe_u32 v42, v43, 2, 1
    v_lshrrev_b32 v44, 4, v43
    v_lshl_or_b32 v42, v44, 1, v42
    v_mul_u32_u24 v42, 6400, v42
    v_add_u32 v51, v51, v42
    s_and_b32 s3, s22, 1
    s_lshl_b32 s3, s3, 3
    v_add_u32 v42, 64, v1
    v_mul_u32_u24 v43, 205, v42
    v_lshrrev_b32 v43, 11, v43
    v_mul_u32_u24 v44, 10, v43
    v_sub_u32 v44, v42, v44
    v_lshlrev_b32 v52, 4, v44
    v_and_b32 v47, 3, v43
    v_bfe_u32 v42, v43, 3, 1
    v_lshl_or_b32 v47, v42, 2, v47
    v_add_u32 v47, s3, v47
    v_bfe_u32 v42, v43, 2, 1
    v_lshrrev_b32 v44, 4, v43
    v_lshl_or_b32 v42, v44, 1, v42
    v_mul_u32_u24 v42, 6400, v42
    v_add_u32 v52, v52, v42
    s_and_b32 s3, s22, 1
    s_lshl_b32 s3, s3, 3
    v_add_u32 v42, 128, v1
    v_mul_u32_u24 v43, 205, v42
    v_lshrrev_b32 v43, 11, v43
    v_mul_u32_u24 v44, 10, v43
    v_sub_u32 v44, v42, v44
    v_lshlrev_b32 v53, 4, v44
    v_and_b32 v48, 3, v43
    v_bfe_u32 v42, v43, 3, 1
    v_lshl_or_b32 v48, v42, 2, v48
    v_add_u32 v48, s3, v48
    v_bfe_u32 v42, v43, 2, 1
    v_lshrrev_b32 v44, 4, v43
    v_lshl_or_b32 v42, v44, 1, v42
    v_mul_u32_u24 v42, 6400, v42
    v_add_u32 v53, v53, v42
    s_and_b32 s3, s22, 1
    s_lshl_b32 s3, s3, 3
    v_add_u32 v42, 192, v1
    v_mul_u32_u24 v43, 205, v42
    v_lshrrev_b32 v43, 11, v43
    v_mul_u32_u24 v44, 10, v43
    v_sub_u32 v44, v42, v44
    v_lshlrev_b32 v54, 4, v44
    v_and_b32 v49, 3, v43
    v_bfe_u32 v42, v43, 3, 1
    v_lshl_or_b32 v49, v42, 2, v49
    v_add_u32 v49, s3, v49
    v_bfe_u32 v42, v43, 2, 1
    v_lshrrev_b32 v44, 4, v43
    v_lshl_or_b32 v42, v44, 1, v42
    v_mul_u32_u24 v42, 6400, v42
    v_add_u32 v54, v54, v42
    s_and_b32 s3, s22, 1
    s_lshl_b32 s3, s3, 3
    v_add_u32 v42, 256, v1
    v_mul_u32_u24 v43, 205, v42
    v_lshrrev_b32 v43, 11, v43
    v_mul_u32_u24 v44, 10, v43
    v_sub_u32 v44, v42, v44
    v_lshlrev_b32 v55, 4, v44
    v_and_b32 v50, 3, v43
    v_bfe_u32 v42, v43, 3, 1
    v_lshl_or_b32 v50, v42, 2, v50
    v_add_u32 v50, s3, v50
    v_bfe_u32 v42, v43, 2, 1
    v_lshrrev_b32 v44, 4, v43
    v_lshl_or_b32 v42, v44, 1, v42
    v_mul_u32_u24 v42, 6400, v42
    v_add_u32 v55, v55, v42
    s_waitcnt vmcnt(13)
    v_lshlrev_b32 v124, 16, v104
    v_and_b32 v125, 0xffff0000, v104
    v_pk_add_f32 v[166:167], v[166:167], v[124:125]
    v_lshlrev_b32 v126, 16, v105
    v_and_b32 v127, 0xffff0000, v105
    v_pk_add_f32 v[166:167], v[166:167], v[126:127]
    v_lshlrev_b32 v128, 16, v106
    v_and_b32 v129, 0xffff0000, v106
    v_pk_add_f32 v[166:167], v[166:167], v[128:129]
    v_lshlrev_b32 v130, 16, v107
    v_and_b32 v131, 0xffff0000, v107
    v_pk_add_f32 v[166:167], v[166:167], v[130:131]
    s_waitcnt vmcnt(12)
    v_lshlrev_b32 v132, 16, v108
    v_and_b32 v133, 0xffff0000, v108
    v_pk_add_f32 v[166:167], v[166:167], v[132:133]
    v_lshlrev_b32 v134, 16, v109
    v_and_b32 v135, 0xffff0000, v109
    v_pk_add_f32 v[166:167], v[166:167], v[134:135]
    v_lshlrev_b32 v136, 16, v110
    v_and_b32 v137, 0xffff0000, v110
    v_pk_add_f32 v[166:167], v[166:167], v[136:137]
    v_lshlrev_b32 v138, 16, v111
    v_and_b32 v139, 0xffff0000, v111
    v_pk_add_f32 v[166:167], v[166:167], v[138:139]
    s_waitcnt vmcnt(11)
    v_lshlrev_b32 v140, 16, v112
    v_and_b32 v141, 0xffff0000, v112
    v_pk_add_f32 v[166:167], v[166:167], v[140:141]
    v_lshlrev_b32 v142, 16, v113
    v_and_b32 v143, 0xffff0000, v113
    v_pk_add_f32 v[166:167], v[166:167], v[142:143]
    v_lshlrev_b32 v144, 16, v114
    v_and_b32 v145, 0xffff0000, v114
    v_pk_add_f32 v[166:167], v[166:167], v[144:145]
    v_lshlrev_b32 v146, 16, v115
    v_and_b32 v147, 0xffff0000, v115
    v_pk_add_f32 v[166:167], v[166:167], v[146:147]
    s_waitcnt vmcnt(10)
    v_lshlrev_b32 v148, 16, v116
    v_and_b32 v149, 0xffff0000, v116
    v_pk_add_f32 v[166:167], v[166:167], v[148:149]
    v_lshlrev_b32 v150, 16, v117
    v_and_b32 v151, 0xffff0000, v117
    v_pk_add_f32 v[166:167], v[166:167], v[150:151]
    v_lshlrev_b32 v152, 16, v118
    v_and_b32 v153, 0xffff0000, v118
    v_pk_add_f32 v[166:167], v[166:167], v[152:153]
    v_lshlrev_b32 v154, 16, v119
    v_and_b32 v155, 0xffff0000, v119
    v_pk_add_f32 v[166:167], v[166:167], v[154:155]
    s_waitcnt vmcnt(9)
    v_lshlrev_b32 v156, 16, v120
    v_and_b32 v157, 0xffff0000, v120
    v_pk_add_f32 v[166:167], v[166:167], v[156:157]
    v_lshlrev_b32 v158, 16, v121
    v_and_b32 v159, 0xffff0000, v121
    v_pk_add_f32 v[166:167], v[166:167], v[158:159]
    v_lshlrev_b32 v160, 16, v122
    v_and_b32 v161, 0xffff0000, v122
    v_pk_add_f32 v[166:167], v[166:167], v[160:161]
    v_lshlrev_b32 v162, 16, v123
    v_and_b32 v163, 0xffff0000, v123
    v_pk_add_f32 v[166:167], v[166:167], v[162:163]
    v_add_f32 v166, v166, v167
    s_nop 1
    v_add_f32_dpp v166, v166, v166 row_ror:8 row_mask:0xf bank_mask:0xf
    s_nop 1
    v_add_f32_dpp v166, v166, v166 row_ror:4 row_mask:0xf bank_mask:0xf
    s_nop 1
    v_add_f32_dpp v166, v166, v166 row_ror:2 row_mask:0xf bank_mask:0xf
    s_nop 1
    v_add_f32_dpp v166, v166, v166 row_ror:1 row_mask:0xf bank_mask:0xf
    s_mov_b32 s30, 986500301
    v_mul_f32 v166, s30, v166
    v_pk_add_f32 v[124:125], v[124:125], v[166:167] op_sel_hi:[1,0] neg_lo:[0,1] neg_hi:[0,1]
    v_pk_fma_f32 v[168:169], v[124:125], v[124:125], v[168:169]
    v_pk_add_f32 v[126:127], v[126:127], v[166:167] op_sel_hi:[1,0] neg_lo:[0,1] neg_hi:[0,1]
    v_pk_fma_f32 v[168:169], v[126:127], v[126:127], v[168:169]
    v_pk_add_f32 v[128:129], v[128:129], v[166:167] op_sel_hi:[1,0] neg_lo:[0,1] neg_hi:[0,1]
    v_pk_fma_f32 v[168:169], v[128:129], v[128:129], v[168:169]
    v_pk_add_f32 v[130:131], v[130:131], v[166:167] op_sel_hi:[1,0] neg_lo:[0,1] neg_hi:[0,1]
    v_pk_fma_f32 v[168:169], v[130:131], v[130:131], v[168:169]
    v_pk_add_f32 v[132:133], v[132:133], v[166:167] op_sel_hi:[1,0] neg_lo:[0,1] neg_hi:[0,1]
    v_pk_fma_f32 v[168:169], v[132:133], v[132:133], v[168:169]
    v_pk_add_f32 v[134:135], v[134:135], v[166:167] op_sel_hi:[1,0] neg_lo:[0,1] neg_hi:[0,1]
    v_pk_fma_f32 v[168:169], v[134:135], v[134:135], v[168:169]
    v_pk_add_f32 v[136:137], v[136:137], v[166:167] op_sel_hi:[1,0] neg_lo:[0,1] neg_hi:[0,1]
    v_pk_fma_f32 v[168:169], v[136:137], v[136:137], v[168:169]
    v_pk_add_f32 v[138:139], v[138:139], v[166:167] op_sel_hi:[1,0] neg_lo:[0,1] neg_hi:[0,1]
    v_pk_fma_f32 v[168:169], v[138:139], v[138:139], v[168:169]
    v_pk_add_f32 v[140:141], v[140:141], v[166:167] op_sel_hi:[1,0] neg_lo:[0,1] neg_hi:[0,1]
    v_pk_fma_f32 v[168:169], v[140:141], v[140:141], v[168:169]
    v_pk_add_f32 v[142:143], v[142:143], v[166:167] op_sel_hi:[1,0] neg_lo:[0,1] neg_hi:[0,1]
    v_pk_fma_f32 v[168:169], v[142:143], v[142:143], v[168:169]
    v_pk_add_f32 v[144:145], v[144:145], v[166:167] op_sel_hi:[1,0] neg_lo:[0,1] neg_hi:[0,1]
    v_pk_fma_f32 v[168:169], v[144:145], v[144:145], v[168:169]
    v_pk_add_f32 v[146:147], v[146:147], v[166:167] op_sel_hi:[1,0] neg_lo:[0,1] neg_hi:[0,1]
    v_pk_fma_f32 v[168:169], v[146:147], v[146:147], v[168:169]
    v_pk_add_f32 v[148:149], v[148:149], v[166:167] op_sel_hi:[1,0] neg_lo:[0,1] neg_hi:[0,1]
    v_pk_fma_f32 v[168:169], v[148:149], v[148:149], v[168:169]
    v_pk_add_f32 v[150:151], v[150:151], v[166:167] op_sel_hi:[1,0] neg_lo:[0,1] neg_hi:[0,1]
    v_pk_fma_f32 v[168:169], v[150:151], v[150:151], v[168:169]
    v_pk_add_f32 v[152:153], v[152:153], v[166:167] op_sel_hi:[1,0] neg_lo:[0,1] neg_hi:[0,1]
    v_pk_fma_f32 v[168:169], v[152:153], v[152:153], v[168:169]
    v_pk_add_f32 v[154:155], v[154:155], v[166:167] op_sel_hi:[1,0] neg_lo:[0,1] neg_hi:[0,1]
    v_pk_fma_f32 v[168:169], v[154:155], v[154:155], v[168:169]
    v_pk_add_f32 v[156:157], v[156:157], v[166:167] op_sel_hi:[1,0] neg_lo:[0,1] neg_hi:[0,1]
    v_pk_fma_f32 v[168:169], v[156:157], v[156:157], v[168:169]
    v_pk_add_f32 v[158:159], v[158:159], v[166:167] op_sel_hi:[1,0] neg_lo:[0,1] neg_hi:[0,1]
    v_pk_fma_f32 v[168:169], v[158:159], v[158:159], v[168:169]
    v_pk_add_f32 v[160:161], v[160:161], v[166:167] op_sel_hi:[1,0] neg_lo:[0,1] neg_hi:[0,1]
    v_pk_fma_f32 v[168:169], v[160:161], v[160:161], v[168:169]
    v_pk_add_f32 v[162:163], v[162:163], v[166:167] op_sel_hi:[1,0] neg_lo:[0,1] neg_hi:[0,1]
    v_pk_fma_f32 v[168:169], v[162:163], v[162:163], v[168:169]
    v_add_f32 v168, v168, v169
    s_nop 1
    v_add_f32_dpp v168, v168, v168 row_ror:8 row_mask:0xf bank_mask:0xf
    s_nop 1
    v_add_f32_dpp v168, v168, v168 row_ror:4 row_mask:0xf bank_mask:0xf
    s_nop 1
    v_add_f32_dpp v168, v168, v168 row_ror:2 row_mask:0xf bank_mask:0xf
    s_nop 1
    v_add_f32_dpp v168, v168, v168 row_ror:1 row_mask:0xf bank_mask:0xf
    v_mul_f32 v168, s30, v168
    s_mov_b32 s30, 925353388
    v_cvt_pk_bf16_f32 v166, v166, v166
    v_lshlrev_b32 v166, 16, v166
    v_cvt_pk_bf16_f32 v168, v168, v168
    v_lshlrev_b32 v168, 16, v168
    v_add_f32 v168, s30, v168
    v_cvt_pk_bf16_f32 v168, v168, v168
    v_lshlrev_b32 v168, 16, v168
    v_sqrt_f32 v168, v168
    s_nop 0
    v_cvt_pk_bf16_f32 v168, v168, v168
    v_lshlrev_b32 v168, 16, v168
    v_rcp_f32 v168, v168
    s_nop 0
    v_lshrrev_b32 v165, 7, v164
    v_and_b32 v164, 127, v164
    v_lshlrev_b32 v164, 2, v164
    v_lshl_add_u32 v164, v165, 10, v164
    s_mov_b32 exec_lo, 0x00010001
    s_mov_b32 exec_hi, 0x00010001
    buffer_store_dword v166, v164, s[40:43], 0 offen sc1
    buffer_store_dword v168, v164, s[40:43], 0 offen offset:512 sc1
    s_mov_b64 exec, -1
    v_mov_b64 v[216:217], 0
    v_mov_b64 v[218:219], 0
    v_mov_b64 v[220:221], 0
    v_mov_b64 v[222:223], 0
    s_waitcnt vmcnt(7)
    v_lshlrev_b32 v232, 16, v176
    v_and_b32 v233, 0xffff0000, v176
    v_pk_add_f32 v[216:217], v[216:217], v[232:233]
    v_lshlrev_b32 v232, 16, v177
    v_and_b32 v233, 0xffff0000, v177
    v_pk_add_f32 v[218:219], v[218:219], v[232:233]
    v_lshlrev_b32 v232, 16, v178
    v_and_b32 v233, 0xffff0000, v178
    v_pk_add_f32 v[220:221], v[220:221], v[232:233]
    v_lshlrev_b32 v232, 16, v179
    v_and_b32 v233, 0xffff0000, v179
    v_pk_add_f32 v[222:223], v[222:223], v[232:233]
    s_waitcnt vmcnt(6)
    v_lshlrev_b32 v232, 16, v180
    v_and_b32 v233, 0xffff0000, v180
    v_pk_add_f32 v[216:217], v[216:217], v[232:233]
    v_lshlrev_b32 v232, 16, v181
    v_and_b32 v233, 0xffff0000, v181
    v_pk_add_f32 v[218:219], v[218:219], v[232:233]
    v_lshlrev_b32 v232, 16, v182
    v_and_b32 v233, 0xffff0000, v182
    v_pk_add_f32 v[220:221], v[220:221], v[232:233]
    v_lshlrev_b32 v232, 16, v183
    v_and_b32 v233, 0xffff0000, v183
    v_pk_add_f32 v[222:223], v[222:223], v[232:233]
    s_waitcnt vmcnt(5)
    v_lshlrev_b32 v232, 16, v184
    v_and_b32 v233, 0xffff0000, v184
    v_pk_add_f32 v[216:217], v[216:217], v[232:233]
    v_lshlrev_b32 v232, 16, v185
    v_and_b32 v233, 0xffff0000, v185
    v_pk_add_f32 v[218:219], v[218:219], v[232:233]
    v_lshlrev_b32 v232, 16, v186
    v_and_b32 v233, 0xffff0000, v186
    v_pk_add_f32 v[220:221], v[220:221], v[232:233]
    v_lshlrev_b32 v232, 16, v187
    v_and_b32 v233, 0xffff0000, v187
    v_pk_add_f32 v[222:223], v[222:223], v[232:233]
    s_waitcnt vmcnt(4)
    v_lshlrev_b32 v232, 16, v188
    v_and_b32 v233, 0xffff0000, v188
    v_pk_add_f32 v[216:217], v[216:217], v[232:233]
    v_lshlrev_b32 v232, 16, v189
    v_and_b32 v233, 0xffff0000, v189
    v_pk_add_f32 v[218:219], v[218:219], v[232:233]
    v_lshlrev_b32 v232, 16, v190
    v_and_b32 v233, 0xffff0000, v190
    v_pk_add_f32 v[220:221], v[220:221], v[232:233]
    v_lshlrev_b32 v232, 16, v191
    v_and_b32 v233, 0xffff0000, v191
    v_pk_add_f32 v[222:223], v[222:223], v[232:233]
    s_waitcnt vmcnt(3)
    v_lshlrev_b32 v232, 16, v192
    v_and_b32 v233, 0xffff0000, v192
    v_pk_add_f32 v[216:217], v[216:217], v[232:233]
    v_lshlrev_b32 v232, 16, v193
    v_and_b32 v233, 0xffff0000, v193
    v_pk_add_f32 v[218:219], v[218:219], v[232:233]
    v_lshlrev_b32 v232, 16, v194
    v_and_b32 v233, 0xffff0000, v194
    v_pk_add_f32 v[220:221], v[220:221], v[232:233]
    v_lshlrev_b32 v232, 16, v195
    v_and_b32 v233, 0xffff0000, v195
    v_pk_add_f32 v[222:223], v[222:223], v[232:233]
    v_mov_b32 v176, v216
    v_mov_b32 v177, v217
    v_mov_b32 v178, v218
    v_mov_b32 v179, v219
    v_mov_b32 v180, v220
    v_mov_b32 v181, v221
    v_mov_b32 v182, v222
    v_mov_b32 v183, v223
    s_nop 0
    v_permlane16_swap_b32 v216, v176
    v_permlane16_swap_b32 v217, v177
    v_permlane16_swap_b32 v218, v178
    v_permlane16_swap_b32 v219, v179
    v_permlane16_swap_b32 v220, v180
    v_permlane16_swap_b32 v221, v181
    v_permlane16_swap_b32 v222, v182
    v_permlane16_swap_b32 v223, v183
    s_nop 0
    v_add_f32 v216, v216, v176
    v_add_f32 v217, v217, v177
    v_add_f32 v218, v218, v178
    v_add_f32 v219, v219, v179
    v_add_f32 v220, v220, v180
    v_add_f32 v221, v221, v181
    v_add_f32 v222, v222, v182
    v_add_f32 v223, v223, v183
    v_mov_b32 v176, v216
    v_mov_b32 v177, v217
    v_mov_b32 v178, v218
    v_mov_b32 v179, v219
    v_mov_b32 v180, v220
    v_mov_b32 v181, v221
    v_mov_b32 v182, v222
    v_mov_b32 v183, v223
    s_nop 0
    v_permlane32_swap_b32 v216, v176
    v_permlane32_swap_b32 v217, v177
    v_permlane32_swap_b32 v218, v178
    v_permlane32_swap_b32 v219, v179
    v_permlane32_swap_b32 v220, v180
    v_permlane32_swap_b32 v221, v181
    v_permlane32_swap_b32 v222, v182
    v_permlane32_swap_b32 v223, v183
    s_nop 0
    v_add_f32 v216, v216, v176
    v_add_f32 v217, v217, v177
    v_add_f32 v218, v218, v178
    v_add_f32 v219, v219, v179
    v_add_f32 v220, v220, v180
    v_add_f32 v221, v221, v181
    v_add_f32 v222, v222, v182
    v_add_f32 v223, v223, v183
    ds_write_b64 v236, v[216:217] offset:0
    ds_write_b64 v236, v[218:219] offset:8
    ds_write_b64 v236, v[220:221] offset:16
    ds_write_b64 v236, v[222:223] offset:24
    s_waitcnt lgkmcnt(0)
    s_barrier
    s_cmp_lg_u32 s22, 0
    s_cbranch_scc1 sequential_preLN__linear_attn_block__dense_activation_relu__prompt_kernel_csk71
    ds_read_b128 v[176:179], v237 offset:0
    ds_read_b128 v[180:183], v237 offset:512
    ds_read_b128 v[184:187], v237 offset:1024
    ds_read_b128 v[188:191], v237 offset:1536
    ds_read_b128 v[192:195], v237 offset:2048
    ds_read_b128 v[196:199], v237 offset:2560
    ds_read_b128 v[200:203], v237 offset:3072
    ds_read_b128 v[204:207], v237 offset:3584
    s_lshl_b32 s3, s32, 9
    s_add_u32 s3, s3, 16384
    s_waitcnt lgkmcnt(0)
    v_pk_add_f32 v[176:177], v[176:177], v[180:181]
    v_pk_add_f32 v[178:179], v[178:179], v[182:183]
    v_pk_add_f32 v[176:177], v[176:177], v[184:185]
    v_pk_add_f32 v[178:179], v[178:179], v[186:187]
    v_pk_add_f32 v[176:177], v[176:177], v[188:189]
    v_pk_add_f32 v[178:179], v[178:179], v[190:191]
    v_pk_add_f32 v[176:177], v[176:177], v[192:193]
    v_pk_add_f32 v[178:179], v[178:179], v[194:195]
    v_pk_add_f32 v[176:177], v[176:177], v[196:197]
    v_pk_add_f32 v[178:179], v[178:179], v[198:199]
    v_pk_add_f32 v[176:177], v[176:177], v[200:201]
    v_pk_add_f32 v[178:179], v[178:179], v[202:203]
    v_pk_add_f32 v[176:177], v[176:177], v[204:205]
    v_pk_add_f32 v[178:179], v[178:179], v[206:207]
    s_mov_b32 exec_hi, 0
    buffer_store_dwordx4 v[176:179], v237, s[40:43], s3 offen sc1
    s_mov_b64 exec, -1
    s_nop 1
sequential_preLN__linear_attn_block__dense_activation_relu__prompt_kernel_csk71:
    s_mov_b64 s[36:37], s[18:19]
    s_mov_b32 s38, 256
    s_mov_b32 s39, 0x20000
    s_waitcnt vmcnt(0)
    s_barrier
    s_cmp_eq_u32 s22, 7
    s_cbranch_scc0 sequential_preLN__linear_attn_block__dense_activation_relu__prompt_kernel_svf72
    s_lshl_b32 s3, s32, 2
    v_mov_b32 v164, s3
    v_mov_b32 v165, 1
    s_mov_b64 exec, 1
    buffer_store_dword v165, v164, s[36:39], 0 offen  sc1
    s_mov_b64 exec, -1
sequential_preLN__linear_attn_block__dense_activation_relu__prompt_kernel_svf72:
    s_barrier
    s_add_u32 s62, s60, 136
    s_mul_i32 s62, s62, 4
    s_cmp_ge_u32 s62, 640
    s_cbranch_scc1 sequential_preLN__linear_attn_block__dense_activation_relu__prompt_kernel_tsk73
    s_min_u32 s62, s62, 636
    s_mul_i32 s62, s62, 3840
    s_add_u32 s62, s62, s61
    s_add_u32 s64, s6, s62
    s_addc_u32 s65, s7, 0
    global_load_dword v2, v239, s[64:65]
sequential_preLN__linear_attn_block__dense_activation_relu__prompt_kernel_tsk73:
    v_min_u32 v244, 59, v1
    v_mul_u32_u24 v243, 205, v244
    v_lshrrev_b32 v243, 10, v243
    v_mul_u32_u24 v242, 5, v243
    v_sub_u32 v244, v244, v242
    v_mul_u32_u24 v243, 1280, v243
    v_lshl_add_u32 v242, v244, 7, v243
    s_add_u32 s62, s60, 0
    s_mul_i32 s62, s62, 12
    s_cmp_ge_u32 s62, 640
    s_cbranch_scc1 sequential_preLN__linear_attn_block__dense_activation_relu__prompt_kernel_tsk74
    s_min_u32 s62, s62, 628
    s_mul_i32 s62, s62, 1280
    s_add_u32 s62, s62, s61
    s_add_u32 s64, s8, s62
    s_addc_u32 s65, s9, 0
    global_load_dword v2, v242, s[64:65]
sequential_preLN__linear_attn_block__dense_activation_relu__prompt_kernel_tsk74:
    buffer_load_dwordx4 v[176:179], v235, s[56:59], s53 offen
    s_add_u32 s53, s53, 110592
    buffer_load_dwordx4 v[180:183], v235, s[56:59], s53 offen
    s_add_u32 s53, s53, 110592
    buffer_load_dwordx4 v[184:187], v235, s[56:59], s53 offen
    s_add_u32 s53, s53, 110592
    buffer_load_dwordx4 v[188:191], v235, s[56:59], s53 offen
    s_add_u32 s53, s53, 110592
    buffer_load_dwordx4 v[192:195], v235, s[56:59], s53 offen
    s_add_u32 s53, s53, 110592
    v_min_u32 v247, 55, v1
    v_mul_u32_u24 v246, 74, v247
    v_lshrrev_b32 v246, 10, v246
    v_mul_u32_u24 v245, 14, v246
    v_sub_u32 v247, v247, v245
    v_mul_u32_u24 v246, 3456, v246
    v_lshl_add_u32 v245, v247, 7, v246
    s_mul_i32 s30, s25, 1664
    v_mov_b64 v[216:217], 0
    v_mov_b64 v[218:219], 0
    v_mov_b64 v[220:221], 0
    v_mov_b64 v[222:223], 0
    s_waitcnt vmcnt(4)
    v_lshlrev_b32 v232, 16, v176
    v_and_b32 v233, 0xffff0000, v176
    v_pk_add_f32 v[216:217], v[216:217], v[232:233]
    v_lshlrev_b32 v232, 16, v177
    v_and_b32 v233, 0xffff0000, v177
    v_pk_add_f32 v[218:219], v[218:219], v[232:233]
    v_lshlrev_b32 v232, 16, v178
    v_and_b32 v233, 0xffff0000, v178
    v_pk_add_f32 v[220:221], v[220:221], v[232:233]
    v_lshlrev_b32 v232, 16, v179
    v_and_b32 v233, 0xffff0000, v179
    v_pk_add_f32 v[222:223], v[222:223], v[232:233]
    s_waitcnt vmcnt(3)
    v_lshlrev_b32 v232, 16, v180
    v_and_b32 v233, 0xffff0000, v180
    v_pk_add_f32 v[216:217], v[216:217], v[232:233]
    v_lshlrev_b32 v232, 16, v181
    v_and_b32 v233, 0xffff0000, v181
    v_pk_add_f32 v[218:219], v[218:219], v[232:233]
    v_lshlrev_b32 v232, 16, v182
    v_and_b32 v233, 0xffff0000, v182
    v_pk_add_f32 v[220:221], v[220:221], v[232:233]
    v_lshlrev_b32 v232, 16, v183
    v_and_b32 v233, 0xffff0000, v183
    v_pk_add_f32 v[222:223], v[222:223], v[232:233]
    s_waitcnt vmcnt(2)
    v_lshlrev_b32 v232, 16, v184
    v_and_b32 v233, 0xffff0000, v184
    v_pk_add_f32 v[216:217], v[216:217], v[232:233]
    v_lshlrev_b32 v232, 16, v185
    v_and_b32 v233, 0xffff0000, v185
    v_pk_add_f32 v[218:219], v[218:219], v[232:233]
    v_lshlrev_b32 v232, 16, v186
    v_and_b32 v233, 0xffff0000, v186
    v_pk_add_f32 v[220:221], v[220:221], v[232:233]
    v_lshlrev_b32 v232, 16, v187
    v_and_b32 v233, 0xffff0000, v187
    v_pk_add_f32 v[222:223], v[222:223], v[232:233]
    s_waitcnt vmcnt(1)
    v_lshlrev_b32 v232, 16, v188
    v_and_b32 v233, 0xffff0000, v188
    v_pk_add_f32 v[216:217], v[216:217], v[232:233]
    v_lshlrev_b32 v232, 16, v189
    v_and_b32 v233, 0xffff0000, v189
    v_pk_add_f32 v[218:219], v[218:219], v[232:233]
    v_lshlrev_b32 v232, 16, v190
    v_and_b32 v233, 0xffff0000, v190
    v_pk_add_f32 v[220:221], v[220:221], v[232:233]
    v_lshlrev_b32 v232, 16, v191
    v_and_b32 v233, 0xffff0000, v191
    v_pk_add_f32 v[222:223], v[222:223], v[232:233]
    s_waitcnt vmcnt(0)
    v_lshlrev_b32 v232, 16, v192
    v_and_b32 v233, 0xffff0000, v192
    v_pk_add_f32 v[216:217], v[216:217], v[232:233]
    v_lshlrev_b32 v232, 16, v193
    v_and_b32 v233, 0xffff0000, v193
    v_pk_add_f32 v[218:219], v[218:219], v[232:233]
    v_lshlrev_b32 v232, 16, v194
    v_and_b32 v233, 0xffff0000, v194
    v_pk_add_f32 v[220:221], v[220:221], v[232:233]
    v_lshlrev_b32 v232, 16, v195
    v_and_b32 v233, 0xffff0000, v195
    v_pk_add_f32 v[222:223], v[222:223], v[232:233]
    v_mov_b32 v176, v216
    v_mov_b32 v177, v217
    v_mov_b32 v178, v218
    v_mov_b32 v179, v219
    v_mov_b32 v180, v220
    v_mov_b32 v181, v221
    v_mov_b32 v182, v222
    v_mov_b32 v183, v223
    s_nop 0
    v_permlane16_swap_b32 v216, v176
    v_permlane16_swap_b32 v217, v177
    v_permlane16_swap_b32 v218, v178
    v_permlane16_swap_b32 v219, v179
    v_permlane16_swap_b32 v220, v180
    v_permlane16_swap_b32 v221, v181
    v_permlane16_swap_b32 v222, v182
    v_permlane16_swap_b32 v223, v183
    s_nop 0
    v_add_f32 v216, v216, v176
    v_add_f32 v217, v217, v177
    v_add_f32 v218, v218, v178
    v_add_f32 v219, v219, v179
    v_add_f32 v220, v220, v180
    v_add_f32 v221, v221, v181
    v_add_f32 v222, v222, v182
    v_add_f32 v223, v223, v183
    v_mov_b32 v176, v216
    v_mov_b32 v177, v217
    v_mov_b32 v178, v218
    v_mov_b32 v179, v219
    v_mov_b32 v180, v220
    v_mov_b32 v181, v221
    v_mov_b32 v182, v222
    v_mov_b32 v183, v223
    s_nop 0
    v_permlane32_swap_b32 v216, v176
    v_permlane32_swap_b32 v217, v177
    v_permlane32_swap_b32 v218, v178
    v_permlane32_swap_b32 v219, v179
    v_permlane32_swap_b32 v220, v180
    v_permlane32_swap_b32 v221, v181
    v_permlane32_swap_b32 v222, v182
    v_permlane32_swap_b32 v223, v183
    s_nop 0
    v_add_f32 v216, v216, v176
    v_add_f32 v217, v217, v177
    v_add_f32 v218, v218, v178
    v_add_f32 v219, v219, v179
    v_add_f32 v220, v220, v180
    v_add_f32 v221, v221, v181
    v_add_f32 v222, v222, v182
    v_add_f32 v223, v223, v183
    ds_write_b64 v236, v[216:217] offset:4096
    ds_write_b64 v236, v[218:219] offset:4104
    ds_write_b64 v236, v[220:221] offset:4112
    ds_write_b64 v236, v[222:223] offset:4120
    s_waitcnt lgkmcnt(0)
    s_barrier
    s_cmp_lg_u32 s22, 0
    s_cbranch_scc1 sequential_preLN__linear_attn_block__dense_activation_relu__prompt_kernel_csk75
    ds_read_b128 v[176:179], v237 offset:4096
    ds_read_b128 v[180:183], v237 offset:4608
    ds_read_b128 v[184:187], v237 offset:5120
    ds_read_b128 v[188:191], v237 offset:5632
    ds_read_b128 v[192:195], v237 offset:6144
    ds_read_b128 v[196:199], v237 offset:6656
    ds_read_b128 v[200:203], v237 offset:7168
    ds_read_b128 v[204:207], v237 offset:7680
    s_lshl_b32 s3, s32, 9
    s_add_u32 s3, s3, 49152
    s_waitcnt lgkmcnt(0)
    v_pk_add_f32 v[176:177], v[176:177], v[180:181]
    v_pk_add_f32 v[178:179], v[178:179], v[182:183]
    v_pk_add_f32 v[176:177], v[176:177], v[184:185]
    v_pk_add_f32 v[178:179], v[178:179], v[186:187]
    v_pk_add_f32 v[176:177], v[176:177], v[188:189]
    v_pk_add_f32 v[178:179], v[178:179], v[190:191]
    v_pk_add_f32 v[176:177], v[176:177], v[192:193]
    v_pk_add_f32 v[178:179], v[178:179], v[194:195]
    v_pk_add_f32 v[176:177], v[176:177], v[196:197]
    v_pk_add_f32 v[178:179], v[178:179], v[198:199]
    v_pk_add_f32 v[176:177], v[176:177], v[200:201]
    v_pk_add_f32 v[178:179], v[178:179], v[202:203]
    v_pk_add_f32 v[176:177], v[176:177], v[204:205]
    v_pk_add_f32 v[178:179], v[178:179], v[206:207]
    s_mov_b32 exec_hi, 0
    buffer_store_dwordx4 v[176:179], v237, s[40:43], s3 offen sc1
    s_mov_b64 exec, -1
    s_nop 1
sequential_preLN__linear_attn_block__dense_activation_relu__prompt_kernel_csk75:
    s_waitcnt vmcnt(0)
    s_mov_b32 s27, 1
    s_branch sequential_preLN__linear_attn_block__dense_activation_relu__prompt_kernel_role5
sequential_preLN__linear_attn_block__dense_activation_relu__prompt_kernel_cons2:
    s_and_b32 s28, s22, 1
    s_lshr_b32 s29, s22, 1
    s_mov_b32 s32, 897988541
    s_mov_b32 s33, 897988541
    s_and_b32 s48, s26, 3
    s_lshl_b32 s3, s24, 2
    s_add_u32 s48, s48, s3
    s_lshr_b32 s50, s26, 3
    s_sub_u32 s50, s50, 1
    s_max_i32 s50, s50, 0
    s_lshr_b32 s49, s26, 2
    s_lshl_b32 s3, s25, 2
    s_add_u32 s49, s49, s3
    s_lshl_b32 s3, s25, 1
    s_add_u32 s3, s3, 4
    s_cmp_eq_u32 s50, 1
    s_cselect_b32 s3, s3, 0
    s_sub_u32 s49, s49, s3
    s_and_b32 s3, s26, 7
    s_cmp_eq_u32 s50, 2
    s_cselect_b32 s49, s3, s49
    s_waitcnt lgkmcnt(0)
    s_add_u32 s36, s20, 16777216
    s_addc_u32 s37, s21, 0
    s_mov_b32 s38, 65536
    s_mov_b32 s39, 0x20000
    s_cmp_eq_u32 s50, 2
    s_cbranch_scc1 sequential_preLN__linear_attn_block__dense_activation_relu__prompt_kernel_sv280
    s_cmp_eq_u32 s50, 1
    s_cbranch_scc1 sequential_preLN__linear_attn_block__dense_activation_relu__prompt_kernel_qset78
    s_movk_i32 s51, 504
    s_lshl_b32 s30, s22, 2
    v_and_b32 v19, 15, v1
    v_subrev_u32 v14, s30, v19
    v_add_u32 v15, 16, v14
    v_lshrrev_b32 v19, 4, v1
    v_lshlrev_b32 v19, 2, v19
    v_subrev_u32 v16, s30, v19
    v_add_u32 v17, 16, v16
    v_mov_b32 v18, 2048
    v_mul_u32_u24 v19, 24, v16
    v_add_lshl_u32 v19, v19, v14, 2
    v_cmp_gt_u32 vcc, 20, v16
    v_cmp_gt_u32 s[52:53], 20, v14
    s_nop 1
    s_and_b64 vcc, vcc, s[52:53]
    s_nop 1
    v_cndmask_b32 v3, v18, v19, vcc
    v_mul_u32_u24 v19, 24, v16
    v_add_lshl_u32 v19, v19, v15, 2
    v_cmp_gt_u32 vcc, 20, v16
    v_cmp_gt_u32 s[52:53], 20, v15
    s_nop 1
    s_and_b64 vcc, vcc, s[52:53]
    s_nop 1
    v_cndmask_b32 v4, v18, v19, vcc
    v_mul_u32_u24 v19, 24, v17
    v_add_lshl_u32 v19, v19, v14, 2
    v_cmp_gt_u32 vcc, 20, v17
    v_cmp_gt_u32 s[52:53], 20, v14
    s_nop 1
    s_and_b64 vcc, vcc, s[52:53]
    s_nop 1
    v_cndmask_b32 v5, v18, v19, vcc
    v_mul_u32_u24 v19, 24, v17
    v_add_lshl_u32 v19, v19, v15, 2
    v_cmp_gt_u32 vcc, 20, v17
    v_cmp_gt_u32 s[52:53], 20, v15
    s_nop 1
    s_and_b64 vcc, vcc, s[52:53]
    s_nop 1
    v_cndmask_b32 v6, v18, v19, vcc
    v_lshlrev_b32 v19, 2, v14
    v_add_u32 v19, 1920, v19
    v_cmp_gt_u32 vcc, 16, v1
    v_cmp_gt_u32 s[52:53], 20, v14
    s_nop 1
    s_and_b64 vcc, vcc, s[52:53]
    s_nop 1
    v_cndmask_b32 v7, v18, v19, vcc
    v_lshlrev_b32 v19, 2, v15
    v_add_u32 v19, 1920, v19
    v_cmp_gt_u32 vcc, 16, v1
    v_cmp_gt_u32 s[52:53], 20, v15
    s_nop 1
    s_and_b64 vcc, vcc, s[52:53]
    s_nop 1
    v_cndmask_b32 v8, v18, v19, vcc
    s_mul_i32 s30, s22, 2560
    s_add_u32 s30, s30, 149504
    v_add_u32 v3, s30, v3
    v_add_u32 v4, s30, v4
    v_add_u32 v5, s30, v5
    v_add_u32 v6, s30, v6
    v_add_u32 v7, s30, v7
    v_add_u32 v8, s30, v8
    v_lshl_add_u32 v9, v1, 2, s30
    v_mov_b32 v18, 2146435072
    v_add_u32 v19, 0, v1
    v_mul_u32_u24 v14, 2731, v19
    v_lshrrev_b32 v14, 16, v14
    v_mul_u32_u24 v14, 24, v14
    v_sub_u32 v14, v19, v14
    v_cmp_gt_u32 vcc, 20, v14
    v_cmp_gt_u32 s[52:53], s51, v19
    v_lshlrev_b32 v19, 2, v19
    s_nop 0
    s_and_b64 vcc, vcc, s[52:53]
    s_nop 1
    v_cndmask_b32 v10, v18, v19, vcc
    v_add_u32 v19, 64, v1
    v_mul_u32_u24 v14, 2731, v19
    v_lshrrev_b32 v14, 16, v14
    v_mul_u32_u24 v14, 24, v14
    v_sub_u32 v14, v19, v14
    v_cmp_gt_u32 vcc, 20, v14
    v_cmp_gt_u32 s[52:53], s51, v19
    v_lshlrev_b32 v19, 2, v19
    s_nop 0
    s_and_b64 vcc, vcc, s[52:53]
    s_nop 1
    v_cndmask_b32 v11, v18, v19, vcc
    v_add_u32 v19, 128, v1
    v_mul_u32_u24 v14, 2731, v19
    v_lshrrev_b32 v14, 16, v14
    v_mul_u32_u24 v14, 24, v14
    v_sub_u32 v14, v19, v14
    v_cmp_gt_u32 vcc, 20, v14
    v_cmp_gt_u32 s[52:53], s51, v19
    v_lshlrev_b32 v19, 2, v19
    s_nop 0
    s_and_b64 vcc, vcc, s[52:53]
    s_nop 1
    v_cndmask_b32 v12, v18, v19, vcc
    v_add_u32 v19, 448, v1
    v_mul_u32_u24 v14, 2731, v19
    v_lshrrev_b32 v14, 16, v14
    v_mul_u32_u24 v14, 24, v14
    v_sub_u32 v14, v19, v14
    v_cmp_gt_u32 vcc, 20, v14
    v_cmp_gt_u32 s[52:53], s51, v19
    v_lshlrev_b32 v19, 2, v19
    s_nop 0
    s_and_b64 vcc, vcc, s[52:53]
    s_nop 1
    v_cndmask_b32 v13, v18, v19, vcc
    s_branch sequential_preLN__linear_attn_block__dense_activation_relu__prompt_kernel_setj79
sequential_preLN__linear_attn_block__dense_activation_relu__prompt_kernel_qset78:
    s_mul_i32 s30, s29, 20480
    s_mul_i32 s31, s28, 5120
    s_add_u32 s30, s30, s31
    v_lshlrev_b32 v11, 4, v1
    v_mov_b32 v12, 2146435072
    v_mov_b32 v13, 2146435072
    v_and_b32 v14, 3, v1
    v_lshlrev_b32 v14, 8, v14
    v_add_u32 v14, s30, v14
    v_lshrrev_b32 v16, 4, v1
    v_min_u32 v16, 2, v16
    v_bfe_u32 v15, v1, 2, 2
    v_lshl_add_u32 v15, v16, 3, v15
    v_cmp_gt_u32 vcc, 2, v16
    s_nop 1
    v_cndmask_b32 v19, 0, 4, vcc
    v_add_u32 v16, 0, v15
    v_lshrrev_b32 v3, 4, v16
    v_lshl_add_u32 v3, v3, 10, v14
    v_and_b32 v16, 15, v16
    v_lshl_add_u32 v3, v16, 4, v3
    v_add_u32 v16, 0, v15
    v_add_u32 v16, v16, v19
    v_lshrrev_b32 v4, 4, v16
    v_lshl_add_u32 v4, v4, 10, v14
    v_and_b32 v16, 15, v16
    v_lshl_add_u32 v4, v16, 4, v4
    v_add_u32 v16, 20, v15
    v_lshrrev_b32 v5, 4, v16
    v_lshl_add_u32 v5, v5, 10, v14
    v_and_b32 v16, 15, v16
    v_lshl_add_u32 v5, v16, 4, v5
    v_add_u32 v16, 20, v15
    v_add_u32 v16, v16, v19
    v_lshrrev_b32 v6, 4, v16
    v_lshl_add_u32 v6, v6, 10, v14
    v_and_b32 v16, 15, v16
    v_lshl_add_u32 v6, v16, 4, v6
    v_add_u32 v16, 40, v15
    v_lshrrev_b32 v7, 4, v16
    v_lshl_add_u32 v7, v7, 10, v14
    v_and_b32 v16, 15, v16
    v_lshl_add_u32 v7, v16, 4, v7
    v_add_u32 v16, 40, v15
    v_add_u32 v16, v16, v19
    v_lshrrev_b32 v8, 4, v16
    v_lshl_add_u32 v8, v8, 10, v14
    v_and_b32 v16, 15, v16
    v_lshl_add_u32 v8, v16, 4, v8
    v_add_u32 v16, 60, v15
    v_lshrrev_b32 v9, 4, v16
    v_lshl_add_u32 v9, v9, 10, v14
    v_and_b32 v16, 15, v16
    v_lshl_add_u32 v9, v16, 4, v9
    v_add_u32 v16, 60, v15
    v_add_u32 v16, v16, v19
    v_lshrrev_b32 v10, 4, v16
    v_lshl_add_u32 v10, v10, 10, v14
    v_and_b32 v16, 15, v16
    v_lshl_add_u32 v10, v16, 4, v10
sequential_preLN__linear_attn_block__dense_activation_relu__prompt_kernel_setj79:
    s_cmp_eq_u32 s50, 1
    s_cselect_b32 s51, 5, 3
    s_cselect_b32 s52, 3, 5
    s_mul_i32 s51, s51, s28
    s_add_u32 s52, s52, s51
    v_and_b32 v14, 15, v1
    v_lshlrev_b32 v14, 2, v14
    v_add_u32 v14, 148480, v14
    s_mul_i32 s30, s28, 320
    v_add_u32 v15, s30, v14
    s_lshl_b32 s30, s52, 6
    v_add_u32 v16, s30, v14
    s_lshl_b32 s30, s51, 6
    v_add_u32 v14, s30, v14
    v_lshrrev_b32 v17, 4, v1
    v_lshlrev_b32 v17, 4, v17
    s_lshl_b32 s30, s29, 8
    s_add_u32 s30, s30, 147456
    v_add_u32 v17, s30, v17
    v_lshlrev_b32 v20, 4, v1
    s_mul_i32 s30, s29, 20480
    s_lshl_b32 s31, s51, 10
    s_add_u32 s31, s31, s30
    v_add_u32 v18, s31, v20
    s_mul_i32 s31, s28, 5120
    s_add_u32 s31, s31, s30
    v_add_u32 v19, s31, v20
    s_lshl_b32 s30, s22, 10
    v_add_u32 v20, s30, v20
    s_cmp_ge_u32 s51, 5
    s_cselect_b32 s3, 2400, 0
    s_lshl_b32 s51, s51, 5
    s_add_u32 s51, s51, s3
    s_cmp_ge_u32 s52, 5
    s_cselect_b32 s3, 2400, 0
    s_lshl_b32 s52, s52, 5
    s_add_u32 s52, s52, s3
    v_mov_b32 v24, 0x3f803f80
    v_mov_b32 v25, 0x3f803f80
    v_mov_b32 v26, 0x3f803f80
    v_mov_b32 v27, 0x3f803f80
    s_mov_b32 s58, 4294918144
    s_mov_b32 s59, 4294905856
    v_and_b32 v180, 15, v1
    v_lshrrev_b32 v181, 4, v1
    v_and_b32 v182, 6, v180
    v_xor_b32 v182, v182, v181
    v_lshlrev_b32 v182, 4, v182
    v_lshl_add_u32 v183, v180, 7, v182
    s_mul_i32 s53, s29, 8192
    s_add_u32 s53, s53, 0
    v_add_u32 v183, s53, v183
    v_xor_b32 v184, 64, v183
    v_bfe_u32 v180, v1, 2, 3
    v_lshrrev_b32 v181, 5, v1
    v_mul_u32_u24 v181, 5120, v181
    v_mul_u32_u24 v182, 160, v180
    v_add_u32 v185, v181, v182
    v_and_b32 v182, 3, v1
    v_lshl_add_u32 v185, v182, 3, v185
    v_add_u32 v185, 65536, v185
    s_mul_i32 s53, s28, 2560
    v_add_u32 v186, s53, v185
    v_add_u32 v187, s52, v185
    v_add_u32 v185, s51, v185
    v_mov_b64 v[28:29], 0
    v_mov_b64 v[30:31], 0
    v_mov_b64 v[32:33], 0
    v_mov_b64 v[34:35], 0
    v_mov_b64 v[36:37], 0
    v_mov_b64 v[38:39], 0
    v_mov_b64 v[40:41], 0
    v_mov_b64 v[42:43], 0
    v_mov_b64 v[44:45], 0
    v_mov_b64 v[46:47], 0
    v_mov_b64 v[48:49], 0
    v_mov_b64 v[50:51], 0
    v_mov_b64 v[52:53], 0
    v_mov_b64 v[54:55], 0
    v_mov_b64 v[56:57], 0
    v_mov_b64 v[58:59], 0
    v_mov_b64 v[60:61], 0
    v_mov_b64 v[62:63], 0
    v_mov_b64 v[64:65], 0
    v_mov_b64 v[66:67], 0
    v_mov_b64 v[68:69], 0
    v_mov_b64 v[70:71], 0
    v_mov_b64 v[72:73], 0
    v_mov_b64 v[74:75], 0
    v_mov_b64 v[76:77], 0
    v_mov_b64 v[78:79], 0
    v_mov_b64 v[80:81], 0
    v_mov_b64 v[82:83], 0
    v_mov_b64 v[84:85], 0
    v_mov_b64 v[86:87], 0
    v_mov_b64 v[88:89], 0
    v_mov_b64 v[90:91], 0
    v_mov_b64 v[92:93], 0
    v_mov_b64 v[94:95], 0
    v_mov_b64 v[96:97], 0
    v_mov_b64 v[98:99], 0
    v_mov_b64 v[100:101], 0
    v_mov_b64 v[102:103], 0
    v_mov_b64 v[104:105], 0
    v_mov_b64 v[106:107], 0
    s_mov_b32 s55, 0
    s_mov_b32 s56, 0
    s_mov_b32 s57, 0
    s_mov_b32 s30, 1069066811
    s_mov_b32 s31, 1069066811
    s_barrier
    ds_read_b128 v[108:111], v183 offset:0
    ds_read_b128 v[112:115], v183 offset:2048
    ds_read_b128 v[116:119], v183 offset:4096
    ds_read_b128 v[120:123], v183 offset:6144
    ds_read_b64_tr_b16 v[140:141], v185 offset:0
    ds_read_b64_tr_b16 v[142:143], v185 offset:1280
    ds_read_b64_tr_b16 v[144:145], v185 offset:32
    ds_read_b64_tr_b16 v[146:147], v185 offset:1312
    ds_read_b64_tr_b16 v[148:149], v186 offset:64
    ds_read_b64_tr_b16 v[150:151], v186 offset:1344
    ds_read_b64_tr_b16 v[152:153], v187 offset:0
    ds_read_b64_tr_b16 v[154:155], v187 offset:1280
    ds_read_b64_tr_b16 v[156:157], v187 offset:32
    ds_read_b64_tr_b16 v[158:159], v187 offset:1312
sequential_preLN__linear_attn_block__dense_activation_relu__prompt_kernel_mm81:
    ds_read_b128 v[124:127], v184 offset:0
    s_waitcnt lgkmcnt(9)
    v_mfma_f32_16x16x32_bf16 v[28:31], v[108:111], v[140:143], v[28:31]
    ds_read_b128 v[128:131], v184 offset:2048
    v_mfma_f32_16x16x32_bf16 v[48:51], v[112:115], v[140:143], v[48:51]
    ds_read_b128 v[132:135], v184 offset:4096
    v_mfma_f32_16x16x32_bf16 v[68:71], v[116:119], v[140:143], v[68:71]
    ds_read_b128 v[136:139], v184 offset:6144
    v_mfma_f32_16x16x32_bf16 v[88:91], v[120:123], v[140:143], v[88:91]
    ds_read_b64_tr_b16 v[160:161], v185 offset:10240
    s_waitcnt lgkmcnt(11)
    v_mfma_f32_16x16x32_bf16 v[32:35], v[108:111], v[144:147], v[32:35]
    ds_read_b64_tr_b16 v[162:163], v185 offset:11520
    s_add_u32 s56, s56, 1
    s_cmp_eq_u32 s56, 4
    s_cselect_b32 s53, s58, 16384
    s_cselect_b32 s56, 0, s56
    v_add_u32 v183, s53, v183
    v_mfma_f32_16x16x32_bf16 v[52:55], v[112:115], v[144:147], v[52:55]
    ds_read_b64_tr_b16 v[164:165], v185 offset:10272
    v_mfma_f32_16x16x32_bf16 v[72:75], v[116:119], v[144:147], v[72:75]
    ds_read_b64_tr_b16 v[166:167], v185 offset:11552
    v_mfma_f32_16x16x32_bf16 v[92:95], v[120:123], v[144:147], v[92:95]
    ds_read_b64_tr_b16 v[168:169], v186 offset:10304
    s_waitcnt lgkmcnt(13)
    v_mfma_f32_16x16x32_bf16 v[36:39], v[108:111], v[148:151], v[36:39]
    ds_read_b64_tr_b16 v[170:171], v186 offset:11584
    v_mfma_f32_16x16x32_bf16 v[56:59], v[112:115], v[148:151], v[56:59]
    ds_read_b64_tr_b16 v[172:173], v187 offset:10240
    v_mfma_f32_16x16x32_bf16 v[76:79], v[116:119], v[148:151], v[76:79]
    ds_read_b64_tr_b16 v[174:175], v187 offset:11520
    s_add_u32 s57, s57, 1
    s_cmp_eq_u32 s57, 4
    s_cselect_b32 s54, s59, 20480
    s_cselect_b32 s57, 0, s57
    v_mfma_f32_16x16x32_bf16 v[96:99], v[120:123], v[148:151], v[96:99]
    ds_read_b64_tr_b16 v[176:177], v187 offset:10272
    s_waitcnt lgkmcnt(15)
    v_mfma_f32_16x16x32_bf16 v[40:43], v[108:111], v[152:155], v[40:43]
    ds_read_b64_tr_b16 v[178:179], v187 offset:11552
    v_mfma_f32_16x16x32_bf16 v[60:63], v[112:115], v[152:155], v[60:63]
    v_mfma_f32_16x16x32_bf16 v[80:83], v[116:119], v[152:155], v[80:83]
    v_mfma_f32_16x16x32_bf16 v[100:103], v[120:123], v[152:155], v[100:103]
    s_waitcnt lgkmcnt(14)
    v_mfma_f32_16x16x32_bf16 v[44:47], v[108:111], v[156:159], v[44:47]
    v_mfma_f32_16x16x32_bf16 v[64:67], v[112:115], v[156:159], v[64:67]
    v_mfma_f32_16x16x32_bf16 v[84:87], v[116:119], v[156:159], v[84:87]
    v_mfma_f32_16x16x32_bf16 v[104:107], v[120:123], v[156:159], v[104:107]
    s_waitcnt lgkmcnt(0)
    s_barrier
    v_add_u32 v185, s54, v185
    v_add_u32 v186, s54, v186
    v_add_u32 v187, s54, v187
    ds_read_b128 v[108:111], v183 offset:0
    s_waitcnt lgkmcnt(9)
    v_mfma_f32_16x16x32_bf16 v[28:31], v[124:127], v[160:163], v[28:31]
    ds_read_b128 v[112:115], v183 offset:2048
    v_mfma_f32_16x16x32_bf16 v[48:51], v[128:131], v[160:163], v[48:51]
    ds_read_b128 v[116:119], v183 offset:4096
    v_mfma_f32_16x16x32_bf16 v[68:71], v[132:135], v[160:163], v[68:71]
    ds_read_b128 v[120:123], v183 offset:6144
    v_mfma_f32_16x16x32_bf16 v[88:91], v[136:139], v[160:163], v[88:91]
    ds_read_b64_tr_b16 v[140:141], v185 offset:0
    s_waitcnt lgkmcnt(11)
    v_mfma_f32_16x16x32_bf16 v[32:35], v[124:127], v[164:167], v[32:35]
    ds_read_b64_tr_b16 v[142:143], v185 offset:1280
    v_mfma_f32_16x16x32_bf16 v[52:55], v[128:131], v[164:167], v[52:55]
    ds_read_b64_tr_b16 v[144:145], v185 offset:32
    v_mfma_f32_16x16x32_bf16 v[72:75], v[132:135], v[164:167], v[72:75]
    ds_read_b64_tr_b16 v[146:147], v185 offset:1312
    v_mfma_f32_16x16x32_bf16 v[92:95], v[136:139], v[164:167], v[92:95]
    v_add_u32 v184, s53, v184
    s_add_u32 s55, s55, 1
    s_cmp_lt_u32 s55, 10
    ds_read_b64_tr_b16 v[148:149], v186 offset:64
    s_waitcnt lgkmcnt(13)
    v_mfma_f32_16x16x32_bf16 v[36:39], v[124:127], v[168:171], v[36:39]
    ds_read_b64_tr_b16 v[150:151], v186 offset:1344
    v_mfma_f32_16x16x32_bf16 v[56:59], v[128:131], v[168:171], v[56:59]
    ds_read_b64_tr_b16 v[152:153], v187 offset:0
    v_mfma_f32_16x16x32_bf16 v[76:79], v[132:135], v[168:171], v[76:79]
    ds_read_b64_tr_b16 v[154:155], v187 offset:1280
    v_mfma_f32_16x16x32_bf16 v[96:99], v[136:139], v[168:171], v[96:99]
    ds_read_b64_tr_b16 v[156:157], v187 offset:32
    s_waitcnt lgkmcnt(15)
    v_mfma_f32_16x16x32_bf16 v[40:43], v[124:127], v[172:175], v[40:43]
    ds_read_b64_tr_b16 v[158:159], v187 offset:1312
    v_mfma_f32_16x16x32_bf16 v[60:63], v[128:131], v[172:175], v[60:63]
    v_mfma_f32_16x16x32_bf16 v[80:83], v[132:135], v[172:175], v[80:83]
    v_mfma_f32_16x16x32_bf16 v[100:103], v[136:139], v[172:175], v[100:103]
    s_waitcnt lgkmcnt(14)
    v_mfma_f32_16x16x32_bf16 v[44:47], v[124:127], v[176:179], v[44:47]
    v_mfma_f32_16x16x32_bf16 v[64:67], v[128:131], v[176:179], v[64:67]
    v_mfma_f32_16x16x32_bf16 v[84:87], v[132:135], v[176:179], v[84:87]
    v_mfma_f32_16x16x32_bf16 v[104:107], v[136:139], v[176:179], v[104:107]
    s_cbranch_scc1 sequential_preLN__linear_attn_block__dense_activation_relu__prompt_kernel_mm81
sequential_preLN__linear_attn_block__dense_activation_relu__prompt_kernel_mmdone82:
    s_waitcnt lgkmcnt(0)
    s_nop 7
    s_barrier
    ds_read_b32 v110, v14 offset:0
    ds_read_b32 v112, v14 offset:64
    ds_read_b32 v114, v15 offset:128
    ds_read_b32 v116, v16 offset:0
    ds_read_b32 v118, v16 offset:64
    ds_read_b128 v[120:123], v17 offset:0
    ds_read_b128 v[124:127], v17 offset:64
    ds_read_b128 v[128:131], v17 offset:128
    ds_read_b128 v[132:135], v17 offset:192
    ds_read_b128 v[136:139], v17 offset:512
    ds_read_b128 v[140:143], v17 offset:576
    ds_read_b128 v[144:147], v17 offset:640
    ds_read_b128 v[148:151], v17 offset:704
    s_waitcnt lgkmcnt(7)
    v_pk_fma_f32 v[28:29], v[120:121], v[110:111], v[28:29] op_sel_hi:[1,0,1] neg_lo:[1,0,0] neg_hi:[1,0,0]
    v_pk_fma_f32 v[30:31], v[122:123], v[110:111], v[30:31] op_sel_hi:[1,0,1] neg_lo:[1,0,0] neg_hi:[1,0,0]
    v_pk_fma_f32 v[32:33], v[120:121], v[112:113], v[32:33] op_sel_hi:[1,0,1] neg_lo:[1,0,0] neg_hi:[1,0,0]
    v_pk_fma_f32 v[34:35], v[122:123], v[112:113], v[34:35] op_sel_hi:[1,0,1] neg_lo:[1,0,0] neg_hi:[1,0,0]
    v_pk_fma_f32 v[36:37], v[120:121], v[114:115], v[36:37] op_sel_hi:[1,0,1] neg_lo:[1,0,0] neg_hi:[1,0,0]
    v_pk_fma_f32 v[38:39], v[122:123], v[114:115], v[38:39] op_sel_hi:[1,0,1] neg_lo:[1,0,0] neg_hi:[1,0,0]
    v_pk_fma_f32 v[40:41], v[120:121], v[116:117], v[40:41] op_sel_hi:[1,0,1] neg_lo:[1,0,0] neg_hi:[1,0,0]
    v_pk_fma_f32 v[42:43], v[122:123], v[116:117], v[42:43] op_sel_hi:[1,0,1] neg_lo:[1,0,0] neg_hi:[1,0,0]
    v_pk_fma_f32 v[44:45], v[120:121], v[118:119], v[44:45] op_sel_hi:[1,0,1] neg_lo:[1,0,0] neg_hi:[1,0,0]
    v_pk_fma_f32 v[46:47], v[122:123], v[118:119], v[46:47] op_sel_hi:[1,0,1] neg_lo:[1,0,0] neg_hi:[1,0,0]
    s_waitcnt lgkmcnt(6)
    v_pk_fma_f32 v[48:49], v[124:125], v[110:111], v[48:49] op_sel_hi:[1,0,1] neg_lo:[1,0,0] neg_hi:[1,0,0]
    v_pk_fma_f32 v[50:51], v[126:127], v[110:111], v[50:51] op_sel_hi:[1,0,1] neg_lo:[1,0,0] neg_hi:[1,0,0]
    v_pk_fma_f32 v[52:53], v[124:125], v[112:113], v[52:53] op_sel_hi:[1,0,1] neg_lo:[1,0,0] neg_hi:[1,0,0]
    v_pk_fma_f32 v[54:55], v[126:127], v[112:113], v[54:55] op_sel_hi:[1,0,1] neg_lo:[1,0,0] neg_hi:[1,0,0]
    v_pk_fma_f32 v[56:57], v[124:125], v[114:115], v[56:57] op_sel_hi:[1,0,1] neg_lo:[1,0,0] neg_hi:[1,0,0]
    v_pk_fma_f32 v[58:59], v[126:127], v[114:115], v[58:59] op_sel_hi:[1,0,1] neg_lo:[1,0,0] neg_hi:[1,0,0]
    v_pk_fma_f32 v[60:61], v[124:125], v[116:117], v[60:61] op_sel_hi:[1,0,1] neg_lo:[1,0,0] neg_hi:[1,0,0]
    v_pk_fma_f32 v[62:63], v[126:127], v[116:117], v[62:63] op_sel_hi:[1,0,1] neg_lo:[1,0,0] neg_hi:[1,0,0]
    v_pk_fma_f32 v[64:65], v[124:125], v[118:119], v[64:65] op_sel_hi:[1,0,1] neg_lo:[1,0,0] neg_hi:[1,0,0]
    v_pk_fma_f32 v[66:67], v[126:127], v[118:119], v[66:67] op_sel_hi:[1,0,1] neg_lo:[1,0,0] neg_hi:[1,0,0]
    s_waitcnt lgkmcnt(5)
    v_pk_fma_f32 v[68:69], v[128:129], v[110:111], v[68:69] op_sel_hi:[1,0,1] neg_lo:[1,0,0] neg_hi:[1,0,0]
    v_pk_fma_f32 v[70:71], v[130:131], v[110:111], v[70:71] op_sel_hi:[1,0,1] neg_lo:[1,0,0] neg_hi:[1,0,0]
    v_pk_fma_f32 v[72:73], v[128:129], v[112:113], v[72:73] op_sel_hi:[1,0,1] neg_lo:[1,0,0] neg_hi:[1,0,0]
    v_pk_fma_f32 v[74:75], v[130:131], v[112:113], v[74:75] op_sel_hi:[1,0,1] neg_lo:[1,0,0] neg_hi:[1,0,0]
    v_pk_fma_f32 v[76:77], v[128:129], v[114:115], v[76:77] op_sel_hi:[1,0,1] neg_lo:[1,0,0] neg_hi:[1,0,0]
    v_pk_fma_f32 v[78:79], v[130:131], v[114:115], v[78:79] op_sel_hi:[1,0,1] neg_lo:[1,0,0] neg_hi:[1,0,0]
    v_pk_fma_f32 v[80:81], v[128:129], v[116:117], v[80:81] op_sel_hi:[1,0,1] neg_lo:[1,0,0] neg_hi:[1,0,0]
    v_pk_fma_f32 v[82:83], v[130:131], v[116:117], v[82:83] op_sel_hi:[1,0,1] neg_lo:[1,0,0] neg_hi:[1,0,0]
    v_pk_fma_f32 v[84:85], v[128:129], v[118:119], v[84:85] op_sel_hi:[1,0,1] neg_lo:[1,0,0] neg_hi:[1,0,0]
    v_pk_fma_f32 v[86:87], v[130:131], v[118:119], v[86:87] op_sel_hi:[1,0,1] neg_lo:[1,0,0] neg_hi:[1,0,0]
    s_waitcnt lgkmcnt(4)
    v_pk_fma_f32 v[88:89], v[132:133], v[110:111], v[88:89] op_sel_hi:[1,0,1] neg_lo:[1,0,0] neg_hi:[1,0,0]
    v_pk_fma_f32 v[90:91], v[134:135], v[110:111], v[90:91] op_sel_hi:[1,0,1] neg_lo:[1,0,0] neg_hi:[1,0,0]
    v_pk_fma_f32 v[92:93], v[132:133], v[112:113], v[92:93] op_sel_hi:[1,0,1] neg_lo:[1,0,0] neg_hi:[1,0,0]
    v_pk_fma_f32 v[94:95], v[134:135], v[112:113], v[94:95] op_sel_hi:[1,0,1] neg_lo:[1,0,0] neg_hi:[1,0,0]
    v_pk_fma_f32 v[96:97], v[132:133], v[114:115], v[96:97] op_sel_hi:[1,0,1] neg_lo:[1,0,0] neg_hi:[1,0,0]
    v_pk_fma_f32 v[98:99], v[134:135], v[114:115], v[98:99] op_sel_hi:[1,0,1] neg_lo:[1,0,0] neg_hi:[1,0,0]
    v_pk_fma_f32 v[100:101], v[132:133], v[116:117], v[100:101] op_sel_hi:[1,0,1] neg_lo:[1,0,0] neg_hi:[1,0,0]
    v_pk_fma_f32 v[102:103], v[134:135], v[116:117], v[102:103] op_sel_hi:[1,0,1] neg_lo:[1,0,0] neg_hi:[1,0,0]
    v_pk_fma_f32 v[104:105], v[132:133], v[118:119], v[104:105] op_sel_hi:[1,0,1] neg_lo:[1,0,0] neg_hi:[1,0,0]
    v_pk_fma_f32 v[106:107], v[134:135], v[118:119], v[106:107] op_sel_hi:[1,0,1] neg_lo:[1,0,0] neg_hi:[1,0,0]
    s_waitcnt lgkmcnt(0)
    v_pk_mul_f32 v[152:153], v[136:137], s[30:31]
    v_pk_mul_f32 v[154:155], v[138:139], s[30:31]
    v_pk_mul_f32 v[156:157], v[140:141], s[30:31]
    v_pk_mul_f32 v[158:159], v[142:143], s[30:31]
    v_pk_mul_f32 v[160:161], v[144:145], s[30:31]
    v_pk_mul_f32 v[162:163], v[146:147], s[30:31]
    v_pk_mul_f32 v[164:165], v[148:149], s[30:31]
    v_pk_mul_f32 v[166:167], v[150:151], s[30:31]
    v_pk_mul_f32 v[108:109], v[28:29], v[152:153]
    v_pk_fma_f32 v[28:29], v[28:29], v[136:137], 1.0 op_sel_hi:[1,1,0]
    v_exp_f32_e64 v108, v108 clamp
    v_exp_f32_e64 v109, v109 clamp
    v_max_f32 v28, v28, v108
    v_max_f32 v29, v29, v109
    v_pk_add_f32 v[28:29], v[28:29], s[32:33]
    v_pk_mul_f32 v[108:109], v[30:31], v[154:155]
    v_pk_fma_f32 v[30:31], v[30:31], v[138:139], 1.0 op_sel_hi:[1,1,0]
    v_exp_f32_e64 v108, v108 clamp
    v_exp_f32_e64 v109, v109 clamp
    v_max_f32 v30, v30, v108
    v_max_f32 v31, v31, v109
    v_pk_add_f32 v[30:31], v[30:31], s[32:33]
    v_pk_mul_f32 v[108:109], v[48:49], v[156:157]
    v_pk_fma_f32 v[48:49], v[48:49], v[140:141], 1.0 op_sel_hi:[1,1,0]
    v_exp_f32_e64 v108, v108 clamp
    v_exp_f32_e64 v109, v109 clamp
    v_max_f32 v48, v48, v108
    v_max_f32 v49, v49, v109
    v_pk_add_f32 v[48:49], v[48:49], s[32:33]
    v_pk_mul_f32 v[108:109], v[50:51], v[158:159]
    v_pk_fma_f32 v[50:51], v[50:51], v[142:143], 1.0 op_sel_hi:[1,1,0]
    v_exp_f32_e64 v108, v108 clamp
    v_exp_f32_e64 v109, v109 clamp
    v_max_f32 v50, v50, v108
    v_max_f32 v51, v51, v109
    v_pk_add_f32 v[50:51], v[50:51], s[32:33]
    v_cvt_pk_bf16_f32 v168, v28, v29
    v_cvt_pk_bf16_f32 v169, v30, v31
    v_cvt_pk_bf16_f32 v170, v48, v49
    v_cvt_pk_bf16_f32 v171, v50, v51
    ds_write_b128 v18, v[168:171] offset:0
    v_pk_mul_f32 v[108:109], v[68:69], v[160:161]
    v_pk_fma_f32 v[68:69], v[68:69], v[144:145], 1.0 op_sel_hi:[1,1,0]
    v_exp_f32_e64 v108, v108 clamp
    v_exp_f32_e64 v109, v109 clamp
    v_max_f32 v68, v68, v108
    v_max_f32 v69, v69, v109
    v_pk_add_f32 v[68:69], v[68:69], s[32:33]
    v_pk_mul_f32 v[108:109], v[70:71], v[162:163]
    v_pk_fma_f32 v[70:71], v[70:71], v[146:147], 1.0 op_sel_hi:[1,1,0]
    v_exp_f32_e64 v108, v108 clamp
    v_exp_f32_e64 v109, v109 clamp
    v_max_f32 v70, v70, v108
    v_max_f32 v71, v71, v109
    v_pk_add_f32 v[70:71], v[70:71], s[32:33]
    v_pk_mul_f32 v[108:109], v[88:89], v[164:165]
    v_pk_fma_f32 v[88:89], v[88:89], v[148:149], 1.0 op_sel_hi:[1,1,0]
    v_exp_f32_e64 v108, v108 clamp
    v_exp_f32_e64 v109, v109 clamp
    v_max_f32 v88, v88, v108
    v_max_f32 v89, v89, v109
    v_pk_add_f32 v[88:89], v[88:89], s[32:33]
    v_pk_mul_f32 v[108:109], v[90:91], v[166:167]
    v_pk_fma_f32 v[90:91], v[90:91], v[150:151], 1.0 op_sel_hi:[1,1,0]
    v_exp_f32_e64 v108, v108 clamp
    v_exp_f32_e64 v109, v109 clamp
    v_max_f32 v90, v90, v108
    v_max_f32 v91, v91, v109
    v_pk_add_f32 v[90:91], v[90:91], s[32:33]
    v_cvt_pk_bf16_f32 v172, v68, v69
    v_cvt_pk_bf16_f32 v173, v70, v71
    v_cvt_pk_bf16_f32 v174, v88, v89
    v_cvt_pk_bf16_f32 v175, v90, v91
    ds_write_b128 v18, v[172:175] offset:10240
    v_pk_mul_f32 v[108:109], v[32:33], v[152:153]
    v_pk_fma_f32 v[32:33], v[32:33], v[136:137], 1.0 op_sel_hi:[1,1,0]
    v_exp_f32_e64 v108, v108 clamp
    v_exp_f32_e64 v109, v109 clamp
    v_max_f32 v32, v32, v108
    v_max_f32 v33, v33, v109
    v_pk_add_f32 v[32:33], v[32:33], s[32:33]
    v_pk_mul_f32 v[108:109], v[34:35], v[154:155]
    v_pk_fma_f32 v[34:35], v[34:35], v[138:139], 1.0 op_sel_hi:[1,1,0]
    v_exp_f32_e64 v108, v108 clamp
    v_exp_f32_e64 v109, v109 clamp
    v_max_f32 v34, v34, v108
    v_max_f32 v35, v35, v109
    v_pk_add_f32 v[34:35], v[34:35], s[32:33]
    v_pk_mul_f32 v[108:109], v[52:53], v[156:157]
    v_pk_fma_f32 v[52:53], v[52:53], v[140:141], 1.0 op_sel_hi:[1,1,0]
    v_exp_f32_e64 v108, v108 clamp
    v_exp_f32_e64 v109, v109 clamp
    v_max_f32 v52, v52, v108
    v_max_f32 v53, v53, v109
    v_pk_add_f32 v[52:53], v[52:53], s[32:33]
    v_pk_mul_f32 v[108:109], v[54:55], v[158:159]
    v_pk_fma_f32 v[54:55], v[54:55], v[142:143], 1.0 op_sel_hi:[1,1,0]
    v_exp_f32_e64 v108, v108 clamp
    v_exp_f32_e64 v109, v109 clamp
    v_max_f32 v54, v54, v108
    v_max_f32 v55, v55, v109
    v_pk_add_f32 v[54:55], v[54:55], s[32:33]
    v_cvt_pk_bf16_f32 v168, v32, v33
    v_cvt_pk_bf16_f32 v169, v34, v35
    v_cvt_pk_bf16_f32 v170, v52, v53
    v_cvt_pk_bf16_f32 v171, v54, v55
    ds_write_b128 v18, v[168:171] offset:1024
    v_pk_mul_f32 v[108:109], v[72:73], v[160:161]
    v_pk_fma_f32 v[72:73], v[72:73], v[144:145], 1.0 op_sel_hi:[1,1,0]
    v_exp_f32_e64 v108, v108 clamp
    v_exp_f32_e64 v109, v109 clamp
    v_max_f32 v72, v72, v108
    v_max_f32 v73, v73, v109
    v_pk_add_f32 v[72:73], v[72:73], s[32:33]
    v_pk_mul_f32 v[108:109], v[74:75], v[162:163]
    v_pk_fma_f32 v[74:75], v[74:75], v[146:147], 1.0 op_sel_hi:[1,1,0]
    v_exp_f32_e64 v108, v108 clamp
    v_exp_f32_e64 v109, v109 clamp
    v_max_f32 v74, v74, v108
    v_max_f32 v75, v75, v109
    v_pk_add_f32 v[74:75], v[74:75], s[32:33]
    v_pk_mul_f32 v[108:109], v[92:93], v[164:165]
    v_pk_fma_f32 v[92:93], v[92:93], v[148:149], 1.0 op_sel_hi:[1,1,0]
    v_exp_f32_e64 v108, v108 clamp
    v_exp_f32_e64 v109, v109 clamp
    v_max_f32 v92, v92, v108
    v_max_f32 v93, v93, v109
    v_pk_add_f32 v[92:93], v[92:93], s[32:33]
    v_pk_mul_f32 v[108:109], v[94:95], v[166:167]
    v_pk_fma_f32 v[94:95], v[94:95], v[150:151], 1.0 op_sel_hi:[1,1,0]
    v_exp_f32_e64 v108, v108 clamp
    v_exp_f32_e64 v109, v109 clamp
    v_max_f32 v94, v94, v108
    v_max_f32 v95, v95, v109
    v_pk_add_f32 v[94:95], v[94:95], s[32:33]
    v_cvt_pk_bf16_f32 v172, v72, v73
    v_cvt_pk_bf16_f32 v173, v74, v75
    v_cvt_pk_bf16_f32 v174, v92, v93
    v_cvt_pk_bf16_f32 v175, v94, v95
    ds_write_b128 v18, v[172:175] offset:11264
    s_cmp_eq_u32 s50, 1
    s_cbranch_scc1 sequential_preLN__linear_attn_block__dense_activation_relu__prompt_kernel_consq76
    v_pk_mul_f32 v[40:41], v[40:41], v[136:137]
    v_pk_mul_f32 v[42:43], v[42:43], v[138:139]
    v_pk_mul_f32 v[60:61], v[60:61], v[140:141]
    v_pk_mul_f32 v[62:63], v[62:63], v[142:143]
    v_cvt_pk_bf16_f32 v168, v40, v41
    v_cvt_pk_bf16_f32 v169, v42, v43
    v_cvt_pk_bf16_f32 v170, v60, v61
    v_cvt_pk_bf16_f32 v171, v62, v63
    ds_write_b128 v18, v[168:171] offset:5120
    v_pk_mul_f32 v[80:81], v[80:81], v[144:145]
    v_pk_mul_f32 v[82:83], v[82:83], v[146:147]
    v_pk_mul_f32 v[100:101], v[100:101], v[148:149]
    v_pk_mul_f32 v[102:103], v[102:103], v[150:151]
    v_cvt_pk_bf16_f32 v172, v80, v81
    v_cvt_pk_bf16_f32 v173, v82, v83
    v_cvt_pk_bf16_f32 v174, v100, v101
    v_cvt_pk_bf16_f32 v175, v102, v103
    ds_write_b128 v18, v[172:175] offset:15360
    v_pk_mul_f32 v[44:45], v[44:45], v[136:137]
    v_pk_mul_f32 v[46:47], v[46:47], v[138:139]
    v_pk_mul_f32 v[64:65], v[64:65], v[140:141]
    v_pk_mul_f32 v[66:67], v[66:67], v[142:143]
    v_cvt_pk_bf16_f32 v168, v44, v45
    v_cvt_pk_bf16_f32 v169, v46, v47
    v_cvt_pk_bf16_f32 v170, v64, v65
    v_cvt_pk_bf16_f32 v171, v66, v67
    ds_write_b128 v18, v[168:171] offset:6144
    v_pk_mul_f32 v[84:85], v[84:85], v[144:145]
    v_pk_mul_f32 v[86:87], v[86:87], v[146:147]
    v_pk_mul_f32 v[104:105], v[104:105], v[148:149]
    v_pk_mul_f32 v[106:107], v[106:107], v[150:151]
    v_cvt_pk_bf16_f32 v172, v84, v85
    v_cvt_pk_bf16_f32 v173, v86, v87
    v_cvt_pk_bf16_f32 v174, v104, v105
    v_cvt_pk_bf16_f32 v175, v106, v107
    ds_write_b128 v18, v[172:175] offset:16384
    s_cmp_eq_u32 s28, 1
    s_cbranch_scc1 sequential_preLN__linear_attn_block__dense_activation_relu__prompt_kernel_vpath83
    v_pk_mul_f32 v[108:109], v[36:37], v[152:153]
    v_pk_fma_f32 v[36:37], v[36:37], v[136:137], 1.0 op_sel_hi:[1,1,0]
    v_exp_f32_e64 v108, v108 clamp
    v_exp_f32_e64 v109, v109 clamp
    v_max_f32 v36, v36, v108
    v_max_f32 v37, v37, v109
    v_pk_add_f32 v[36:37], v[36:37], s[32:33]
    v_pk_mul_f32 v[108:109], v[38:39], v[154:155]
    v_pk_fma_f32 v[38:39], v[38:39], v[138:139], 1.0 op_sel_hi:[1,1,0]
    v_exp_f32_e64 v108, v108 clamp
    v_exp_f32_e64 v109, v109 clamp
    v_max_f32 v38, v38, v108
    v_max_f32 v39, v39, v109
    v_pk_add_f32 v[38:39], v[38:39], s[32:33]
    v_pk_mul_f32 v[108:109], v[56:57], v[156:157]
    v_pk_fma_f32 v[56:57], v[56:57], v[140:141], 1.0 op_sel_hi:[1,1,0]
    v_exp_f32_e64 v108, v108 clamp
    v_exp_f32_e64 v109, v109 clamp
    v_max_f32 v56, v56, v108
    v_max_f32 v57, v57, v109
    v_pk_add_f32 v[56:57], v[56:57], s[32:33]
    v_pk_mul_f32 v[108:109], v[58:59], v[158:159]
    v_pk_fma_f32 v[58:59], v[58:59], v[142:143], 1.0 op_sel_hi:[1,1,0]
    v_exp_f32_e64 v108, v108 clamp
    v_exp_f32_e64 v109, v109 clamp
    v_max_f32 v58, v58, v108
    v_max_f32 v59, v59, v109
    v_pk_add_f32 v[58:59], v[58:59], s[32:33]
    v_cvt_pk_bf16_f32 v168, v36, v37
    v_cvt_pk_bf16_f32 v169, v38, v39
    v_cvt_pk_bf16_f32 v170, v56, v57
    v_cvt_pk_bf16_f32 v171, v58, v59
    ds_write_b128 v19, v[168:171] offset:2048
    v_pk_mul_f32 v[108:109], v[76:77], v[160:161]
    v_pk_fma_f32 v[76:77], v[76:77], v[144:145], 1.0 op_sel_hi:[1,1,0]
    v_exp_f32_e64 v108, v108 clamp
    v_exp_f32_e64 v109, v109 clamp
    v_max_f32 v76, v76, v108
    v_max_f32 v77, v77, v109
    v_pk_add_f32 v[76:77], v[76:77], s[32:33]
    v_pk_mul_f32 v[108:109], v[78:79], v[162:163]
    v_pk_fma_f32 v[78:79], v[78:79], v[146:147], 1.0 op_sel_hi:[1,1,0]
    v_exp_f32_e64 v108, v108 clamp
    v_exp_f32_e64 v109, v109 clamp
    v_max_f32 v78, v78, v108
    v_max_f32 v79, v79, v109
    v_pk_add_f32 v[78:79], v[78:79], s[32:33]
    v_pk_mul_f32 v[108:109], v[96:97], v[164:165]
    v_pk_fma_f32 v[96:97], v[96:97], v[148:149], 1.0 op_sel_hi:[1,1,0]
    v_exp_f32_e64 v108, v108 clamp
    v_exp_f32_e64 v109, v109 clamp
    v_max_f32 v96, v96, v108
    v_max_f32 v97, v97, v109
    v_pk_add_f32 v[96:97], v[96:97], s[32:33]
    v_pk_mul_f32 v[108:109], v[98:99], v[166:167]
    v_pk_fma_f32 v[98:99], v[98:99], v[150:151], 1.0 op_sel_hi:[1,1,0]
    v_exp_f32_e64 v108, v108 clamp
    v_exp_f32_e64 v109, v109 clamp
    v_max_f32 v98, v98, v108
    v_max_f32 v99, v99, v109
    v_pk_add_f32 v[98:99], v[98:99], s[32:33]
    v_cvt_pk_bf16_f32 v172, v76, v77
    v_cvt_pk_bf16_f32 v173, v78, v79
    v_cvt_pk_bf16_f32 v174, v96, v97
    v_cvt_pk_bf16_f32 v175, v98, v99
    ds_write_b128 v19, v[172:175] offset:12288
    s_branch sequential_preLN__linear_attn_block__dense_activation_relu__prompt_kernel_vjoin84
sequential_preLN__linear_attn_block__dense_activation_relu__prompt_kernel_vpath83:
    v_pk_mul_f32 v[36:37], v[36:37], v[136:137]
    v_pk_mul_f32 v[38:39], v[38:39], v[138:139]
    v_pk_mul_f32 v[56:57], v[56:57], v[140:141]
    v_pk_mul_f32 v[58:59], v[58:59], v[142:143]
    v_cvt_pk_bf16_f32 v168, v36, v37
    v_cvt_pk_bf16_f32 v169, v38, v39
    v_cvt_pk_bf16_f32 v170, v56, v57
    v_cvt_pk_bf16_f32 v171, v58, v59
    ds_write_b128 v19, v[168:171] offset:2048
    v_pk_mul_f32 v[76:77], v[76:77], v[144:145]
    v_pk_mul_f32 v[78:79], v[78:79], v[146:147]
    v_pk_mul_f32 v[96:97], v[96:97], v[148:149]
    v_pk_mul_f32 v[98:99], v[98:99], v[150:151]
    v_cvt_pk_bf16_f32 v172, v76, v77
    v_cvt_pk_bf16_f32 v173, v78, v79
    v_cvt_pk_bf16_f32 v174, v96, v97
    v_cvt_pk_bf16_f32 v175, v98, v99
    ds_write_b128 v19, v[172:175] offset:12288
sequential_preLN__linear_attn_block__dense_activation_relu__prompt_kernel_vjoin84:
    s_lshl_b32 s30, s49, 2
    s_add_u32 s30, s30, s22
    s_lshl_b32 s30, s30, 11
    s_waitcnt lgkmcnt(0)
    s_barrier
    ds_read_b128 v[28:31], v20 offset:0
    ds_read_b128 v[32:35], v20 offset:1024
    ds_read_b128 v[36:39], v20 offset:5120
    ds_read_b128 v[40:43], v20 offset:6144
    ds_read_b128 v[44:47], v20 offset:10240
    ds_read_b128 v[48:51], v20 offset:11264
    ds_read_b128 v[52:55], v20 offset:15360
    ds_read_b128 v[56:59], v20 offset:16384
    ds_read_b128 v[60:63], v20 offset:20480
    ds_read_b128 v[64:67], v20 offset:21504
    ds_read_b128 v[68:71], v20 offset:25600
    ds_read_b128 v[72:75], v20 offset:26624
    ds_read_b128 v[76:79], v20 offset:30720
    ds_read_b128 v[80:83], v20 offset:31744
    ds_read_b128 v[84:87], v20 offset:35840
    s_waitcnt lgkmcnt(11)
    ds_read_b128 v[88:91], v20 offset:36864
    s_waitcnt lgkmcnt(12)
    v_mfma_f32_16x16x32_bf16 v[92:95], v[36:39], v[28:31], 0
    v_mfma_f32_16x16x32_bf16 v[96:99], v[36:39], v[32:35], 0
    v_mfma_f32_16x16x32_bf16 v[100:103], v[40:43], v[28:31], 0
    v_mfma_f32_16x16x32_bf16 v[104:107], v[40:43], v[32:35], 0
    v_mfma_f32_16x16x32_bf16 v[176:179], v[24:27], v[28:31], 0
    v_mfma_f32_16x16x32_bf16 v[180:183], v[24:27], v[32:35], 0
    s_waitcnt lgkmcnt(8)
    v_mfma_f32_16x16x32_bf16 v[92:95], v[52:55], v[44:47], v[92:95]
    v_mfma_f32_16x16x32_bf16 v[96:99], v[52:55], v[48:51], v[96:99]
    v_mfma_f32_16x16x32_bf16 v[100:103], v[56:59], v[44:47], v[100:103]
    v_mfma_f32_16x16x32_bf16 v[104:107], v[56:59], v[48:51], v[104:107]
    v_mfma_f32_16x16x32_bf16 v[176:179], v[24:27], v[44:47], v[176:179]
    v_mfma_f32_16x16x32_bf16 v[180:183], v[24:27], v[48:51], v[180:183]
    s_waitcnt lgkmcnt(4)
    v_mfma_f32_16x16x32_bf16 v[92:95], v[68:71], v[60:63], v[92:95]
    v_mfma_f32_16x16x32_bf16 v[96:99], v[68:71], v[64:67], v[96:99]
    v_mfma_f32_16x16x32_bf16 v[100:103], v[72:75], v[60:63], v[100:103]
    v_mfma_f32_16x16x32_bf16 v[104:107], v[72:75], v[64:67], v[104:107]
    v_mfma_f32_16x16x32_bf16 v[176:179], v[24:27], v[60:63], v[176:179]
    v_mfma_f32_16x16x32_bf16 v[180:183], v[24:27], v[64:67], v[180:183]
    s_waitcnt lgkmcnt(0)
    v_mfma_f32_16x16x32_bf16 v[92:95], v[84:87], v[76:79], v[92:95]
    v_mfma_f32_16x16x32_bf16 v[96:99], v[84:87], v[80:83], v[96:99]
    v_mfma_f32_16x16x32_bf16 v[100:103], v[88:91], v[76:79], v[100:103]
    v_mfma_f32_16x16x32_bf16 v[104:107], v[88:91], v[80:83], v[104:107]
    v_mfma_f32_16x16x32_bf16 v[176:179], v[24:27], v[76:79], v[176:179]
    v_mfma_f32_16x16x32_bf16 v[180:183], v[24:27], v[80:83], v[180:183]
    s_nop 3
    ds_write_b32 v3, v92 offset:0
    ds_write_b32 v3, v93 offset:96
    ds_write_b32 v3, v94 offset:192
    ds_write_b32 v3, v95 offset:288
    ds_write_b32 v4, v96 offset:0
    ds_write_b32 v4, v97 offset:96
    ds_write_b32 v4, v98 offset:192
    ds_write_b32 v4, v99 offset:288
    ds_write_b32 v5, v100 offset:0
    ds_write_b32 v5, v101 offset:96
    ds_write_b32 v5, v102 offset:192
    ds_write_b32 v5, v103 offset:288
    s_waitcnt lgkmcnt(6)
    ds_write_b32 v6, v104 offset:0
    ds_write_b32 v6, v105 offset:96
    ds_write_b32 v6, v106 offset:192
    ds_write_b32 v6, v107 offset:288
    ds_write_b32 v7, v176
    ds_write_b32 v8, v180
    s_waitcnt lgkmcnt(0)
    ds_read_b32 v28, v9 offset:0
    ds_read_b32 v29, v9 offset:256
    ds_read_b32 v30, v9 offset:512
    ds_read_b32 v31, v9 offset:768
    ds_read_b32 v32, v9 offset:1024
    ds_read_b32 v33, v9 offset:1280
    ds_read_b32 v34, v9 offset:1536
    ds_read_b32 v35, v9 offset:1792
    s_waitcnt lgkmcnt(7)
    buffer_atomic_add_f32 v28, v10, s[36:39], s30 offen offset:0
    s_waitcnt lgkmcnt(6)
    buffer_atomic_add_f32 v29, v11, s[36:39], s30 offen offset:0
    s_waitcnt lgkmcnt(5)
    buffer_atomic_add_f32 v30, v12, s[36:39], s30 offen offset:0
    s_waitcnt lgkmcnt(4)
    buffer_atomic_add_f32 v31, v10, s[36:39], s30 offen offset:768
    s_waitcnt lgkmcnt(3)
    buffer_atomic_add_f32 v32, v11, s[36:39], s30 offen offset:768
    s_waitcnt lgkmcnt(2)
    buffer_atomic_add_f32 v33, v12, s[36:39], s30 offen offset:768
    s_waitcnt lgkmcnt(1)
    buffer_atomic_add_f32 v34, v10, s[36:39], s30 offen offset:1536
    s_waitcnt lgkmcnt(0)
    buffer_atomic_add_f32 v35, v13, s[36:39], s30 offen offset:0
    s_branch sequential_preLN__linear_attn_block__dense_activation_relu__prompt_kernel_p1done77
sequential_preLN__linear_attn_block__dense_activation_relu__prompt_kernel_consq76:
    s_mov_b64 s[40:41], s[20:21]
    s_mov_b32 s42, 3145728
    s_mov_b32 s43, 0x20000
    s_lshl_b32 s53, s48, 1
    s_add_u32 s53, s53, s29
    s_lshl_b32 s53, s53, 4
    s_add_u32 s53, s53, s49
    s_lshl_b32 s53, s53, 1
    s_add_u32 s53, s53, s28
    s_mul_i32 s53, s53, 3072
    s_waitcnt lgkmcnt(0)
    ds_read_b64_tr_b16 v[28:29], v3 offset:0
    ds_read_b64_tr_b16 v[30:31], v4 offset:0
    ds_read_b64_tr_b16 v[48:49], v3 offset:8
    ds_read_b64_tr_b16 v[50:51], v4 offset:8
    ds_read_b64_tr_b16 v[68:69], v3 offset:10240
    ds_read_b64_tr_b16 v[70:71], v4 offset:10240
    ds_read_b64_tr_b16 v[88:89], v3 offset:10248
    ds_read_b64_tr_b16 v[90:91], v4 offset:10248
    v_pk_mul_f32 v[108:109], v[36:37], v[152:153]
    v_pk_fma_f32 v[36:37], v[36:37], v[136:137], 1.0 op_sel_hi:[1,1,0]
    v_exp_f32_e64 v108, v108 clamp
    v_exp_f32_e64 v109, v109 clamp
    v_max_f32 v36, v36, v108
    v_max_f32 v37, v37, v109
    v_pk_add_f32 v[36:37], v[36:37], s[32:33]
    v_pk_mul_f32 v[108:109], v[38:39], v[154:155]
    v_pk_fma_f32 v[38:39], v[38:39], v[138:139], 1.0 op_sel_hi:[1,1,0]
    v_exp_f32_e64 v108, v108 clamp
    v_exp_f32_e64 v109, v109 clamp
    v_max_f32 v38, v38, v108
    v_max_f32 v39, v39, v109
    v_pk_add_f32 v[38:39], v[38:39], s[32:33]
    v_pk_mul_f32 v[108:109], v[56:57], v[156:157]
    v_pk_fma_f32 v[56:57], v[56:57], v[140:141], 1.0 op_sel_hi:[1,1,0]
    v_exp_f32_e64 v108, v108 clamp
    v_exp_f32_e64 v109, v109 clamp
    v_max_f32 v56, v56, v108
    v_max_f32 v57, v57, v109
    v_pk_add_f32 v[56:57], v[56:57], s[32:33]
    v_pk_mul_f32 v[108:109], v[58:59], v[158:159]
    v_pk_fma_f32 v[58:59], v[58:59], v[142:143], 1.0 op_sel_hi:[1,1,0]
    v_exp_f32_e64 v108, v108 clamp
    v_exp_f32_e64 v109, v109 clamp
    v_max_f32 v58, v58, v108
    v_max_f32 v59, v59, v109
    v_pk_add_f32 v[58:59], v[58:59], s[32:33]
    v_cvt_pk_bf16_f32 v168, v36, v37
    v_cvt_pk_bf16_f32 v169, v38, v39
    v_cvt_pk_bf16_f32 v170, v56, v57
    v_cvt_pk_bf16_f32 v171, v58, v59
    ds_write_b128 v19, v[168:171] offset:2048
    v_pk_mul_f32 v[108:109], v[76:77], v[160:161]
    v_pk_fma_f32 v[76:77], v[76:77], v[144:145], 1.0 op_sel_hi:[1,1,0]
    v_exp_f32_e64 v108, v108 clamp
    v_exp_f32_e64 v109, v109 clamp
    v_max_f32 v76, v76, v108
    v_max_f32 v77, v77, v109
    v_pk_add_f32 v[76:77], v[76:77], s[32:33]
    v_pk_mul_f32 v[108:109], v[78:79], v[162:163]
    v_pk_fma_f32 v[78:79], v[78:79], v[146:147], 1.0 op_sel_hi:[1,1,0]
    v_exp_f32_e64 v108, v108 clamp
    v_exp_f32_e64 v109, v109 clamp
    v_max_f32 v78, v78, v108
    v_max_f32 v79, v79, v109
    v_pk_add_f32 v[78:79], v[78:79], s[32:33]
    v_pk_mul_f32 v[108:109], v[96:97], v[164:165]
    v_pk_fma_f32 v[96:97], v[96:97], v[148:149], 1.0 op_sel_hi:[1,1,0]
    v_exp_f32_e64 v108, v108 clamp
    v_exp_f32_e64 v109, v109 clamp
    v_max_f32 v96, v96, v108
    v_max_f32 v97, v97, v109
    v_pk_add_f32 v[96:97], v[96:97], s[32:33]
    v_pk_mul_f32 v[108:109], v[98:99], v[166:167]
    v_pk_fma_f32 v[98:99], v[98:99], v[150:151], 1.0 op_sel_hi:[1,1,0]
    v_exp_f32_e64 v108, v108 clamp
    v_exp_f32_e64 v109, v109 clamp
    v_max_f32 v98, v98, v108
    v_max_f32 v99, v99, v109
    v_pk_add_f32 v[98:99], v[98:99], s[32:33]
    v_cvt_pk_bf16_f32 v172, v76, v77
    v_cvt_pk_bf16_f32 v173, v78, v79
    v_cvt_pk_bf16_f32 v174, v96, v97
    v_cvt_pk_bf16_f32 v175, v98, v99
    ds_write_b128 v19, v[172:175] offset:12288
    s_waitcnt lgkmcnt(2)
    s_mov_b32 exec_hi, 0xffff
    s_add_u32 s3, s53, 0
    buffer_store_dwordx4 v[28:31], v11, s[40:43], s3 offen offset:0 sc1
    s_add_u32 s3, s53, 24576
    buffer_store_dwordx4 v[48:51], v11, s[40:43], s3 offen offset:0 sc1
    s_add_u32 s3, s53, 49152
    buffer_store_dwordx4 v[68:71], v11, s[40:43], s3 offen offset:0 sc1
    s_add_u32 s3, s53, 73728
    buffer_store_dwordx4 v[88:91], v11, s[40:43], s3 offen offset:0 sc1
    s_mov_b64 exec, -1
    s_waitcnt lgkmcnt(0)
    ds_read_b64_tr_b16 v[32:33], v5 offset:0
    ds_read_b64_tr_b16 v[34:35], v6 offset:0
    ds_read_b64_tr_b16 v[52:53], v5 offset:8
    ds_read_b64_tr_b16 v[54:55], v6 offset:8
    ds_read_b64_tr_b16 v[72:73], v5 offset:10240
    ds_read_b64_tr_b16 v[74:75], v6 offset:10240
    ds_read_b64_tr_b16 v[92:93], v5 offset:10248
    ds_read_b64_tr_b16 v[94:95], v6 offset:10248
    v_pk_mul_f32 v[108:109], v[40:41], v[152:153]
    v_pk_fma_f32 v[40:41], v[40:41], v[136:137], 1.0 op_sel_hi:[1,1,0]
    v_exp_f32_e64 v108, v108 clamp
    v_exp_f32_e64 v109, v109 clamp
    v_max_f32 v40, v40, v108
    v_max_f32 v41, v41, v109
    v_pk_add_f32 v[40:41], v[40:41], s[32:33]
    v_pk_mul_f32 v[108:109], v[42:43], v[154:155]
    v_pk_fma_f32 v[42:43], v[42:43], v[138:139], 1.0 op_sel_hi:[1,1,0]
    v_exp_f32_e64 v108, v108 clamp
    v_exp_f32_e64 v109, v109 clamp
    v_max_f32 v42, v42, v108
    v_max_f32 v43, v43, v109
    v_pk_add_f32 v[42:43], v[42:43], s[32:33]
    v_pk_mul_f32 v[108:109], v[60:61], v[156:157]
    v_pk_fma_f32 v[60:61], v[60:61], v[140:141], 1.0 op_sel_hi:[1,1,0]
    v_exp_f32_e64 v108, v108 clamp
    v_exp_f32_e64 v109, v109 clamp
    v_max_f32 v60, v60, v108
    v_max_f32 v61, v61, v109
    v_pk_add_f32 v[60:61], v[60:61], s[32:33]
    v_pk_mul_f32 v[108:109], v[62:63], v[158:159]
    v_pk_fma_f32 v[62:63], v[62:63], v[142:143], 1.0 op_sel_hi:[1,1,0]
    v_exp_f32_e64 v108, v108 clamp
    v_exp_f32_e64 v109, v109 clamp
    v_max_f32 v62, v62, v108
    v_max_f32 v63, v63, v109
    v_pk_add_f32 v[62:63], v[62:63], s[32:33]
    v_cvt_pk_bf16_f32 v168, v40, v41
    v_cvt_pk_bf16_f32 v169, v42, v43
    v_cvt_pk_bf16_f32 v170, v60, v61
    v_cvt_pk_bf16_f32 v171, v62, v63
    ds_write_b128 v18, v[168:171] offset:3072
    v_pk_mul_f32 v[108:109], v[80:81], v[160:161]
    v_pk_fma_f32 v[80:81], v[80:81], v[144:145], 1.0 op_sel_hi:[1,1,0]
    v_exp_f32_e64 v108, v108 clamp
    v_exp_f32_e64 v109, v109 clamp
    v_max_f32 v80, v80, v108
    v_max_f32 v81, v81, v109
    v_pk_add_f32 v[80:81], v[80:81], s[32:33]
    v_pk_mul_f32 v[108:109], v[82:83], v[162:163]
    v_pk_fma_f32 v[82:83], v[82:83], v[146:147], 1.0 op_sel_hi:[1,1,0]
    v_exp_f32_e64 v108, v108 clamp
    v_exp_f32_e64 v109, v109 clamp
    v_max_f32 v82, v82, v108
    v_max_f32 v83, v83, v109
    v_pk_add_f32 v[82:83], v[82:83], s[32:33]
    v_pk_mul_f32 v[108:109], v[100:101], v[164:165]
    v_pk_fma_f32 v[100:101], v[100:101], v[148:149], 1.0 op_sel_hi:[1,1,0]
    v_exp_f32_e64 v108, v108 clamp
    v_exp_f32_e64 v109, v109 clamp
    v_max_f32 v100, v100, v108
    v_max_f32 v101, v101, v109
    v_pk_add_f32 v[100:101], v[100:101], s[32:33]
    v_pk_mul_f32 v[108:109], v[102:103], v[166:167]
    v_pk_fma_f32 v[102:103], v[102:103], v[150:151], 1.0 op_sel_hi:[1,1,0]
    v_exp_f32_e64 v108, v108 clamp
    v_exp_f32_e64 v109, v109 clamp
    v_max_f32 v102, v102, v108
    v_max_f32 v103, v103, v109
    v_pk_add_f32 v[102:103], v[102:103], s[32:33]
    v_cvt_pk_bf16_f32 v172, v80, v81
    v_cvt_pk_bf16_f32 v173, v82, v83
    v_cvt_pk_bf16_f32 v174, v100, v101
    v_cvt_pk_bf16_f32 v175, v102, v103
    ds_write_b128 v18, v[172:175] offset:13312
    s_waitcnt lgkmcnt(2)
    s_mov_b32 exec_hi, 0xffff
    s_add_u32 s3, s53, 0
    buffer_store_dwordx4 v[32:35], v11, s[40:43], s3 offen offset:768 sc1
    s_add_u32 s3, s53, 24576
    buffer_store_dwordx4 v[52:55], v11, s[40:43], s3 offen offset:768 sc1
    s_add_u32 s3, s53, 49152
    buffer_store_dwordx4 v[72:75], v11, s[40:43], s3 offen offset:768 sc1
    s_add_u32 s3, s53, 73728
    buffer_store_dwordx4 v[92:95], v11, s[40:43], s3 offen offset:768 sc1
    s_mov_b64 exec, -1
    s_barrier
    s_waitcnt lgkmcnt(0)
    ds_read_b64_tr_b16 v[36:37], v7 offset:0
    ds_read_b64_tr_b16 v[38:39], v8 offset:0
    ds_read_b64_tr_b16 v[56:57], v7 offset:8
    ds_read_b64_tr_b16 v[58:59], v8 offset:8
    ds_read_b64_tr_b16 v[76:77], v7 offset:10240
    ds_read_b64_tr_b16 v[78:79], v8 offset:10240
    ds_read_b64_tr_b16 v[96:97], v7 offset:10248
    ds_read_b64_tr_b16 v[98:99], v8 offset:10248
    v_pk_mul_f32 v[108:109], v[44:45], v[152:153]
    v_pk_fma_f32 v[44:45], v[44:45], v[136:137], 1.0 op_sel_hi:[1,1,0]
    v_exp_f32_e64 v108, v108 clamp
    v_exp_f32_e64 v109, v109 clamp
    v_max_f32 v44, v44, v108
    v_max_f32 v45, v45, v109
    v_pk_add_f32 v[44:45], v[44:45], s[32:33]
    v_pk_mul_f32 v[108:109], v[46:47], v[154:155]
    v_pk_fma_f32 v[46:47], v[46:47], v[138:139], 1.0 op_sel_hi:[1,1,0]
    v_exp_f32_e64 v108, v108 clamp
    v_exp_f32_e64 v109, v109 clamp
    v_max_f32 v46, v46, v108
    v_max_f32 v47, v47, v109
    v_pk_add_f32 v[46:47], v[46:47], s[32:33]
    v_pk_mul_f32 v[108:109], v[64:65], v[156:157]
    v_pk_fma_f32 v[64:65], v[64:65], v[140:141], 1.0 op_sel_hi:[1,1,0]
    v_exp_f32_e64 v108, v108 clamp
    v_exp_f32_e64 v109, v109 clamp
    v_max_f32 v64, v64, v108
    v_max_f32 v65, v65, v109
    v_pk_add_f32 v[64:65], v[64:65], s[32:33]
    v_pk_mul_f32 v[108:109], v[66:67], v[158:159]
    v_pk_fma_f32 v[66:67], v[66:67], v[142:143], 1.0 op_sel_hi:[1,1,0]
    v_exp_f32_e64 v108, v108 clamp
    v_exp_f32_e64 v109, v109 clamp
    v_max_f32 v66, v66, v108
    v_max_f32 v67, v67, v109
    v_pk_add_f32 v[66:67], v[66:67], s[32:33]
    v_cvt_pk_bf16_f32 v168, v44, v45
    v_cvt_pk_bf16_f32 v169, v46, v47
    v_cvt_pk_bf16_f32 v170, v64, v65
    v_cvt_pk_bf16_f32 v171, v66, v67
    ds_write_b128 v18, v[168:171] offset:4096
    v_pk_mul_f32 v[108:109], v[84:85], v[160:161]
    v_pk_fma_f32 v[84:85], v[84:85], v[144:145], 1.0 op_sel_hi:[1,1,0]
    v_exp_f32_e64 v108, v108 clamp
    v_exp_f32_e64 v109, v109 clamp
    v_max_f32 v84, v84, v108
    v_max_f32 v85, v85, v109
    v_pk_add_f32 v[84:85], v[84:85], s[32:33]
    v_pk_mul_f32 v[108:109], v[86:87], v[162:163]
    v_pk_fma_f32 v[86:87], v[86:87], v[146:147], 1.0 op_sel_hi:[1,1,0]
    v_exp_f32_e64 v108, v108 clamp
    v_exp_f32_e64 v109, v109 clamp
    v_max_f32 v86, v86, v108
    v_max_f32 v87, v87, v109
    v_pk_add_f32 v[86:87], v[86:87], s[32:33]
    v_pk_mul_f32 v[108:109], v[104:105], v[164:165]
    v_pk_fma_f32 v[104:105], v[104:105], v[148:149], 1.0 op_sel_hi:[1,1,0]
    v_exp_f32_e64 v108, v108 clamp
    v_exp_f32_e64 v109, v109 clamp
    v_max_f32 v104, v104, v108
    v_max_f32 v105, v105, v109
    v_pk_add_f32 v[104:105], v[104:105], s[32:33]
    v_pk_mul_f32 v[108:109], v[106:107], v[166:167]
    v_pk_fma_f32 v[106:107], v[106:107], v[150:151], 1.0 op_sel_hi:[1,1,0]
    v_exp_f32_e64 v108, v108 clamp
    v_exp_f32_e64 v109, v109 clamp
    v_max_f32 v106, v106, v108
    v_max_f32 v107, v107, v109
    v_pk_add_f32 v[106:107], v[106:107], s[32:33]
    v_cvt_pk_bf16_f32 v172, v84, v85
    v_cvt_pk_bf16_f32 v173, v86, v87
    v_cvt_pk_bf16_f32 v174, v104, v105
    v_cvt_pk_bf16_f32 v175, v106, v107
    ds_write_b128 v18, v[172:175] offset:14336
    s_waitcnt lgkmcnt(2)
    s_mov_b32 exec_hi, 0xffff
    s_add_u32 s3, s53, 0
    buffer_store_dwordx4 v[36:39], v11, s[40:43], s3 offen offset:1536 sc1
    s_add_u32 s3, s53, 24576
    buffer_store_dwordx4 v[56:59], v11, s[40:43], s3 offen offset:1536 sc1
    s_add_u32 s3, s53, 49152
    buffer_store_dwordx4 v[76:79], v11, s[40:43], s3 offen offset:1536 sc1
    s_add_u32 s3, s53, 73728
    buffer_store_dwordx4 v[96:99], v11, s[40:43], s3 offen offset:1536 sc1
    s_mov_b64 exec, -1
    s_waitcnt lgkmcnt(0)
    ds_read_b64_tr_b16 v[40:41], v9 offset:0
    ds_read_b64_tr_b16 v[42:43], v10 offset:0
    ds_read_b64_tr_b16 v[60:61], v9 offset:8
    ds_read_b64_tr_b16 v[62:63], v10 offset:8
    ds_read_b64_tr_b16 v[80:81], v9 offset:10240
    ds_read_b64_tr_b16 v[82:83], v10 offset:10240
    ds_read_b64_tr_b16 v[100:101], v9 offset:10248
    ds_read_b64_tr_b16 v[102:103], v10 offset:10248
    s_waitcnt lgkmcnt(0)
    s_mov_b32 exec_hi, 0xffff
    s_add_u32 s3, s53, 0
    buffer_store_dwordx4 v[40:43], v11, s[40:43], s3 offen offset:2304 sc1
    s_add_u32 s3, s53, 24576
    buffer_store_dwordx4 v[60:63], v11, s[40:43], s3 offen offset:2304 sc1
    s_add_u32 s3, s53, 49152
    buffer_store_dwordx4 v[80:83], v11, s[40:43], s3 offen offset:2304 sc1
    s_add_u32 s3, s53, 73728
    buffer_store_dwordx4 v[100:103], v11, s[40:43], s3 offen offset:2304 sc1
    s_mov_b64 exec, -1
    s_branch sequential_preLN__linear_attn_block__dense_activation_relu__prompt_kernel_p1done77
sequential_preLN__linear_attn_block__dense_activation_relu__prompt_kernel_sv280:
    s_barrier
    s_barrier
    s_branch sequential_preLN__linear_attn_block__dense_activation_relu__prompt_kernel_p1done77
sequential_preLN__linear_attn_block__dense_activation_relu__prompt_kernel_p1done77:
    s_and_b32 s48, s23, 7
    s_lshl_b32 s3, s24, 3
    s_add_u32 s48, s48, s3
    s_lshr_b32 s49, s23, 3
    s_lshl_b32 s3, s25, 2
    s_add_u32 s49, s49, s3
    s_lshl_b32 s30, s48, 6
    s_lshl_b32 s31, s28, 5
    s_add_u32 s30, s30, s31
    s_lshl_b32 s31, s29, 4
    s_add_u32 s30, s30, s31
    v_and_b32 v240, 15, v1
    v_add_u32 v230, s30, v240
    v_mul_u32_u24 v228, 1280, v230
    s_mul_i32 s30, s49, 160
    v_add_u32 v228, s30, v228
    v_lshrrev_b32 v239, 4, v1
    v_lshl_add_u32 v229, v239, 3, v228
    v_bfe_u32 v238, v1, 4, 1
    v_lshl_add_u32 v228, v238, 5, v228
    v_lshrrev_b32 v238, 5, v1
    v_lshl_add_u32 v228, v238, 4, v228
    v_cmp_eq_u32 vcc, 3, v239
    v_lshrrev_b32 v238, 2, v240
    v_add_u32 v232, v238, v240
    v_cndmask_b32 v231, v239, 1, vcc
    v_lshlrev_b32 v231, 8, v231
    v_lshl_add_u32 v231, v240, 4, v231
    v_mul_u32_u24 v233, 5, v238
    v_add_u32 v233, 4, v233
    v_and_b32 v238, 3, v240
    v_cmp_eq_u32 s[50:51], 0, v238
    v_mov_b32 v238, 20
    s_nop 0
    v_cndmask_b32 v233, v238, v233, s[50:51]
    v_mul_u32_u24 v232, 48, v232
    v_mul_u32_u24 v233, 48, v233
    v_lshl_add_u32 v232, v239, 4, v232
    v_lshl_add_u32 v233, v239, 4, v233
    v_mov_b32 v238, 1008
    v_cndmask_b32 v232, v232, v238, vcc
    v_cndmask_b32 v233, v233, v238, vcc
    s_lshl_b32 s30, s29, 14
    s_add_u32 s30, s30, 0
    v_add_u32 v232, s30, v232
    v_add_u32 v233, s30, v233
    v_bfe_u32 v238, v1, 2, 3
    v_lshrrev_b32 v239, 5, v1
    v_mul_u32_u24 v239, 2560, v239
    v_mul_u32_u24 v238, 160, v238
    v_add_u32 v234, v239, v238
    v_and_b32 v238, 3, v1
    v_lshl_add_u32 v234, v238, 3, v234
    s_mul_i32 s30, s29, 51200
    s_add_u32 s30, s30, 40960
    v_add_u32 v234, s30, v234
    s_mul_i32 s30, s22, 5120
    s_add_u32 s30, s30, 143360
    v_lshlrev_b32 v238, 4, v1
    v_add_u32 v236, s30, v238
    s_xor_b32 s30, s22, 2
    s_mul_i32 s30, s30, 5120
    s_add_u32 s30, s30, 143360
    v_add_u32 v237, s30, v238
    v_lshlrev_b32 v235, 4, v0
    v_lshlrev_b32 v240, 3, v0
    s_lshl_b32 s30, s23, 11
    v_add_u32 v240, s30, v240
    v_and_b32 v240, 0x7fff, v240
    v_mov_b32 v224, 0
    v_mov_b32 v225, s32
    v_mov_b64 v[226:227], 0
    s_mov_b64 s[44:45], s[4:5]
    s_mov_b32 s46, 2621440
    s_mov_b32 s47, 0x20000
    s_mov_b64 s[40:41], s[20:21]
    s_mov_b32 s42, 3145728
    s_mov_b32 s43, 0x20000
    s_lshl_b32 s30, s48, 2
    s_lshl_b32 s31, s28, 1
    s_add_u32 s30, s30, s31
    s_add_u32 s30, s30, s29
    s_xor_b32 s31, s30, 1
    s_lshl_b32 s30, s30, 1
    s_add_u32 s30, s30, s29
    s_mul_i32 s30, s30, 12288
    s_lshl_b32 s31, s31, 1
    s_add_u32 s31, s31, s29
    s_mul_i32 s31, s31, 12288
    s_waitcnt vmcnt(0)
    s_barrier
    buffer_load_dwordx4 v[212:215], v228, s[44:47], 0 offen
    buffer_load_dwordx4 v[216:219], v228, s[44:47], 0 offen offset:64
    buffer_load_dwordx2 v[220:221], v229, s[44:47], 0 offen offset:128
    s_barrier
    buffer_load_dwordx4 v[4:7], v231, s[40:43], s30 offen offset:0 sc1
    buffer_load_dwordx4 v[68:71], v231, s[40:43], s31 offen offset:0 sc1
    buffer_load_dwordx4 v[8:11], v231, s[40:43], s30 offen offset:768 sc1
    buffer_load_dwordx4 v[72:75], v231, s[40:43], s31 offen offset:768 sc1
    buffer_load_dwordx4 v[12:15], v231, s[40:43], s30 offen offset:1536 sc1
    buffer_load_dwordx4 v[76:79], v231, s[40:43], s31 offen offset:1536 sc1
    buffer_load_dwordx4 v[16:19], v231, s[40:43], s30 offen offset:2304 sc1
    buffer_load_dwordx4 v[80:83], v231, s[40:43], s31 offen offset:2304 sc1
    buffer_load_dwordx4 v[20:23], v231, s[40:43], s30 offen offset:3072 sc1
    buffer_load_dwordx4 v[84:87], v231, s[40:43], s31 offen offset:3072 sc1
    s_barrier
    s_lshl_b32 s52, s23, 12
    s_and_b32 s52, s52, 0xffff
    buffer_load_dwordx4 v[132:135], v235, s[36:39], s52 offen sc1
    s_add_u32 s52, s52, 4096
    s_and_b32 s52, s52, 0xffff
    buffer_load_dwordx4 v[136:139], v235, s[36:39], s52 offen sc1
    s_add_u32 s52, s52, 4096
    s_and_b32 s52, s52, 0xffff
    buffer_load_dwordx4 v[140:143], v235, s[36:39], s52 offen sc1
    s_add_u32 s52, s52, 4096
    s_and_b32 s52, s52, 0xffff
    buffer_load_dwordx4 v[144:147], v235, s[36:39], s52 offen sc1
    s_add_u32 s52, s52, 4096
    s_and_b32 s52, s52, 0xffff
    buffer_load_dwordx4 v[148:151], v235, s[36:39], s52 offen sc1
    s_add_u32 s52, s52, 4096
    s_and_b32 s52, s52, 0xffff
    buffer_load_dwordx4 v[152:155], v235, s[36:39], s52 offen sc1
    s_add_u32 s52, s52, 4096
    s_and_b32 s52, s52, 0xffff
    buffer_load_dwordx4 v[156:159], v235, s[36:39], s52 offen sc1
    s_add_u32 s52, s52, 4096
    s_and_b32 s52, s52, 0xffff
    buffer_load_dwordx4 v[160:163], v235, s[36:39], s52 offen sc1
    s_add_u32 s52, s52, 4096
    s_and_b32 s52, s52, 0xffff
    buffer_load_dwordx4 v[164:167], v235, s[36:39], s52 offen sc1
    s_add_u32 s52, s52, 4096
    s_and_b32 s52, s52, 0xffff
    buffer_load_dwordx4 v[168:171], v235, s[36:39], s52 offen sc1
    s_add_u32 s52, s52, 4096
    s_and_b32 s52, s52, 0xffff
    buffer_load_dwordx4 v[172:175], v235, s[36:39], s52 offen sc1
    s_add_u32 s52, s52, 4096
    s_and_b32 s52, s52, 0xffff
    buffer_load_dwordx4 v[176:179], v235, s[36:39], s52 offen sc1
    s_add_u32 s52, s52, 4096
    s_and_b32 s52, s52, 0xffff
    buffer_load_dwordx4 v[180:183], v235, s[36:39], s52 offen sc1
    s_add_u32 s52, s52, 4096
    s_and_b32 s52, s52, 0xffff
    buffer_load_dwordx4 v[184:187], v235, s[36:39], s52 offen sc1
    s_add_u32 s52, s52, 4096
    s_and_b32 s52, s52, 0xffff
    buffer_load_dwordx4 v[188:191], v235, s[36:39], s52 offen sc1
    s_add_u32 s52, s52, 4096
    s_and_b32 s52, s52, 0xffff
    buffer_load_dwordx4 v[192:195], v235, s[36:39], s52 offen sc1
    s_add_u32 s52, s52, 4096
    s_waitcnt vmcnt(15)
    v_cvt_pk_bf16_f32 v132, v132, v133
    v_cvt_pk_bf16_f32 v133, v134, v135
    ds_write_b64 v240, v[132:133]
    v_add_u32 v240, 2048, v240
    v_and_b32 v240, 0x7fff, v240
    s_waitcnt vmcnt(14)
    v_cvt_pk_bf16_f32 v136, v136, v137
    v_cvt_pk_bf16_f32 v137, v138, v139
    ds_write_b64 v240, v[136:137]
    v_add_u32 v240, 2048, v240
    v_and_b32 v240, 0x7fff, v240
    s_waitcnt vmcnt(13)
    v_cvt_pk_bf16_f32 v140, v140, v141
    v_cvt_pk_bf16_f32 v141, v142, v143
    ds_write_b64 v240, v[140:141]
    v_add_u32 v240, 2048, v240
    v_and_b32 v240, 0x7fff, v240
    s_waitcnt vmcnt(12)
    v_cvt_pk_bf16_f32 v144, v144, v145
    v_cvt_pk_bf16_f32 v145, v146, v147
    ds_write_b64 v240, v[144:145]
    v_add_u32 v240, 2048, v240
    v_and_b32 v240, 0x7fff, v240
    s_waitcnt vmcnt(11)
    v_cvt_pk_bf16_f32 v148, v148, v149
    v_cvt_pk_bf16_f32 v149, v150, v151
    ds_write_b64 v240, v[148:149]
    v_add_u32 v240, 2048, v240
    v_and_b32 v240, 0x7fff, v240
    s_waitcnt vmcnt(10)
    v_cvt_pk_bf16_f32 v152, v152, v153
    v_cvt_pk_bf16_f32 v153, v154, v155
    ds_write_b64 v240, v[152:153]
    v_add_u32 v240, 2048, v240
    v_and_b32 v240, 0x7fff, v240
    s_waitcnt vmcnt(9)
    v_cvt_pk_bf16_f32 v156, v156, v157
    v_cvt_pk_bf16_f32 v157, v158, v159
    ds_write_b64 v240, v[156:157]
    v_add_u32 v240, 2048, v240
    v_and_b32 v240, 0x7fff, v240
    s_waitcnt vmcnt(8)
    v_cvt_pk_bf16_f32 v160, v160, v161
    v_cvt_pk_bf16_f32 v161, v162, v163
    ds_write_b64 v240, v[160:161]
    v_add_u32 v240, 2048, v240
    v_and_b32 v240, 0x7fff, v240
    s_waitcnt lgkmcnt(4)
    s_waitcnt vmcnt(7)
    v_cvt_pk_bf16_f32 v164, v164, v165
    v_cvt_pk_bf16_f32 v165, v166, v167
    ds_write_b64 v240, v[164:165]
    v_add_u32 v240, 2048, v240
    v_and_b32 v240, 0x7fff, v240
    s_add_u32 s30, s30, 3840
    s_add_u32 s31, s31, 3840
    buffer_load_dwordx4 v[24:27], v231, s[40:43], s30 offen offset:0 sc1
    s_waitcnt vmcnt(7)
    v_cvt_pk_bf16_f32 v168, v168, v169
    v_cvt_pk_bf16_f32 v169, v170, v171
    ds_write_b64 v240, v[168:169]
    v_add_u32 v240, 2048, v240
    v_and_b32 v240, 0x7fff, v240
    buffer_load_dwordx4 v[88:91], v231, s[40:43], s31 offen offset:0 sc1
    s_waitcnt vmcnt(7)
    v_cvt_pk_bf16_f32 v172, v172, v173
    v_cvt_pk_bf16_f32 v173, v174, v175
    ds_write_b64 v240, v[172:173]
    v_add_u32 v240, 2048, v240
    v_and_b32 v240, 0x7fff, v240
    buffer_load_dwordx4 v[28:31], v231, s[40:43], s30 offen offset:768 sc1
    s_waitcnt vmcnt(7)
    v_cvt_pk_bf16_f32 v176, v176, v177
    v_cvt_pk_bf16_f32 v177, v178, v179
    ds_write_b64 v240, v[176:177]
    v_add_u32 v240, 2048, v240
    v_and_b32 v240, 0x7fff, v240
    buffer_load_dwordx4 v[92:95], v231, s[40:43], s31 offen offset:768 sc1
    s_waitcnt vmcnt(7)
    v_cvt_pk_bf16_f32 v180, v180, v181
    v_cvt_pk_bf16_f32 v181, v182, v183
    ds_write_b64 v240, v[180:181]
    v_add_u32 v240, 2048, v240
    v_and_b32 v240, 0x7fff, v240
    buffer_load_dwordx4 v[32:35], v231, s[40:43], s30 offen offset:1536 sc1
    s_waitcnt vmcnt(7)
    v_cvt_pk_bf16_f32 v184, v184, v185
    v_cvt_pk_bf16_f32 v185, v186, v187
    ds_write_b64 v240, v[184:185]
    v_add_u32 v240, 2048, v240
    v_and_b32 v240, 0x7fff, v240
    buffer_load_dwordx4 v[96:99], v231, s[40:43], s31 offen offset:1536 sc1
    s_waitcnt vmcnt(7)
    v_cvt_pk_bf16_f32 v188, v188, v189
    v_cvt_pk_bf16_f32 v189, v190, v191
    ds_write_b64 v240, v[188:189]
    v_add_u32 v240, 2048, v240
    v_and_b32 v240, 0x7fff, v240
    buffer_load_dwordx4 v[36:39], v231, s[40:43], s30 offen offset:2304 sc1
    s_waitcnt vmcnt(7)
    v_cvt_pk_bf16_f32 v192, v192, v193
    v_cvt_pk_bf16_f32 v193, v194, v195
    ds_write_b64 v240, v[192:193]
    v_add_u32 v240, 2048, v240
    v_and_b32 v240, 0x7fff, v240
    buffer_load_dwordx4 v[100:103], v231, s[40:43], s31 offen offset:2304 sc1
    s_waitcnt lgkmcnt(0)
    s_barrier
    ds_read_b128 v[148:151], v233 offset:0
    ds_read_b128 v[132:135], v232 offset:0
    ds_read_b128 v[152:155], v233 offset:1024
    ds_read_b128 v[136:139], v232 offset:1024
    ds_read_b128 v[156:159], v233 offset:2048
    ds_read_b128 v[140:143], v232 offset:2048
    ds_read_b128 v[160:163], v233 offset:3072
    ds_read_b128 v[144:147], v232 offset:3072
    s_waitcnt vmcnt(14)
    s_waitcnt lgkmcnt(4)
    v_mfma_f32_16x16x32_bf16 v[180:183], v[148:151], v[4:7], v[224:227]
    v_mfma_f32_16x16x32_bf16 v[164:167], v[132:135], v[4:7], 0
    v_mfma_f32_16x16x32_bf16 v[184:187], v[152:155], v[8:11], v[224:227]
    v_mfma_f32_16x16x32_bf16 v[168:171], v[136:139], v[8:11], 0
    s_nop 5
    v_mfma_f32_16x16x32_bf16 v[188:191], v[148:151], v[68:71], v[224:227]
    v_mfma_f32_16x16x32_bf16 v[172:175], v[132:135], v[68:71], 0
    v_mfma_f32_16x16x32_bf16 v[192:195], v[152:155], v[72:75], v[224:227]
    v_mfma_f32_16x16x32_bf16 v[176:179], v[136:139], v[72:75], 0
    v_rcp_f32 v181, v181
    v_rcp_f32 v185, v185
    v_pk_mul_f32 v[164:165], v[164:165], v[180:181] op_sel:[0,1]
    v_pk_mul_f32 v[166:167], v[166:167], v[180:181] op_sel:[0,1]
    v_mul_f32 v180, v180, v181
    v_pk_mul_f32 v[168:169], v[168:169], v[184:185] op_sel:[0,1]
    v_pk_mul_f32 v[170:171], v[170:171], v[184:185] op_sel:[0,1]
    v_mul_f32 v184, v184, v185
    v_cvt_pk_bf16_f32 v4, v164, v165
    v_cvt_pk_bf16_f32 v5, v166, v167
    v_cvt_pk_bf16_f32 v6, v180, v168
    v_cvt_pk_bf16_f32 v7, v169, v170
    v_cvt_pk_bf16_f32 v8, v171, v184
    ds_read_b128 v[148:151], v233 offset:4096
    ds_read_b128 v[132:135], v232 offset:4096
    ds_read_b128 v[152:155], v233 offset:5120
    ds_read_b128 v[136:139], v232 offset:5120
    buffer_load_dwordx4 v[40:43], v231, s[40:43], s30 offen offset:3072 sc1
    buffer_load_dwordx4 v[104:107], v231, s[40:43], s31 offen offset:3072 sc1
    s_add_u32 s30, s30, 3840
    s_add_u32 s31, s31, 3840
    buffer_load_dwordx4 v[44:47], v231, s[40:43], s30 offen offset:0 sc1
    s_waitcnt vmcnt(13)
    s_waitcnt lgkmcnt(4)
    v_mfma_f32_16x16x32_bf16 v[180:183], v[156:159], v[12:15], v[224:227]
    v_mfma_f32_16x16x32_bf16 v[164:167], v[140:143], v[12:15], 0
    v_mfma_f32_16x16x32_bf16 v[184:187], v[160:163], v[16:19], v[224:227]
    v_mfma_f32_16x16x32_bf16 v[168:171], v[144:147], v[16:19], 0
    v_rcp_f32 v189, v189
    v_rcp_f32 v193, v193
    v_pk_mul_f32 v[172:173], v[172:173], v[188:189] op_sel:[0,1]
    v_pk_mul_f32 v[174:175], v[174:175], v[188:189] op_sel:[0,1]
    v_mul_f32 v188, v188, v189
    v_pk_mul_f32 v[176:177], v[176:177], v[192:193] op_sel:[0,1]
    v_pk_mul_f32 v[178:179], v[178:179], v[192:193] op_sel:[0,1]
    v_mul_f32 v192, v192, v193
    v_cvt_pk_bf16_f32 v68, v172, v173
    v_cvt_pk_bf16_f32 v69, v174, v175
    v_cvt_pk_bf16_f32 v70, v188, v176
    v_cvt_pk_bf16_f32 v71, v177, v178
    v_cvt_pk_bf16_f32 v72, v179, v192
    buffer_load_dwordx4 v[108:111], v231, s[40:43], s31 offen offset:0 sc1
    buffer_load_dwordx4 v[48:51], v231, s[40:43], s30 offen offset:768 sc1
    buffer_load_dwordx4 v[112:115], v231, s[40:43], s31 offen offset:768 sc1
    v_mfma_f32_16x16x32_bf16 v[188:191], v[156:159], v[76:79], v[224:227]
    v_mfma_f32_16x16x32_bf16 v[172:175], v[140:143], v[76:79], 0
    v_mfma_f32_16x16x32_bf16 v[192:195], v[160:163], v[80:83], v[224:227]
    v_mfma_f32_16x16x32_bf16 v[176:179], v[144:147], v[80:83], 0
    v_rcp_f32 v181, v181
    v_rcp_f32 v185, v185
    v_pk_mul_f32 v[164:165], v[164:165], v[180:181] op_sel:[0,1]
    v_pk_mul_f32 v[166:167], v[166:167], v[180:181] op_sel:[0,1]
    v_mul_f32 v180, v180, v181
    v_pk_mul_f32 v[168:169], v[168:169], v[184:185] op_sel:[0,1]
    v_pk_mul_f32 v[170:171], v[170:171], v[184:185] op_sel:[0,1]
    v_mul_f32 v184, v184, v185
    v_cvt_pk_bf16_f32 v9, v164, v165
    v_cvt_pk_bf16_f32 v10, v166, v167
    v_cvt_pk_bf16_f32 v11, v180, v168
    v_cvt_pk_bf16_f32 v12, v169, v170
    v_cvt_pk_bf16_f32 v13, v171, v184
    ds_read_b128 v[156:159], v233 offset:6144
    ds_read_b128 v[140:143], v232 offset:6144
    ds_read_b128 v[160:163], v233 offset:7168
    ds_read_b128 v[144:147], v232 offset:7168
    buffer_load_dwordx4 v[52:55], v231, s[40:43], s30 offen offset:1536 sc1
    buffer_load_dwordx4 v[116:119], v231, s[40:43], s31 offen offset:1536 sc1
    buffer_load_dwordx4 v[56:59], v231, s[40:43], s30 offen offset:2304 sc1
    s_waitcnt vmcnt(15)
    s_waitcnt lgkmcnt(4)
    v_mfma_f32_16x16x32_bf16 v[180:183], v[148:151], v[20:23], v[224:227]
    v_mfma_f32_16x16x32_bf16 v[164:167], v[132:135], v[20:23], 0
    v_mfma_f32_16x16x32_bf16 v[184:187], v[152:155], v[24:27], v[224:227]
    v_mfma_f32_16x16x32_bf16 v[168:171], v[136:139], v[24:27], 0
    v_rcp_f32 v189, v189
    v_rcp_f32 v193, v193
    v_pk_mul_f32 v[172:173], v[172:173], v[188:189] op_sel:[0,1]
    v_pk_mul_f32 v[174:175], v[174:175], v[188:189] op_sel:[0,1]
    v_mul_f32 v188, v188, v189
    v_pk_mul_f32 v[176:177], v[176:177], v[192:193] op_sel:[0,1]
    v_pk_mul_f32 v[178:179], v[178:179], v[192:193] op_sel:[0,1]
    v_mul_f32 v192, v192, v193
    v_cvt_pk_bf16_f32 v73, v172, v173
    v_cvt_pk_bf16_f32 v74, v174, v175
    v_cvt_pk_bf16_f32 v75, v188, v176
    v_cvt_pk_bf16_f32 v76, v177, v178
    v_cvt_pk_bf16_f32 v77, v179, v192
    buffer_load_dwordx4 v[120:123], v231, s[40:43], s31 offen offset:2304 sc1
    buffer_load_dwordx4 v[60:63], v231, s[40:43], s30 offen offset:3072 sc1
    buffer_load_dwordx4 v[124:127], v231, s[40:43], s31 offen offset:3072 sc1
    v_mfma_f32_16x16x32_bf16 v[188:191], v[148:151], v[84:87], v[224:227]
    v_mfma_f32_16x16x32_bf16 v[172:175], v[132:135], v[84:87], 0
    v_mfma_f32_16x16x32_bf16 v[192:195], v[152:155], v[88:91], v[224:227]
    v_mfma_f32_16x16x32_bf16 v[176:179], v[136:139], v[88:91], 0
    v_rcp_f32 v181, v181
    v_rcp_f32 v185, v185
    v_pk_mul_f32 v[164:165], v[164:165], v[180:181] op_sel:[0,1]
    v_pk_mul_f32 v[166:167], v[166:167], v[180:181] op_sel:[0,1]
    v_mul_f32 v180, v180, v181
    v_pk_mul_f32 v[168:169], v[168:169], v[184:185] op_sel:[0,1]
    v_pk_mul_f32 v[170:171], v[170:171], v[184:185] op_sel:[0,1]
    v_mul_f32 v184, v184, v185
    v_cvt_pk_bf16_f32 v14, v164, v165
    v_cvt_pk_bf16_f32 v15, v166, v167
    v_cvt_pk_bf16_f32 v16, v180, v168
    v_cvt_pk_bf16_f32 v17, v169, v170
    v_cvt_pk_bf16_f32 v18, v171, v184
    ds_read_b128 v[148:151], v233 offset:8192
    ds_read_b128 v[132:135], v232 offset:8192
    ds_read_b128 v[152:155], v233 offset:9216
    ds_read_b128 v[136:139], v232 offset:9216
    s_add_u32 s30, s30, 3840
    s_add_u32 s31, s31, 3840
    buffer_load_dwordx4 v[64:67], v231, s[40:43], s30 offen offset:0 sc1
    buffer_load_dwordx4 v[128:131], v231, s[40:43], s31 offen offset:0 sc1
    s_barrier
    s_waitcnt vmcnt(16)
    s_waitcnt lgkmcnt(4)
    v_mfma_f32_16x16x32_bf16 v[180:183], v[156:159], v[28:31], v[224:227]
    v_mfma_f32_16x16x32_bf16 v[164:167], v[140:143], v[28:31], 0
    v_mfma_f32_16x16x32_bf16 v[184:187], v[160:163], v[32:35], v[224:227]
    v_mfma_f32_16x16x32_bf16 v[168:171], v[144:147], v[32:35], 0
    v_rcp_f32 v189, v189
    v_rcp_f32 v193, v193
    v_pk_mul_f32 v[172:173], v[172:173], v[188:189] op_sel:[0,1]
    v_pk_mul_f32 v[174:175], v[174:175], v[188:189] op_sel:[0,1]
    v_mul_f32 v188, v188, v189
    v_pk_mul_f32 v[176:177], v[176:177], v[192:193] op_sel:[0,1]
    v_pk_mul_f32 v[178:179], v[178:179], v[192:193] op_sel:[0,1]
    v_mul_f32 v192, v192, v193
    v_cvt_pk_bf16_f32 v78, v172, v173
    v_cvt_pk_bf16_f32 v79, v174, v175
    v_cvt_pk_bf16_f32 v80, v188, v176
    v_cvt_pk_bf16_f32 v81, v177, v178
    v_cvt_pk_bf16_f32 v82, v179, v192
    v_mfma_f32_16x16x32_bf16 v[188:191], v[156:159], v[92:95], v[224:227]
    v_mfma_f32_16x16x32_bf16 v[172:175], v[140:143], v[92:95], 0
    v_mfma_f32_16x16x32_bf16 v[192:195], v[160:163], v[96:99], v[224:227]
    v_mfma_f32_16x16x32_bf16 v[176:179], v[144:147], v[96:99], 0
    v_rcp_f32 v181, v181
    v_rcp_f32 v185, v185
    v_pk_mul_f32 v[164:165], v[164:165], v[180:181] op_sel:[0,1]
    v_pk_mul_f32 v[166:167], v[166:167], v[180:181] op_sel:[0,1]
    v_mul_f32 v180, v180, v181
    v_pk_mul_f32 v[168:169], v[168:169], v[184:185] op_sel:[0,1]
    v_pk_mul_f32 v[170:171], v[170:171], v[184:185] op_sel:[0,1]
    v_mul_f32 v184, v184, v185
    v_cvt_pk_bf16_f32 v19, v164, v165
    v_cvt_pk_bf16_f32 v20, v166, v167
    v_cvt_pk_bf16_f32 v21, v180, v168
    v_cvt_pk_bf16_f32 v22, v169, v170
    v_cvt_pk_bf16_f32 v23, v171, v184
    ds_read_b128 v[156:159], v233 offset:10240
    ds_read_b128 v[140:143], v232 offset:10240
    ds_read_b128 v[160:163], v233 offset:11264
    ds_read_b128 v[144:147], v232 offset:11264
    s_waitcnt vmcnt(12)
    s_waitcnt lgkmcnt(4)
    v_mfma_f32_16x16x32_bf16 v[180:183], v[148:151], v[36:39], v[224:227]
    v_mfma_f32_16x16x32_bf16 v[164:167], v[132:135], v[36:39], 0
    v_mfma_f32_16x16x32_bf16 v[184:187], v[152:155], v[40:43], v[224:227]
    v_mfma_f32_16x16x32_bf16 v[168:171], v[136:139], v[40:43], 0
    v_rcp_f32 v189, v189
    v_rcp_f32 v193, v193
    v_pk_mul_f32 v[172:173], v[172:173], v[188:189] op_sel:[0,1]
    v_pk_mul_f32 v[174:175], v[174:175], v[188:189] op_sel:[0,1]
    v_mul_f32 v188, v188, v189
    v_pk_mul_f32 v[176:177], v[176:177], v[192:193] op_sel:[0,1]
    v_pk_mul_f32 v[178:179], v[178:179], v[192:193] op_sel:[0,1]
    v_mul_f32 v192, v192, v193
    v_cvt_pk_bf16_f32 v83, v172, v173
    v_cvt_pk_bf16_f32 v84, v174, v175
    v_cvt_pk_bf16_f32 v85, v188, v176
    v_cvt_pk_bf16_f32 v86, v177, v178
    v_cvt_pk_bf16_f32 v87, v179, v192
    v_mfma_f32_16x16x32_bf16 v[188:191], v[148:151], v[100:103], v[224:227]
    v_mfma_f32_16x16x32_bf16 v[172:175], v[132:135], v[100:103], 0
    v_mfma_f32_16x16x32_bf16 v[192:195], v[152:155], v[104:107], v[224:227]
    v_mfma_f32_16x16x32_bf16 v[176:179], v[136:139], v[104:107], 0
    v_rcp_f32 v181, v181
    v_rcp_f32 v185, v185
    v_pk_mul_f32 v[164:165], v[164:165], v[180:181] op_sel:[0,1]
    v_pk_mul_f32 v[166:167], v[166:167], v[180:181] op_sel:[0,1]
    v_mul_f32 v180, v180, v181
    v_pk_mul_f32 v[168:169], v[168:169], v[184:185] op_sel:[0,1]
    v_pk_mul_f32 v[170:171], v[170:171], v[184:185] op_sel:[0,1]
    v_mul_f32 v184, v184, v185
    v_cvt_pk_bf16_f32 v24, v164, v165
    v_cvt_pk_bf16_f32 v25, v166, v167
    v_cvt_pk_bf16_f32 v26, v180, v168
    v_cvt_pk_bf16_f32 v27, v169, v170
    v_cvt_pk_bf16_f32 v28, v171, v184
    ds_read_b128 v[148:151], v233 offset:12288
    ds_read_b128 v[132:135], v232 offset:12288
    ds_read_b128 v[152:155], v233 offset:13312
    ds_read_b128 v[136:139], v232 offset:13312
    s_waitcnt vmcnt(8)
    s_waitcnt lgkmcnt(4)
    v_mfma_f32_16x16x32_bf16 v[180:183], v[156:159], v[44:47], v[224:227]
    v_mfma_f32_16x16x32_bf16 v[164:167], v[140:143], v[44:47], 0
    v_mfma_f32_16x16x32_bf16 v[184:187], v[160:163], v[48:51], v[224:227]
    v_mfma_f32_16x16x32_bf16 v[168:171], v[144:147], v[48:51], 0
    v_rcp_f32 v189, v189
    v_rcp_f32 v193, v193
    v_pk_mul_f32 v[172:173], v[172:173], v[188:189] op_sel:[0,1]
    v_pk_mul_f32 v[174:175], v[174:175], v[188:189] op_sel:[0,1]
    v_mul_f32 v188, v188, v189
    v_pk_mul_f32 v[176:177], v[176:177], v[192:193] op_sel:[0,1]
    v_pk_mul_f32 v[178:179], v[178:179], v[192:193] op_sel:[0,1]
    v_mul_f32 v192, v192, v193
    v_cvt_pk_bf16_f32 v88, v172, v173
    v_cvt_pk_bf16_f32 v89, v174, v175
    v_cvt_pk_bf16_f32 v90, v188, v176
    v_cvt_pk_bf16_f32 v91, v177, v178
    v_cvt_pk_bf16_f32 v92, v179, v192
    v_mfma_f32_16x16x32_bf16 v[188:191], v[156:159], v[108:111], v[224:227]
    v_mfma_f32_16x16x32_bf16 v[172:175], v[140:143], v[108:111], 0
    v_mfma_f32_16x16x32_bf16 v[192:195], v[160:163], v[112:115], v[224:227]
    v_mfma_f32_16x16x32_bf16 v[176:179], v[144:147], v[112:115], 0
    v_rcp_f32 v181, v181
    v_rcp_f32 v185, v185
    v_pk_mul_f32 v[164:165], v[164:165], v[180:181] op_sel:[0,1]
    v_pk_mul_f32 v[166:167], v[166:167], v[180:181] op_sel:[0,1]
    v_mul_f32 v180, v180, v181
    v_pk_mul_f32 v[168:169], v[168:169], v[184:185] op_sel:[0,1]
    v_pk_mul_f32 v[170:171], v[170:171], v[184:185] op_sel:[0,1]
    v_mul_f32 v184, v184, v185
    v_cvt_pk_bf16_f32 v29, v164, v165
    v_cvt_pk_bf16_f32 v30, v166, v167
    v_cvt_pk_bf16_f32 v31, v180, v168
    v_cvt_pk_bf16_f32 v32, v169, v170
    v_cvt_pk_bf16_f32 v33, v171, v184
    ds_read_b128 v[156:159], v233 offset:14336
    ds_read_b128 v[140:143], v232 offset:14336
    ds_read_b128 v[160:163], v233 offset:15360
    ds_read_b128 v[144:147], v232 offset:15360
    s_waitcnt vmcnt(4)
    s_waitcnt lgkmcnt(4)
    v_mfma_f32_16x16x32_bf16 v[180:183], v[148:151], v[52:55], v[224:227]
    v_mfma_f32_16x16x32_bf16 v[164:167], v[132:135], v[52:55], 0
    v_mfma_f32_16x16x32_bf16 v[184:187], v[152:155], v[56:59], v[224:227]
    v_mfma_f32_16x16x32_bf16 v[168:171], v[136:139], v[56:59], 0
    v_rcp_f32 v189, v189
    v_rcp_f32 v193, v193
    v_pk_mul_f32 v[172:173], v[172:173], v[188:189] op_sel:[0,1]
    v_pk_mul_f32 v[174:175], v[174:175], v[188:189] op_sel:[0,1]
    v_mul_f32 v188, v188, v189
    v_pk_mul_f32 v[176:177], v[176:177], v[192:193] op_sel:[0,1]
    v_pk_mul_f32 v[178:179], v[178:179], v[192:193] op_sel:[0,1]
    v_mul_f32 v192, v192, v193
    v_cvt_pk_bf16_f32 v93, v172, v173
    v_cvt_pk_bf16_f32 v94, v174, v175
    v_cvt_pk_bf16_f32 v95, v188, v176
    v_cvt_pk_bf16_f32 v96, v177, v178
    v_cvt_pk_bf16_f32 v97, v179, v192
    v_mfma_f32_16x16x32_bf16 v[188:191], v[148:151], v[116:119], v[224:227]
    v_mfma_f32_16x16x32_bf16 v[172:175], v[132:135], v[116:119], 0
    v_mfma_f32_16x16x32_bf16 v[192:195], v[152:155], v[120:123], v[224:227]
    v_mfma_f32_16x16x32_bf16 v[176:179], v[136:139], v[120:123], 0
    v_rcp_f32 v181, v181
    v_rcp_f32 v185, v185
    v_pk_mul_f32 v[164:165], v[164:165], v[180:181] op_sel:[0,1]
    v_pk_mul_f32 v[166:167], v[166:167], v[180:181] op_sel:[0,1]
    v_mul_f32 v180, v180, v181
    v_pk_mul_f32 v[168:169], v[168:169], v[184:185] op_sel:[0,1]
    v_pk_mul_f32 v[170:171], v[170:171], v[184:185] op_sel:[0,1]
    v_mul_f32 v184, v184, v185
    v_cvt_pk_bf16_f32 v34, v164, v165
    v_cvt_pk_bf16_f32 v35, v166, v167
    v_cvt_pk_bf16_f32 v36, v180, v168
    v_cvt_pk_bf16_f32 v37, v169, v170
    v_cvt_pk_bf16_f32 v38, v171, v184
    s_waitcnt vmcnt(0)
    s_waitcnt lgkmcnt(0)
    v_mfma_f32_16x16x32_bf16 v[180:183], v[156:159], v[60:63], v[224:227]
    v_mfma_f32_16x16x32_bf16 v[164:167], v[140:143], v[60:63], 0
    v_mfma_f32_16x16x32_bf16 v[184:187], v[160:163], v[64:67], v[224:227]
    v_mfma_f32_16x16x32_bf16 v[168:171], v[144:147], v[64:67], 0
    v_rcp_f32 v189, v189
    v_rcp_f32 v193, v193
    v_pk_mul_f32 v[172:173], v[172:173], v[188:189] op_sel:[0,1]
    v_pk_mul_f32 v[174:175], v[174:175], v[188:189] op_sel:[0,1]
    v_mul_f32 v188, v188, v189
    v_pk_mul_f32 v[176:177], v[176:177], v[192:193] op_sel:[0,1]
    v_pk_mul_f32 v[178:179], v[178:179], v[192:193] op_sel:[0,1]
    v_mul_f32 v192, v192, v193
    v_cvt_pk_bf16_f32 v98, v172, v173
    v_cvt_pk_bf16_f32 v99, v174, v175
    v_cvt_pk_bf16_f32 v100, v188, v176
    v_cvt_pk_bf16_f32 v101, v177, v178
    v_cvt_pk_bf16_f32 v102, v179, v192
    v_mfma_f32_16x16x32_bf16 v[188:191], v[156:159], v[124:127], v[224:227]
    v_mfma_f32_16x16x32_bf16 v[172:175], v[140:143], v[124:127], 0
    v_mfma_f32_16x16x32_bf16 v[192:195], v[160:163], v[128:131], v[224:227]
    v_mfma_f32_16x16x32_bf16 v[176:179], v[144:147], v[128:131], 0
    v_rcp_f32 v181, v181
    v_rcp_f32 v185, v185
    v_pk_mul_f32 v[164:165], v[164:165], v[180:181] op_sel:[0,1]
    v_pk_mul_f32 v[166:167], v[166:167], v[180:181] op_sel:[0,1]
    v_mul_f32 v180, v180, v181
    v_pk_mul_f32 v[168:169], v[168:169], v[184:185] op_sel:[0,1]
    v_pk_mul_f32 v[170:171], v[170:171], v[184:185] op_sel:[0,1]
    v_mul_f32 v184, v184, v185
    v_cvt_pk_bf16_f32 v39, v164, v165
    v_cvt_pk_bf16_f32 v40, v166, v167
    v_cvt_pk_bf16_f32 v41, v180, v168
    v_cvt_pk_bf16_f32 v42, v169, v170
    v_cvt_pk_bf16_f32 v43, v171, v184
    ds_read_b64_tr_b16 v[132:133], v234 offset:0
    ds_read_b64_tr_b16 v[134:135], v234 offset:1280
    ds_read_b64_tr_b16 v[136:137], v234 offset:32
    ds_read_b64_tr_b16 v[138:139], v234 offset:1312
    ds_read_b64_tr_b16 v[140:141], v234 offset:64
    ds_read_b64_tr_b16 v[142:143], v234 offset:1344
    ds_read_b64_tr_b16 v[144:145], v234 offset:96
    ds_read_b64_tr_b16 v[146:147], v234 offset:1376
    ds_read_b64_tr_b16 v[148:149], v234 offset:128
    ds_read_b64_tr_b16 v[150:151], v234 offset:1408
    v_rcp_f32 v189, v189
    v_rcp_f32 v193, v193
    v_pk_mul_f32 v[172:173], v[172:173], v[188:189] op_sel:[0,1]
    v_pk_mul_f32 v[174:175], v[174:175], v[188:189] op_sel:[0,1]
    v_mul_f32 v188, v188, v189
    v_pk_mul_f32 v[176:177], v[176:177], v[192:193] op_sel:[0,1]
    v_pk_mul_f32 v[178:179], v[178:179], v[192:193] op_sel:[0,1]
    v_mul_f32 v192, v192, v193
    v_cvt_pk_bf16_f32 v103, v172, v173
    v_cvt_pk_bf16_f32 v104, v174, v175
    v_cvt_pk_bf16_f32 v105, v188, v176
    v_cvt_pk_bf16_f32 v106, v177, v178
    v_cvt_pk_bf16_f32 v107, v179, v192
    s_waitcnt lgkmcnt(8)
    v_mfma_f32_16x16x32_bf16 v[172:175], v[132:135], v[4:7], 0
    ds_read_b64_tr_b16 v[152:153], v234 offset:5120
    v_mfma_f32_16x16x32_bf16 v[192:195], v[132:135], v[68:71], 0
    ds_read_b64_tr_b16 v[154:155], v234 offset:6400
    s_waitcnt lgkmcnt(8)
    v_mfma_f32_16x16x32_bf16 v[176:179], v[136:139], v[4:7], 0
    ds_read_b64_tr_b16 v[156:157], v234 offset:5152
    v_mfma_f32_16x16x32_bf16 v[196:199], v[136:139], v[68:71], 0
    ds_read_b64_tr_b16 v[158:159], v234 offset:6432
    s_waitcnt lgkmcnt(8)
    v_mfma_f32_16x16x32_bf16 v[180:183], v[140:143], v[4:7], 0
    ds_read_b64_tr_b16 v[160:161], v234 offset:5184
    v_mfma_f32_16x16x32_bf16 v[200:203], v[140:143], v[68:71], 0
    ds_read_b64_tr_b16 v[162:163], v234 offset:6464
    s_waitcnt lgkmcnt(8)
    v_mfma_f32_16x16x32_bf16 v[184:187], v[144:147], v[4:7], 0
    ds_read_b64_tr_b16 v[164:165], v234 offset:5216
    v_mfma_f32_16x16x32_bf16 v[204:207], v[144:147], v[68:71], 0
    ds_read_b64_tr_b16 v[166:167], v234 offset:6496
    s_waitcnt lgkmcnt(8)
    v_mfma_f32_16x16x32_bf16 v[188:191], v[148:151], v[4:7], 0
    ds_read_b64_tr_b16 v[168:169], v234 offset:5248
    v_mfma_f32_16x16x32_bf16 v[208:211], v[148:151], v[68:71], 0
    ds_read_b64_tr_b16 v[170:171], v234 offset:6528
    s_waitcnt lgkmcnt(8)
    v_mfma_f32_16x16x32_bf16 v[172:175], v[152:155], v[8:11], v[172:175]
    ds_read_b64_tr_b16 v[132:133], v234 offset:10240
    v_mfma_f32_16x16x32_bf16 v[192:195], v[152:155], v[72:75], v[192:195]
    ds_read_b64_tr_b16 v[134:135], v234 offset:11520
    s_waitcnt lgkmcnt(8)
    v_mfma_f32_16x16x32_bf16 v[176:179], v[156:159], v[8:11], v[176:179]
    ds_read_b64_tr_b16 v[136:137], v234 offset:10272
    v_mfma_f32_16x16x32_bf16 v[196:199], v[156:159], v[72:75], v[196:199]
    ds_read_b64_tr_b16 v[138:139], v234 offset:11552
    s_waitcnt lgkmcnt(8)
    v_mfma_f32_16x16x32_bf16 v[180:183], v[160:163], v[8:11], v[180:183]
    ds_read_b64_tr_b16 v[140:141], v234 offset:10304
    v_mfma_f32_16x16x32_bf16 v[200:203], v[160:163], v[72:75], v[200:203]
    ds_read_b64_tr_b16 v[142:143], v234 offset:11584
    s_waitcnt lgkmcnt(8)
    v_mfma_f32_16x16x32_bf16 v[184:187], v[164:167], v[8:11], v[184:187]
    ds_read_b64_tr_b16 v[144:145], v234 offset:10336
    v_mfma_f32_16x16x32_bf16 v[204:207], v[164:167], v[72:75], v[204:207]
    ds_read_b64_tr_b16 v[146:147], v234 offset:11616
    s_waitcnt lgkmcnt(8)
    v_mfma_f32_16x16x32_bf16 v[188:191], v[168:171], v[8:11], v[188:191]
    ds_read_b64_tr_b16 v[148:149], v234 offset:10368
    v_mfma_f32_16x16x32_bf16 v[208:211], v[168:171], v[72:75], v[208:211]
    ds_read_b64_tr_b16 v[150:151], v234 offset:11648
    s_waitcnt lgkmcnt(8)
    v_mfma_f32_16x16x32_bf16 v[172:175], v[132:135], v[12:15], v[172:175]
    ds_read_b64_tr_b16 v[152:153], v234 offset:15360
    v_mfma_f32_16x16x32_bf16 v[192:195], v[132:135], v[76:79], v[192:195]
    ds_read_b64_tr_b16 v[154:155], v234 offset:16640
    s_waitcnt lgkmcnt(8)
    v_mfma_f32_16x16x32_bf16 v[176:179], v[136:139], v[12:15], v[176:179]
    ds_read_b64_tr_b16 v[156:157], v234 offset:15392
    v_mfma_f32_16x16x32_bf16 v[196:199], v[136:139], v[76:79], v[196:199]
    ds_read_b64_tr_b16 v[158:159], v234 offset:16672
    s_waitcnt lgkmcnt(8)
    v_mfma_f32_16x16x32_bf16 v[180:183], v[140:143], v[12:15], v[180:183]
    ds_read_b64_tr_b16 v[160:161], v234 offset:15424
    v_mfma_f32_16x16x32_bf16 v[200:203], v[140:143], v[76:79], v[200:203]
    ds_read_b64_tr_b16 v[162:163], v234 offset:16704
    s_waitcnt lgkmcnt(8)
    v_mfma_f32_16x16x32_bf16 v[184:187], v[144:147], v[12:15], v[184:187]
    ds_read_b64_tr_b16 v[164:165], v234 offset:15456
    v_mfma_f32_16x16x32_bf16 v[204:207], v[144:147], v[76:79], v[204:207]
    ds_read_b64_tr_b16 v[166:167], v234 offset:16736
    s_waitcnt lgkmcnt(8)
    v_mfma_f32_16x16x32_bf16 v[188:191], v[148:151], v[12:15], v[188:191]
    ds_read_b64_tr_b16 v[168:169], v234 offset:15488
    v_mfma_f32_16x16x32_bf16 v[208:211], v[148:151], v[76:79], v[208:211]
    ds_read_b64_tr_b16 v[170:171], v234 offset:16768
    s_waitcnt lgkmcnt(8)
    v_mfma_f32_16x16x32_bf16 v[172:175], v[152:155], v[16:19], v[172:175]
    ds_read_b64_tr_b16 v[132:133], v234 offset:20480
    v_mfma_f32_16x16x32_bf16 v[192:195], v[152:155], v[80:83], v[192:195]
    ds_read_b64_tr_b16 v[134:135], v234 offset:21760
    s_waitcnt lgkmcnt(8)
    v_mfma_f32_16x16x32_bf16 v[176:179], v[156:159], v[16:19], v[176:179]
    ds_read_b64_tr_b16 v[136:137], v234 offset:20512
    v_mfma_f32_16x16x32_bf16 v[196:199], v[156:159], v[80:83], v[196:199]
    ds_read_b64_tr_b16 v[138:139], v234 offset:21792
    s_waitcnt lgkmcnt(8)
    v_mfma_f32_16x16x32_bf16 v[180:183], v[160:163], v[16:19], v[180:183]
    ds_read_b64_tr_b16 v[140:141], v234 offset:20544
    v_mfma_f32_16x16x32_bf16 v[200:203], v[160:163], v[80:83], v[200:203]
    ds_read_b64_tr_b16 v[142:143], v234 offset:21824
    s_waitcnt lgkmcnt(8)
    v_mfma_f32_16x16x32_bf16 v[184:187], v[164:167], v[16:19], v[184:187]
    ds_read_b64_tr_b16 v[144:145], v234 offset:20576
    v_mfma_f32_16x16x32_bf16 v[204:207], v[164:167], v[80:83], v[204:207]
    ds_read_b64_tr_b16 v[146:147], v234 offset:21856
    s_waitcnt lgkmcnt(8)
    v_mfma_f32_16x16x32_bf16 v[188:191], v[168:171], v[16:19], v[188:191]
    ds_read_b64_tr_b16 v[148:149], v234 offset:20608
    v_mfma_f32_16x16x32_bf16 v[208:211], v[168:171], v[80:83], v[208:211]
    ds_read_b64_tr_b16 v[150:151], v234 offset:21888
    s_waitcnt lgkmcnt(8)
    v_mfma_f32_16x16x32_bf16 v[172:175], v[132:135], v[20:23], v[172:175]
    ds_read_b64_tr_b16 v[152:153], v234 offset:25600
    v_mfma_f32_16x16x32_bf16 v[192:195], v[132:135], v[84:87], v[192:195]
    ds_read_b64_tr_b16 v[154:155], v234 offset:26880
    s_waitcnt lgkmcnt(8)
    v_mfma_f32_16x16x32_bf16 v[176:179], v[136:139], v[20:23], v[176:179]
    ds_read_b64_tr_b16 v[156:157], v234 offset:25632
    v_mfma_f32_16x16x32_bf16 v[196:199], v[136:139], v[84:87], v[196:199]
    ds_read_b64_tr_b16 v[158:159], v234 offset:26912
    s_waitcnt lgkmcnt(8)
    v_mfma_f32_16x16x32_bf16 v[180:183], v[140:143], v[20:23], v[180:183]
    ds_read_b64_tr_b16 v[160:161], v234 offset:25664
    v_mfma_f32_16x16x32_bf16 v[200:203], v[140:143], v[84:87], v[200:203]
    ds_read_b64_tr_b16 v[162:163], v234 offset:26944
    s_waitcnt lgkmcnt(8)
    v_mfma_f32_16x16x32_bf16 v[184:187], v[144:147], v[20:23], v[184:187]
    ds_read_b64_tr_b16 v[164:165], v234 offset:25696
    v_mfma_f32_16x16x32_bf16 v[204:207], v[144:147], v[84:87], v[204:207]
    ds_read_b64_tr_b16 v[166:167], v234 offset:26976
    s_waitcnt lgkmcnt(8)
    v_mfma_f32_16x16x32_bf16 v[188:191], v[148:151], v[20:23], v[188:191]
    ds_read_b64_tr_b16 v[168:169], v234 offset:25728
    v_mfma_f32_16x16x32_bf16 v[208:211], v[148:151], v[84:87], v[208:211]
    ds_read_b64_tr_b16 v[170:171], v234 offset:27008
    s_waitcnt lgkmcnt(8)
    v_mfma_f32_16x16x32_bf16 v[172:175], v[152:155], v[24:27], v[172:175]
    ds_read_b64_tr_b16 v[132:133], v234 offset:30720
    v_mfma_f32_16x16x32_bf16 v[192:195], v[152:155], v[88:91], v[192:195]
    ds_read_b64_tr_b16 v[134:135], v234 offset:32000
    s_waitcnt lgkmcnt(8)
    v_mfma_f32_16x16x32_bf16 v[176:179], v[156:159], v[24:27], v[176:179]
    ds_read_b64_tr_b16 v[136:137], v234 offset:30752
    v_mfma_f32_16x16x32_bf16 v[196:199], v[156:159], v[88:91], v[196:199]
    ds_read_b64_tr_b16 v[138:139], v234 offset:32032
    s_waitcnt lgkmcnt(8)
    v_mfma_f32_16x16x32_bf16 v[180:183], v[160:163], v[24:27], v[180:183]
    ds_read_b64_tr_b16 v[140:141], v234 offset:30784
    v_mfma_f32_16x16x32_bf16 v[200:203], v[160:163], v[88:91], v[200:203]
    ds_read_b64_tr_b16 v[142:143], v234 offset:32064
    s_waitcnt lgkmcnt(8)
    v_mfma_f32_16x16x32_bf16 v[184:187], v[164:167], v[24:27], v[184:187]
    ds_read_b64_tr_b16 v[144:145], v234 offset:30816
    v_mfma_f32_16x16x32_bf16 v[204:207], v[164:167], v[88:91], v[204:207]
    ds_read_b64_tr_b16 v[146:147], v234 offset:32096
    s_waitcnt lgkmcnt(8)
    v_mfma_f32_16x16x32_bf16 v[188:191], v[168:171], v[24:27], v[188:191]
    ds_read_b64_tr_b16 v[148:149], v234 offset:30848
    v_mfma_f32_16x16x32_bf16 v[208:211], v[168:171], v[88:91], v[208:211]
    ds_read_b64_tr_b16 v[150:151], v234 offset:32128
    s_waitcnt lgkmcnt(8)
    v_mfma_f32_16x16x32_bf16 v[172:175], v[132:135], v[28:31], v[172:175]
    ds_read_b64_tr_b16 v[152:153], v234 offset:35840
    v_mfma_f32_16x16x32_bf16 v[192:195], v[132:135], v[92:95], v[192:195]
    ds_read_b64_tr_b16 v[154:155], v234 offset:37120
    s_waitcnt lgkmcnt(8)
    v_mfma_f32_16x16x32_bf16 v[176:179], v[136:139], v[28:31], v[176:179]
    ds_read_b64_tr_b16 v[156:157], v234 offset:35872
    v_mfma_f32_16x16x32_bf16 v[196:199], v[136:139], v[92:95], v[196:199]
    ds_read_b64_tr_b16 v[158:159], v234 offset:37152
    s_waitcnt lgkmcnt(8)
    v_mfma_f32_16x16x32_bf16 v[180:183], v[140:143], v[28:31], v[180:183]
    ds_read_b64_tr_b16 v[160:161], v234 offset:35904
    v_mfma_f32_16x16x32_bf16 v[200:203], v[140:143], v[92:95], v[200:203]
    ds_read_b64_tr_b16 v[162:163], v234 offset:37184
    s_waitcnt lgkmcnt(8)
    v_mfma_f32_16x16x32_bf16 v[184:187], v[144:147], v[28:31], v[184:187]
    ds_read_b64_tr_b16 v[164:165], v234 offset:35936
    v_mfma_f32_16x16x32_bf16 v[204:207], v[144:147], v[92:95], v[204:207]
    ds_read_b64_tr_b16 v[166:167], v234 offset:37216
    s_waitcnt lgkmcnt(8)
    v_mfma_f32_16x16x32_bf16 v[188:191], v[148:151], v[28:31], v[188:191]
    ds_read_b64_tr_b16 v[168:169], v234 offset:35968
    v_mfma_f32_16x16x32_bf16 v[208:211], v[148:151], v[92:95], v[208:211]
    ds_read_b64_tr_b16 v[170:171], v234 offset:37248
    s_waitcnt lgkmcnt(8)
    v_mfma_f32_16x16x32_bf16 v[172:175], v[152:155], v[32:35], v[172:175]
    ds_read_b64_tr_b16 v[132:133], v234 offset:40960
    v_mfma_f32_16x16x32_bf16 v[192:195], v[152:155], v[96:99], v[192:195]
    ds_read_b64_tr_b16 v[134:135], v234 offset:42240
    s_waitcnt lgkmcnt(8)
    v_mfma_f32_16x16x32_bf16 v[176:179], v[156:159], v[32:35], v[176:179]
    ds_read_b64_tr_b16 v[136:137], v234 offset:40992
    v_mfma_f32_16x16x32_bf16 v[196:199], v[156:159], v[96:99], v[196:199]
    ds_read_b64_tr_b16 v[138:139], v234 offset:42272
    s_waitcnt lgkmcnt(8)
    v_mfma_f32_16x16x32_bf16 v[180:183], v[160:163], v[32:35], v[180:183]
    ds_read_b64_tr_b16 v[140:141], v234 offset:41024
    v_mfma_f32_16x16x32_bf16 v[200:203], v[160:163], v[96:99], v[200:203]
    ds_read_b64_tr_b16 v[142:143], v234 offset:42304
    s_waitcnt lgkmcnt(8)
    v_mfma_f32_16x16x32_bf16 v[184:187], v[164:167], v[32:35], v[184:187]
    ds_read_b64_tr_b16 v[144:145], v234 offset:41056
    v_mfma_f32_16x16x32_bf16 v[204:207], v[164:167], v[96:99], v[204:207]
    ds_read_b64_tr_b16 v[146:147], v234 offset:42336
    s_waitcnt lgkmcnt(8)
    v_mfma_f32_16x16x32_bf16 v[188:191], v[168:171], v[32:35], v[188:191]
    ds_read_b64_tr_b16 v[148:149], v234 offset:41088
    v_mfma_f32_16x16x32_bf16 v[208:211], v[168:171], v[96:99], v[208:211]
    ds_read_b64_tr_b16 v[150:151], v234 offset:42368
    s_waitcnt lgkmcnt(8)
    v_mfma_f32_16x16x32_bf16 v[172:175], v[132:135], v[36:39], v[172:175]
    ds_read_b64_tr_b16 v[152:153], v234 offset:46080
    v_mfma_f32_16x16x32_bf16 v[192:195], v[132:135], v[100:103], v[192:195]
    ds_read_b64_tr_b16 v[154:155], v234 offset:47360
    s_waitcnt lgkmcnt(8)
    v_mfma_f32_16x16x32_bf16 v[176:179], v[136:139], v[36:39], v[176:179]
    ds_read_b64_tr_b16 v[156:157], v234 offset:46112
    v_mfma_f32_16x16x32_bf16 v[196:199], v[136:139], v[100:103], v[196:199]
    ds_read_b64_tr_b16 v[158:159], v234 offset:47392
    s_waitcnt lgkmcnt(8)
    v_mfma_f32_16x16x32_bf16 v[180:183], v[140:143], v[36:39], v[180:183]
    ds_read_b64_tr_b16 v[160:161], v234 offset:46144
    v_mfma_f32_16x16x32_bf16 v[200:203], v[140:143], v[100:103], v[200:203]
    ds_read_b64_tr_b16 v[162:163], v234 offset:47424
    s_waitcnt lgkmcnt(8)
    v_mfma_f32_16x16x32_bf16 v[184:187], v[144:147], v[36:39], v[184:187]
    ds_read_b64_tr_b16 v[164:165], v234 offset:46176
    v_mfma_f32_16x16x32_bf16 v[204:207], v[144:147], v[100:103], v[204:207]
    ds_read_b64_tr_b16 v[166:167], v234 offset:47456
    s_waitcnt lgkmcnt(8)
    v_mfma_f32_16x16x32_bf16 v[188:191], v[148:151], v[36:39], v[188:191]
    ds_read_b64_tr_b16 v[168:169], v234 offset:46208
    v_mfma_f32_16x16x32_bf16 v[208:211], v[148:151], v[100:103], v[208:211]
    ds_read_b64_tr_b16 v[170:171], v234 offset:47488
    s_waitcnt lgkmcnt(8)
    v_mfma_f32_16x16x32_bf16 v[172:175], v[152:155], v[40:43], v[172:175]
    v_mfma_f32_16x16x32_bf16 v[192:195], v[152:155], v[104:107], v[192:195]
    s_waitcnt lgkmcnt(6)
    v_mfma_f32_16x16x32_bf16 v[176:179], v[156:159], v[40:43], v[176:179]
    v_mfma_f32_16x16x32_bf16 v[196:199], v[156:159], v[104:107], v[196:199]
    s_waitcnt lgkmcnt(4)
    v_mfma_f32_16x16x32_bf16 v[180:183], v[160:163], v[40:43], v[180:183]
    v_mfma_f32_16x16x32_bf16 v[200:203], v[160:163], v[104:107], v[200:203]
    s_waitcnt lgkmcnt(2)
    v_mfma_f32_16x16x32_bf16 v[184:187], v[164:167], v[40:43], v[184:187]
    v_mfma_f32_16x16x32_bf16 v[204:207], v[164:167], v[104:107], v[204:207]
    s_waitcnt lgkmcnt(0)
    v_mfma_f32_16x16x32_bf16 v[188:191], v[168:171], v[40:43], v[188:191]
    v_mfma_f32_16x16x32_bf16 v[208:211], v[168:171], v[104:107], v[208:211]
    s_add_u32 s40, s20, 4194304
    s_addc_u32 s41, s21, 0
    s_mov_b32 s42, 2621440
    s_mov_b32 s43, 0x20000
    s_add_u32 s44, s20, 17039360
    s_addc_u32 s45, s21, 0
    s_mov_b32 s46, 131072
    s_mov_b32 s47, 0x20000
    ds_write_b128 v236, v[192:195] offset:0
    ds_write_b128 v236, v[196:199] offset:1024
    ds_write_b128 v236, v[200:203] offset:2048
    ds_write_b128 v236, v[204:207] offset:3072
    ds_write_b128 v236, v[208:211] offset:4096
    v_mov_b64 v[152:153], 0
    v_mov_b64 v[154:155], 0
    s_waitcnt lgkmcnt(0)
    s_barrier
    ds_read_b128 v[132:135], v237 offset:0
    ds_read_b128 v[136:139], v237 offset:1024
    ds_read_b128 v[140:143], v237 offset:2048
    ds_read_b128 v[144:147], v237 offset:3072
    ds_read_b128 v[148:151], v237 offset:4096
    s_waitcnt lgkmcnt(4)
    v_pk_add_f32 v[172:173], v[172:173], v[132:133]
    v_pk_add_f32 v[174:175], v[174:175], v[134:135]
    v_cvt_pk_bf16_f32 v160, v172, v173
    v_cvt_pk_bf16_f32 v161, v174, v175
    s_waitcnt lgkmcnt(3)
    v_pk_add_f32 v[176:177], v[176:177], v[136:137]
    v_pk_add_f32 v[178:179], v[178:179], v[138:139]
    v_cvt_pk_bf16_f32 v162, v176, v177
    v_cvt_pk_bf16_f32 v163, v178, v179
    s_waitcnt lgkmcnt(2)
    v_pk_add_f32 v[180:181], v[180:181], v[140:141]
    v_pk_add_f32 v[182:183], v[182:183], v[142:143]
    v_cvt_pk_bf16_f32 v164, v180, v181
    v_cvt_pk_bf16_f32 v165, v182, v183
    s_waitcnt lgkmcnt(1)
    v_pk_add_f32 v[184:185], v[184:185], v[144:145]
    v_pk_add_f32 v[186:187], v[186:187], v[146:147]
    v_cvt_pk_bf16_f32 v166, v184, v185
    v_cvt_pk_bf16_f32 v167, v186, v187
    s_waitcnt lgkmcnt(0)
    v_pk_add_f32 v[188:189], v[188:189], v[148:149]
    v_pk_add_f32 v[190:191], v[190:191], v[150:151]
    v_cvt_pk_bf16_f32 v168, v188, v189
    v_cvt_pk_bf16_f32 v169, v190, v191
    v_permlane16_swap_b32 v160, v162
    v_permlane16_swap_b32 v161, v163
    v_permlane16_swap_b32 v164, v166
    v_permlane16_swap_b32 v165, v167
    v_lshlrev_b32 v156, 16, v160
    v_and_b32 v157, 0xffff0000, v160
    v_lshlrev_b32 v158, 16, v212
    v_and_b32 v159, 0xffff0000, v212
    v_pk_add_f32 v[156:157], v[156:157], v[158:159]
    v_cvt_pk_bf16_f32 v160, v156, v157
    v_lshlrev_b32 v156, 16, v161
    v_and_b32 v157, 0xffff0000, v161
    v_lshlrev_b32 v158, 16, v213
    v_and_b32 v159, 0xffff0000, v213
    v_pk_add_f32 v[156:157], v[156:157], v[158:159]
    v_cvt_pk_bf16_f32 v161, v156, v157
    v_lshlrev_b32 v156, 16, v162
    v_and_b32 v157, 0xffff0000, v162
    v_lshlrev_b32 v158, 16, v214
    v_and_b32 v159, 0xffff0000, v214
    v_pk_add_f32 v[156:157], v[156:157], v[158:159]
    v_cvt_pk_bf16_f32 v162, v156, v157
    v_lshlrev_b32 v156, 16, v163
    v_and_b32 v157, 0xffff0000, v163
    v_lshlrev_b32 v158, 16, v215
    v_and_b32 v159, 0xffff0000, v215
    v_pk_add_f32 v[156:157], v[156:157], v[158:159]
    v_cvt_pk_bf16_f32 v163, v156, v157
    buffer_store_dwordx4 v[160:163], v228, s[40:43], 0 offen offset:0 sc1
    v_lshlrev_b32 v156, 16, v164
    v_and_b32 v157, 0xffff0000, v164
    v_lshlrev_b32 v158, 16, v216
    v_and_b32 v159, 0xffff0000, v216
    v_pk_add_f32 v[156:157], v[156:157], v[158:159]
    v_cvt_pk_bf16_f32 v164, v156, v157
    v_lshlrev_b32 v156, 16, v165
    v_and_b32 v157, 0xffff0000, v165
    v_lshlrev_b32 v158, 16, v217
    v_and_b32 v159, 0xffff0000, v217
    v_pk_add_f32 v[156:157], v[156:157], v[158:159]
    v_cvt_pk_bf16_f32 v165, v156, v157
    v_lshlrev_b32 v156, 16, v166
    v_and_b32 v157, 0xffff0000, v166
    v_lshlrev_b32 v158, 16, v218
    v_and_b32 v159, 0xffff0000, v218
    v_pk_add_f32 v[156:157], v[156:157], v[158:159]
    v_cvt_pk_bf16_f32 v166, v156, v157
    v_lshlrev_b32 v156, 16, v167
    v_and_b32 v157, 0xffff0000, v167
    v_lshlrev_b32 v158, 16, v219
    v_and_b32 v159, 0xffff0000, v219
    v_pk_add_f32 v[156:157], v[156:157], v[158:159]
    v_cvt_pk_bf16_f32 v167, v156, v157
    buffer_store_dwordx4 v[164:167], v228, s[40:43], 0 offen offset:64 sc1
    v_lshlrev_b32 v156, 16, v168
    v_and_b32 v157, 0xffff0000, v168
    v_lshlrev_b32 v158, 16, v220
    v_and_b32 v159, 0xffff0000, v220
    v_pk_add_f32 v[156:157], v[156:157], v[158:159]
    v_cvt_pk_bf16_f32 v168, v156, v157
    v_lshlrev_b32 v156, 16, v169
    v_and_b32 v157, 0xffff0000, v169
    v_lshlrev_b32 v158, 16, v221
    v_and_b32 v159, 0xffff0000, v221
    v_pk_add_f32 v[156:157], v[156:157], v[158:159]
    v_cvt_pk_bf16_f32 v169, v156, v157
    buffer_store_dwordx2 v[168:169], v229, s[40:43], 0 offen offset:128 sc1
    v_lshlrev_b32 v156, 16, v160
    v_and_b32 v157, 0xffff0000, v160
    v_pk_add_f32 v[152:153], v[152:153], v[156:157]
    v_pk_fma_f32 v[154:155], v[156:157], v[156:157], v[154:155]
    v_lshlrev_b32 v156, 16, v161
    v_and_b32 v157, 0xffff0000, v161
    v_pk_add_f32 v[152:153], v[152:153], v[156:157]
    v_pk_fma_f32 v[154:155], v[156:157], v[156:157], v[154:155]
    v_lshlrev_b32 v156, 16, v162
    v_and_b32 v157, 0xffff0000, v162
    v_pk_add_f32 v[152:153], v[152:153], v[156:157]
    v_pk_fma_f32 v[154:155], v[156:157], v[156:157], v[154:155]
    v_lshlrev_b32 v156, 16, v163
    v_and_b32 v157, 0xffff0000, v163
    v_pk_add_f32 v[152:153], v[152:153], v[156:157]
    v_pk_fma_f32 v[154:155], v[156:157], v[156:157], v[154:155]
    v_lshlrev_b32 v156, 16, v164
    v_and_b32 v157, 0xffff0000, v164
    v_pk_add_f32 v[152:153], v[152:153], v[156:157]
    v_pk_fma_f32 v[154:155], v[156:157], v[156:157], v[154:155]
    v_lshlrev_b32 v156, 16, v165
    v_and_b32 v157, 0xffff0000, v165
    v_pk_add_f32 v[152:153], v[152:153], v[156:157]
    v_pk_fma_f32 v[154:155], v[156:157], v[156:157], v[154:155]
    v_lshlrev_b32 v156, 16, v166
    v_and_b32 v157, 0xffff0000, v166
    v_pk_add_f32 v[152:153], v[152:153], v[156:157]
    v_pk_fma_f32 v[154:155], v[156:157], v[156:157], v[154:155]
    v_lshlrev_b32 v156, 16, v167
    v_and_b32 v157, 0xffff0000, v167
    v_pk_add_f32 v[152:153], v[152:153], v[156:157]
    v_pk_fma_f32 v[154:155], v[156:157], v[156:157], v[154:155]
    v_lshlrev_b32 v156, 16, v168
    v_and_b32 v157, 0xffff0000, v168
    v_pk_add_f32 v[152:153], v[152:153], v[156:157]
    v_pk_fma_f32 v[154:155], v[156:157], v[156:157], v[154:155]
    v_lshlrev_b32 v156, 16, v169
    v_and_b32 v157, 0xffff0000, v169
    v_pk_add_f32 v[152:153], v[152:153], v[156:157]
    v_pk_fma_f32 v[154:155], v[156:157], v[156:157], v[154:155]
    v_add_f32 v152, v152, v153
    v_add_f32 v153, v154, v155
    v_mov_b32 v238, v152
    v_mov_b32 v239, v153
    s_nop 0
    v_permlane16_swap_b32 v152, v238
    v_permlane16_swap_b32 v153, v239
    s_nop 0
    v_add_f32 v152, v152, v238
    v_add_f32 v153, v153, v239
    v_mov_b32 v238, v152
    v_mov_b32 v239, v153
    s_nop 0
    v_permlane32_swap_b32 v152, v238
    v_permlane32_swap_b32 v153, v239
    s_nop 0
    v_add_f32 v152, v152, v238
    v_add_f32 v153, v153, v239
    v_lshlrev_b32 v230, 3, v230
    s_lshl_b32 s30, s49, 14
    s_mov_b64 exec, 0xffff
    buffer_store_dwordx2 v[152:153], v230, s[44:47], s30 offen sc1
    s_mov_b64 exec, -1
    s_and_b32 s48, s23, 3
    s_lshl_b32 s3, s24, 2
    s_add_u32 s48, s48, s3
    s_lshr_b32 s49, s23, 2
    s_mul_i32 s3, s25, 7
    s_add_u32 s49, s49, s3
    s_waitcnt vmcnt(0)
    s_barrier
    s_cmp_ge_u32 s23, 28
    s_cbranch_scc1 sequential_preLN__linear_attn_block__dense_activation_relu__prompt_kernel_p4c86
    s_add_u32 s40, s20, 8388608
    s_addc_u32 s41, s21, 0
    s_mov_b32 s42, 7077888
    s_mov_b32 s43, 0x20000
    v_and_b32 v8, 15, v1
    v_lshrrev_b32 v9, 4, v1
    v_lshlrev_b32 v4, 15, v9
    v_lshl_add_u32 v4, v8, 3, v4
    s_lshl_b32 s30, s48, 10
    s_lshl_b32 s31, s22, 8
    s_add_u32 s30, s30, s31
    v_add_u32 v4, s30, v4
    v_lshlrev_b32 v5, 4, v9
    v_add_u32 v5, 148480, v5
    v_and_b32 v10, 6, v8
    v_xor_b32 v10, v10, v9
    v_lshlrev_b32 v10, 4, v10
    v_lshl_add_u32 v6, v8, 7, v10
    s_lshl_b32 s30, s22, 12
    s_add_u32 s30, s30, 81920
    v_add_u32 v6, s30, v6
    v_xor_b32 v7, 64, v6
    v_mul_u32_u24 v3, 3456, v8
    v_bfe_u32 v8, v1, 4, 1
    v_lshl_add_u32 v3, v8, 5, v3
    v_lshrrev_b32 v8, 5, v1
    v_lshl_add_u32 v3, v8, 4, v3
    s_lshl_b32 s30, s48, 7
    s_lshl_b32 s31, s22, 5
    s_add_u32 s30, s30, s31
    s_mul_i32 s30, s30, 3456
    s_lshl_b32 s31, s49, 8
    s_add_u32 s30, s30, s31
    v_add_u32 v3, s30, v3
    v_bfe_u32 v9, v1, 2, 3
    v_mul_u32_u24 v8, 2048, v8
    v_lshl_add_u32 v8, v9, 7, v8
    v_and_b32 v10, 3, v1
    v_lshl_add_u32 v8, v10, 3, v8
    v_lshrrev_b32 v9, 1, v9
    s_mov_b32 s31, 55296
    v_xor_b32 v10, 0, v9
    v_lshl_add_u32 v11, v10, 5, v8
    v_xor_b32 v10, 1, v9
    v_lshl_add_u32 v12, v10, 5, v8
    v_xor_b32 v10, 2, v9
    v_lshl_add_u32 v13, v10, 5, v8
    v_xor_b32 v10, 3, v9
    v_lshl_add_u32 v14, v10, 5, v8
    s_movk_i32 s50, 16384
    s_mov_b32 s51, 986500301
    s_mov_b32 s52, 925353388
    s_barrier
    buffer_load_dwordx2 v[16:17], v4, s[44:47], 0 offen offset:0 sc1
    buffer_load_dwordx2 v[164:165], v4, s[44:47], s50 offen offset:0 sc1
    buffer_load_dwordx2 v[18:19], v4, s[44:47], 0 offen offset:128 sc1
    buffer_load_dwordx2 v[168:169], v4, s[44:47], s50 offen offset:128 sc1
    s_waitcnt vmcnt(0)
    v_pk_add_f32 v[16:17], v[16:17], v[164:165]
    v_pk_add_f32 v[18:19], v[18:19], v[168:169]
    v_mov_b32 v164, v16
    v_mov_b32 v165, v18
    v_mov_b32 v166, v17
    v_mov_b32 v167, v19
    s_nop 0
    v_permlane16_swap_b32 v16, v164
    v_permlane16_swap_b32 v18, v165
    v_permlane16_swap_b32 v17, v166
    v_permlane16_swap_b32 v19, v167
    s_nop 0
    v_add_f32 v16, v16, v164
    v_add_f32 v18, v18, v165
    v_add_f32 v17, v17, v166
    v_add_f32 v19, v19, v167
    v_mov_b32 v164, v16
    v_mov_b32 v165, v18
    v_mov_b32 v166, v17
    v_mov_b32 v167, v19
    s_nop 0
    v_permlane32_swap_b32 v16, v164
    v_permlane32_swap_b32 v18, v165
    v_permlane32_swap_b32 v17, v166
    v_permlane32_swap_b32 v19, v167
    s_nop 0
    v_add_f32 v16, v16, v164
    v_add_f32 v18, v18, v165
    v_add_f32 v17, v17, v166
    v_add_f32 v19, v19, v167
    v_mul_f32 v16, s51, v16
    v_mul_f32 v17, s51, v17
    v_fma_f32 v17, -v16, v16, v17
    v_max_f32 v17, 0, v17
    v_mul_f32 v18, s51, v18
    v_mul_f32 v19, s51, v19
    v_fma_f32 v19, -v18, v18, v19
    v_max_f32 v19, 0, v19
    v_cvt_pk_bf16_f32 v16, v16, v16
    v_lshlrev_b32 v16, 16, v16
    v_cvt_pk_bf16_f32 v18, v18, v18
    v_lshlrev_b32 v18, 16, v18
    v_cvt_pk_bf16_f32 v17, v17, v17
    v_lshlrev_b32 v17, 16, v17
    v_add_f32 v17, s52, v17
    v_cvt_pk_bf16_f32 v17, v17, v17
    v_lshlrev_b32 v17, 16, v17
    v_cvt_pk_bf16_f32 v19, v19, v19
    v_lshlrev_b32 v19, 16, v19
    v_add_f32 v19, s52, v19
    v_cvt_pk_bf16_f32 v19, v19, v19
    v_lshlrev_b32 v19, 16, v19
    v_sqrt_f32 v17, v17
    v_sqrt_f32 v19, v19
    s_nop 0
    v_cvt_pk_bf16_f32 v17, v17, v17
    v_lshlrev_b32 v17, 16, v17
    v_cvt_pk_bf16_f32 v19, v19, v19
    v_lshlrev_b32 v19, 16, v19
    v_rcp_f32 v17, v17
    v_rcp_f32 v19, v19
    s_nop 0
    s_barrier
    ds_read_b128 v[84:87], v6 offset:0
    ds_read_b128 v[88:91], v6 offset:2048
    ds_read_b128 v[92:95], v7 offset:0
    ds_read_b128 v[96:99], v7 offset:2048
    ds_read_b64_tr_b16 v[52:53], v11 offset:0
    ds_read_b64_tr_b16 v[54:55], v11 offset:1024
    ds_read_b64_tr_b16 v[56:57], v12 offset:0
    ds_read_b64_tr_b16 v[58:59], v12 offset:1024
    ds_read_b64_tr_b16 v[60:61], v13 offset:0
    ds_read_b64_tr_b16 v[62:63], v13 offset:1024
    ds_read_b64_tr_b16 v[64:65], v14 offset:0
    ds_read_b64_tr_b16 v[66:67], v14 offset:1024
    ds_read_b64_tr_b16 v[68:69], v11 offset:4096
    ds_read_b64_tr_b16 v[70:71], v11 offset:5120
    ds_read_b64_tr_b16 v[72:73], v12 offset:4096
    s_waitcnt lgkmcnt(11)
    s_barrier
    s_waitcnt lgkmcnt(9)
    v_mfma_f32_16x16x32_bf16 v[20:23], v[52:55], v[84:87], 0
    ds_read_b128 v[100:103], v6 offset:16384
    ds_read_b128 v[104:107], v6 offset:18432
    ds_read_b128 v[108:111], v7 offset:16384
    v_mfma_f32_16x16x32_bf16 v[36:39], v[52:55], v[88:91], 0
    ds_read_b128 v[112:115], v7 offset:18432
    ds_read_b64_tr_b16 v[74:75], v12 offset:5120
    s_waitcnt lgkmcnt(12)
    v_mfma_f32_16x16x32_bf16 v[24:27], v[56:59], v[84:87], 0
    ds_read_b64_tr_b16 v[76:77], v13 offset:4096
    ds_read_b64_tr_b16 v[78:79], v13 offset:5120
    v_mfma_f32_16x16x32_bf16 v[40:43], v[56:59], v[88:91], 0
    ds_read_b64_tr_b16 v[80:81], v14 offset:4096
    ds_read_b64_tr_b16 v[82:83], v14 offset:5120
    s_waitcnt lgkmcnt(14)
    v_mfma_f32_16x16x32_bf16 v[28:31], v[60:63], v[84:87], 0
    ds_read_b64_tr_b16 v[228:229], v11 offset:8192
    ds_read_b64_tr_b16 v[230:231], v11 offset:9216
    v_mfma_f32_16x16x32_bf16 v[44:47], v[60:63], v[88:91], 0
    ds_read_b64_tr_b16 v[232:233], v12 offset:8192
    ds_read_b64_tr_b16 v[234:235], v12 offset:9216
    s_waitcnt lgkmcnt(15)
    v_mfma_f32_16x16x32_bf16 v[32:35], v[64:67], v[84:87], 0
    ds_read_b64_tr_b16 v[236:237], v13 offset:8192
    ds_read_b64_tr_b16 v[238:239], v13 offset:9216
    v_mfma_f32_16x16x32_bf16 v[48:51], v[64:67], v[88:91], 0
    ds_read_b64_tr_b16 v[240:241], v14 offset:8192
    ds_read_b64_tr_b16 v[242:243], v14 offset:9216
    s_waitcnt lgkmcnt(15)
    v_mfma_f32_16x16x32_bf16 v[20:23], v[68:71], v[92:95], v[20:23]
    ds_read_b64_tr_b16 v[52:53], v11 offset:12288
    v_mfma_f32_16x16x32_bf16 v[36:39], v[68:71], v[96:99], v[36:39]
    ds_read_b64_tr_b16 v[54:55], v11 offset:13312
    s_waitcnt lgkmcnt(14)
    v_mfma_f32_16x16x32_bf16 v[24:27], v[72:75], v[92:95], v[24:27]
    ds_read_b64_tr_b16 v[56:57], v12 offset:12288
    v_mfma_f32_16x16x32_bf16 v[40:43], v[72:75], v[96:99], v[40:43]
    ds_read_b64_tr_b16 v[58:59], v12 offset:13312
    s_waitcnt lgkmcnt(14)
    v_mfma_f32_16x16x32_bf16 v[28:31], v[76:79], v[92:95], v[28:31]
    ds_read_b64_tr_b16 v[60:61], v13 offset:12288
    v_mfma_f32_16x16x32_bf16 v[44:47], v[76:79], v[96:99], v[44:47]
    ds_read_b64_tr_b16 v[62:63], v13 offset:13312
    s_waitcnt lgkmcnt(14)
    v_mfma_f32_16x16x32_bf16 v[32:35], v[80:83], v[92:95], v[32:35]
    ds_read_b64_tr_b16 v[64:65], v14 offset:12288
    v_mfma_f32_16x16x32_bf16 v[48:51], v[80:83], v[96:99], v[48:51]
    ds_read_b64_tr_b16 v[66:67], v14 offset:13312
    s_barrier
    s_waitcnt lgkmcnt(14)
    v_mfma_f32_16x16x32_bf16 v[20:23], v[228:231], v[100:103], v[20:23]
    ds_read_b128 v[116:119], v6 offset:32768
    ds_read_b128 v[120:123], v6 offset:34816
    v_mfma_f32_16x16x32_bf16 v[36:39], v[228:231], v[104:107], v[36:39]
    ds_read_b128 v[124:127], v7 offset:32768
    s_waitcnt lgkmcnt(15)
    v_mfma_f32_16x16x32_bf16 v[24:27], v[232:235], v[100:103], v[24:27]
    ds_read_b128 v[128:131], v7 offset:34816
    ds_read_b64_tr_b16 v[68:69], v11 offset:16384
    v_mfma_f32_16x16x32_bf16 v[40:43], v[232:235], v[104:107], v[40:43]
    ds_read_b64_tr_b16 v[70:71], v11 offset:17408
    s_waitcnt lgkmcnt(15)
    v_mfma_f32_16x16x32_bf16 v[28:31], v[236:239], v[100:103], v[28:31]
    ds_read_b64_tr_b16 v[72:73], v12 offset:16384
    ds_read_b64_tr_b16 v[74:75], v12 offset:17408
    v_mfma_f32_16x16x32_bf16 v[44:47], v[236:239], v[104:107], v[44:47]
    ds_read_b64_tr_b16 v[76:77], v13 offset:16384
    s_waitcnt lgkmcnt(15)
    v_mfma_f32_16x16x32_bf16 v[32:35], v[240:243], v[100:103], v[32:35]
    ds_read_b64_tr_b16 v[78:79], v13 offset:17408
    ds_read_b64_tr_b16 v[80:81], v14 offset:16384
    v_mfma_f32_16x16x32_bf16 v[48:51], v[240:243], v[104:107], v[48:51]
    ds_read_b64_tr_b16 v[82:83], v14 offset:17408
    s_waitcnt lgkmcnt(15)
    v_mfma_f32_16x16x32_bf16 v[20:23], v[52:55], v[108:111], v[20:23]
    ds_read_b64_tr_b16 v[228:229], v11 offset:20480
    v_mfma_f32_16x16x32_bf16 v[36:39], v[52:55], v[112:115], v[36:39]
    ds_read_b64_tr_b16 v[230:231], v11 offset:21504
    s_waitcnt lgkmcnt(15)
    v_mfma_f32_16x16x32_bf16 v[24:27], v[56:59], v[108:111], v[24:27]
    ds_read_b64_tr_b16 v[232:233], v12 offset:20480
    v_mfma_f32_16x16x32_bf16 v[40:43], v[56:59], v[112:115], v[40:43]
    ds_read_b64_tr_b16 v[234:235], v12 offset:21504
    s_waitcnt lgkmcnt(15)
    v_mfma_f32_16x16x32_bf16 v[28:31], v[60:63], v[108:111], v[28:31]
    ds_read_b64_tr_b16 v[236:237], v13 offset:20480
    v_mfma_f32_16x16x32_bf16 v[44:47], v[60:63], v[112:115], v[44:47]
    ds_read_b64_tr_b16 v[238:239], v13 offset:21504
    s_waitcnt lgkmcnt(15)
    v_mfma_f32_16x16x32_bf16 v[32:35], v[64:67], v[108:111], v[32:35]
    ds_read_b64_tr_b16 v[240:241], v14 offset:20480
    v_mfma_f32_16x16x32_bf16 v[48:51], v[64:67], v[112:115], v[48:51]
    ds_read_b64_tr_b16 v[242:243], v14 offset:21504
    s_waitcnt lgkmcnt(15)
    s_barrier
    s_waitcnt lgkmcnt(14)
    v_mfma_f32_16x16x32_bf16 v[20:23], v[68:71], v[116:119], v[20:23]
    ds_read_b128 v[132:135], v6 offset:49152
    ds_read_b128 v[136:139], v6 offset:51200
    v_mfma_f32_16x16x32_bf16 v[36:39], v[68:71], v[120:123], v[36:39]
    ds_read_b128 v[140:143], v7 offset:49152
    s_waitcnt lgkmcnt(15)
    v_mfma_f32_16x16x32_bf16 v[24:27], v[72:75], v[116:119], v[24:27]
    ds_read_b128 v[144:147], v7 offset:51200
    ds_read_b64_tr_b16 v[52:53], v11 offset:24576
    v_mfma_f32_16x16x32_bf16 v[40:43], v[72:75], v[120:123], v[40:43]
    ds_read_b64_tr_b16 v[54:55], v11 offset:25600
    s_waitcnt lgkmcnt(15)
    v_mfma_f32_16x16x32_bf16 v[28:31], v[76:79], v[116:119], v[28:31]
    ds_read_b64_tr_b16 v[56:57], v12 offset:24576
    ds_read_b64_tr_b16 v[58:59], v12 offset:25600
    v_mfma_f32_16x16x32_bf16 v[44:47], v[76:79], v[120:123], v[44:47]
    ds_read_b64_tr_b16 v[60:61], v13 offset:24576
    s_waitcnt lgkmcnt(15)
    v_mfma_f32_16x16x32_bf16 v[32:35], v[80:83], v[116:119], v[32:35]
    ds_read_b64_tr_b16 v[62:63], v13 offset:25600
    ds_read_b64_tr_b16 v[64:65], v14 offset:24576
    v_mfma_f32_16x16x32_bf16 v[48:51], v[80:83], v[120:123], v[48:51]
    ds_read_b64_tr_b16 v[66:67], v14 offset:25600
    s_waitcnt lgkmcnt(15)
    v_mfma_f32_16x16x32_bf16 v[20:23], v[228:231], v[124:127], v[20:23]
    ds_read_b64_tr_b16 v[68:69], v11 offset:28672
    v_mfma_f32_16x16x32_bf16 v[36:39], v[228:231], v[128:131], v[36:39]
    ds_read_b64_tr_b16 v[70:71], v11 offset:29696
    s_waitcnt lgkmcnt(15)
    v_mfma_f32_16x16x32_bf16 v[24:27], v[232:235], v[124:127], v[24:27]
    ds_read_b64_tr_b16 v[72:73], v12 offset:28672
    v_mfma_f32_16x16x32_bf16 v[40:43], v[232:235], v[128:131], v[40:43]
    ds_read_b64_tr_b16 v[74:75], v12 offset:29696
    s_waitcnt lgkmcnt(15)
    v_mfma_f32_16x16x32_bf16 v[28:31], v[236:239], v[124:127], v[28:31]
    ds_read_b64_tr_b16 v[76:77], v13 offset:28672
    v_mfma_f32_16x16x32_bf16 v[44:47], v[236:239], v[128:131], v[44:47]
    ds_read_b64_tr_b16 v[78:79], v13 offset:29696
    s_waitcnt lgkmcnt(15)
    v_mfma_f32_16x16x32_bf16 v[32:35], v[240:243], v[124:127], v[32:35]
    ds_read_b64_tr_b16 v[80:81], v14 offset:28672
    v_mfma_f32_16x16x32_bf16 v[48:51], v[240:243], v[128:131], v[48:51]
    ds_read_b64_tr_b16 v[82:83], v14 offset:29696
    s_waitcnt lgkmcnt(15)
    s_barrier
    s_waitcnt lgkmcnt(14)
    v_mfma_f32_16x16x32_bf16 v[20:23], v[52:55], v[132:135], v[20:23]
    ds_read_b128 v[148:151], v6 offset:0
    ds_read_b128 v[152:155], v6 offset:2048
    v_mfma_f32_16x16x32_bf16 v[36:39], v[52:55], v[136:139], v[36:39]
    ds_read_b128 v[156:159], v7 offset:0
    s_waitcnt lgkmcnt(15)
    v_mfma_f32_16x16x32_bf16 v[24:27], v[56:59], v[132:135], v[24:27]
    ds_read_b128 v[160:163], v7 offset:2048
    ds_read_b64_tr_b16 v[228:229], v11 offset:32768
    v_mfma_f32_16x16x32_bf16 v[40:43], v[56:59], v[136:139], v[40:43]
    ds_read_b64_tr_b16 v[230:231], v11 offset:33792
    s_waitcnt lgkmcnt(15)
    v_mfma_f32_16x16x32_bf16 v[28:31], v[60:63], v[132:135], v[28:31]
    ds_read_b64_tr_b16 v[232:233], v12 offset:32768
    ds_read_b64_tr_b16 v[234:235], v12 offset:33792
    v_mfma_f32_16x16x32_bf16 v[44:47], v[60:63], v[136:139], v[44:47]
    ds_read_b64_tr_b16 v[236:237], v13 offset:32768
    s_waitcnt lgkmcnt(15)
    v_mfma_f32_16x16x32_bf16 v[32:35], v[64:67], v[132:135], v[32:35]
    ds_read_b64_tr_b16 v[238:239], v13 offset:33792
    ds_read_b64_tr_b16 v[240:241], v14 offset:32768
    v_mfma_f32_16x16x32_bf16 v[48:51], v[64:67], v[136:139], v[48:51]
    ds_read_b64_tr_b16 v[242:243], v14 offset:33792
    s_waitcnt lgkmcnt(15)
    v_mfma_f32_16x16x32_bf16 v[20:23], v[68:71], v[140:143], v[20:23]
    ds_read_b64_tr_b16 v[52:53], v11 offset:36864
    v_mfma_f32_16x16x32_bf16 v[36:39], v[68:71], v[144:147], v[36:39]
    ds_read_b64_tr_b16 v[54:55], v11 offset:37888
    s_waitcnt lgkmcnt(15)
    v_mfma_f32_16x16x32_bf16 v[24:27], v[72:75], v[140:143], v[24:27]
    ds_read_b64_tr_b16 v[56:57], v12 offset:36864
    v_mfma_f32_16x16x32_bf16 v[40:43], v[72:75], v[144:147], v[40:43]
    ds_read_b64_tr_b16 v[58:59], v12 offset:37888
    s_waitcnt lgkmcnt(15)
    v_mfma_f32_16x16x32_bf16 v[28:31], v[76:79], v[140:143], v[28:31]
    ds_read_b64_tr_b16 v[60:61], v13 offset:36864
    v_mfma_f32_16x16x32_bf16 v[44:47], v[76:79], v[144:147], v[44:47]
    ds_read_b64_tr_b16 v[62:63], v13 offset:37888
    s_waitcnt lgkmcnt(15)
    v_mfma_f32_16x16x32_bf16 v[32:35], v[80:83], v[140:143], v[32:35]
    ds_read_b64_tr_b16 v[64:65], v14 offset:36864
    v_mfma_f32_16x16x32_bf16 v[48:51], v[80:83], v[144:147], v[48:51]
    ds_read_b64_tr_b16 v[66:67], v14 offset:37888
    s_waitcnt lgkmcnt(15)
    s_barrier
    s_waitcnt lgkmcnt(14)
    v_mfma_f32_16x16x32_bf16 v[20:23], v[228:231], v[148:151], v[20:23]
    ds_read_b128 v[164:167], v6 offset:16384
    ds_read_b128 v[168:171], v6 offset:18432
    v_mfma_f32_16x16x32_bf16 v[36:39], v[228:231], v[152:155], v[36:39]
    ds_read_b128 v[172:175], v7 offset:16384
    ds_read_b128 v[176:179], v7 offset:18432
    s_waitcnt lgkmcnt(15)
    v_mfma_f32_16x16x32_bf16 v[24:27], v[232:235], v[148:151], v[24:27]
    v_add_u32 v11, 40960, v11
    v_add_u32 v12, 40960, v12
    v_mfma_f32_16x16x32_bf16 v[40:43], v[232:235], v[152:155], v[40:43]
    v_add_u32 v13, 40960, v13
    v_add_u32 v14, 40960, v14
    s_waitcnt lgkmcnt(14)
    v_mfma_f32_16x16x32_bf16 v[28:31], v[236:239], v[148:151], v[28:31]
    ds_read_b64_tr_b16 v[68:69], v11 offset:0
    ds_read_b64_tr_b16 v[70:71], v11 offset:1024
    v_mfma_f32_16x16x32_bf16 v[44:47], v[236:239], v[152:155], v[44:47]
    ds_read_b64_tr_b16 v[72:73], v12 offset:0
    ds_read_b64_tr_b16 v[74:75], v12 offset:1024
    s_waitcnt lgkmcnt(15)
    v_mfma_f32_16x16x32_bf16 v[32:35], v[240:243], v[148:151], v[32:35]
    ds_read_b64_tr_b16 v[76:77], v13 offset:0
    ds_read_b64_tr_b16 v[78:79], v13 offset:1024
    v_mfma_f32_16x16x32_bf16 v[48:51], v[240:243], v[152:155], v[48:51]
    ds_read_b64_tr_b16 v[80:81], v14 offset:0
    ds_read_b64_tr_b16 v[82:83], v14 offset:1024
    s_waitcnt lgkmcnt(15)
    v_mfma_f32_16x16x32_bf16 v[20:23], v[52:55], v[156:159], v[20:23]
    ds_read_b64_tr_b16 v[228:229], v11 offset:4096
    v_mfma_f32_16x16x32_bf16 v[36:39], v[52:55], v[160:163], v[36:39]
    ds_read_b64_tr_b16 v[230:231], v11 offset:5120
    s_waitcnt lgkmcnt(15)
    v_mfma_f32_16x16x32_bf16 v[24:27], v[56:59], v[156:159], v[24:27]
    ds_read_b64_tr_b16 v[232:233], v12 offset:4096
    v_mfma_f32_16x16x32_bf16 v[40:43], v[56:59], v[160:163], v[40:43]
    ds_read_b64_tr_b16 v[234:235], v12 offset:5120
    s_waitcnt lgkmcnt(15)
    v_mfma_f32_16x16x32_bf16 v[28:31], v[60:63], v[156:159], v[28:31]
    ds_read_b64_tr_b16 v[236:237], v13 offset:4096
    v_mfma_f32_16x16x32_bf16 v[44:47], v[60:63], v[160:163], v[44:47]
    ds_read_b64_tr_b16 v[238:239], v13 offset:5120
    s_waitcnt lgkmcnt(15)
    v_mfma_f32_16x16x32_bf16 v[32:35], v[64:67], v[156:159], v[32:35]
    ds_read_b64_tr_b16 v[240:241], v14 offset:4096
    v_mfma_f32_16x16x32_bf16 v[48:51], v[64:67], v[160:163], v[48:51]
    ds_read_b64_tr_b16 v[242:243], v14 offset:5120
    s_waitcnt lgkmcnt(15)
    s_barrier
    s_waitcnt lgkmcnt(14)
    v_mfma_f32_16x16x32_bf16 v[20:23], v[68:71], v[164:167], v[20:23]
    ds_read_b128 v[180:183], v6 offset:32768
    ds_read_b128 v[184:187], v6 offset:34816
    v_mfma_f32_16x16x32_bf16 v[36:39], v[68:71], v[168:171], v[36:39]
    ds_read_b128 v[188:191], v7 offset:32768
    s_waitcnt lgkmcnt(15)
    v_mfma_f32_16x16x32_bf16 v[24:27], v[72:75], v[164:167], v[24:27]
    ds_read_b128 v[192:195], v7 offset:34816
    ds_read_b64_tr_b16 v[52:53], v11 offset:8192
    v_mfma_f32_16x16x32_bf16 v[40:43], v[72:75], v[168:171], v[40:43]
    ds_read_b64_tr_b16 v[54:55], v11 offset:9216
    s_waitcnt lgkmcnt(15)
    v_mfma_f32_16x16x32_bf16 v[28:31], v[76:79], v[164:167], v[28:31]
    ds_read_b64_tr_b16 v[56:57], v12 offset:8192
    ds_read_b64_tr_b16 v[58:59], v12 offset:9216
    v_mfma_f32_16x16x32_bf16 v[44:47], v[76:79], v[168:171], v[44:47]
    ds_read_b64_tr_b16 v[60:61], v13 offset:8192
    s_waitcnt lgkmcnt(15)
    v_mfma_f32_16x16x32_bf16 v[32:35], v[80:83], v[164:167], v[32:35]
    ds_read_b64_tr_b16 v[62:63], v13 offset:9216
    ds_read_b64_tr_b16 v[64:65], v14 offset:8192
    v_mfma_f32_16x16x32_bf16 v[48:51], v[80:83], v[168:171], v[48:51]
    ds_read_b64_tr_b16 v[66:67], v14 offset:9216
    s_waitcnt lgkmcnt(15)
    v_mfma_f32_16x16x32_bf16 v[20:23], v[228:231], v[172:175], v[20:23]
    ds_read_b64_tr_b16 v[68:69], v11 offset:12288
    v_mfma_f32_16x16x32_bf16 v[36:39], v[228:231], v[176:179], v[36:39]
    ds_read_b64_tr_b16 v[70:71], v11 offset:13312
    s_waitcnt lgkmcnt(15)
    v_mfma_f32_16x16x32_bf16 v[24:27], v[232:235], v[172:175], v[24:27]
    ds_read_b64_tr_b16 v[72:73], v12 offset:12288
    v_mfma_f32_16x16x32_bf16 v[40:43], v[232:235], v[176:179], v[40:43]
    ds_read_b64_tr_b16 v[74:75], v12 offset:13312
    s_waitcnt lgkmcnt(15)
    v_mfma_f32_16x16x32_bf16 v[28:31], v[236:239], v[172:175], v[28:31]
    ds_read_b64_tr_b16 v[76:77], v13 offset:12288
    v_mfma_f32_16x16x32_bf16 v[44:47], v[236:239], v[176:179], v[44:47]
    ds_read_b64_tr_b16 v[78:79], v13 offset:13312
    s_waitcnt lgkmcnt(15)
    v_mfma_f32_16x16x32_bf16 v[32:35], v[240:243], v[172:175], v[32:35]
    ds_read_b64_tr_b16 v[80:81], v14 offset:12288
    v_mfma_f32_16x16x32_bf16 v[48:51], v[240:243], v[176:179], v[48:51]
    ds_read_b64_tr_b16 v[82:83], v14 offset:13312
    s_waitcnt lgkmcnt(15)
    s_barrier
    s_waitcnt lgkmcnt(14)
    v_mfma_f32_16x16x32_bf16 v[20:23], v[52:55], v[180:183], v[20:23]
    ds_read_b128 v[196:199], v6 offset:49152
    ds_read_b128 v[200:203], v6 offset:51200
    v_mfma_f32_16x16x32_bf16 v[36:39], v[52:55], v[184:187], v[36:39]
    ds_read_b128 v[204:207], v7 offset:49152
    s_waitcnt lgkmcnt(15)
    v_mfma_f32_16x16x32_bf16 v[24:27], v[56:59], v[180:183], v[24:27]
    ds_read_b128 v[208:211], v7 offset:51200
    ds_read_b64_tr_b16 v[228:229], v11 offset:16384
    v_mfma_f32_16x16x32_bf16 v[40:43], v[56:59], v[184:187], v[40:43]
    ds_read_b64_tr_b16 v[230:231], v11 offset:17408
    s_waitcnt lgkmcnt(15)
    v_mfma_f32_16x16x32_bf16 v[28:31], v[60:63], v[180:183], v[28:31]
    ds_read_b64_tr_b16 v[232:233], v12 offset:16384
    ds_read_b64_tr_b16 v[234:235], v12 offset:17408
    v_mfma_f32_16x16x32_bf16 v[44:47], v[60:63], v[184:187], v[44:47]
    ds_read_b64_tr_b16 v[236:237], v13 offset:16384
    s_waitcnt lgkmcnt(15)
    v_mfma_f32_16x16x32_bf16 v[32:35], v[64:67], v[180:183], v[32:35]
    ds_read_b64_tr_b16 v[238:239], v13 offset:17408
    ds_read_b64_tr_b16 v[240:241], v14 offset:16384
    v_mfma_f32_16x16x32_bf16 v[48:51], v[64:67], v[184:187], v[48:51]
    ds_read_b64_tr_b16 v[242:243], v14 offset:17408
    s_waitcnt lgkmcnt(15)
    v_mfma_f32_16x16x32_bf16 v[20:23], v[68:71], v[188:191], v[20:23]
    ds_read_b64_tr_b16 v[52:53], v11 offset:20480
    v_mfma_f32_16x16x32_bf16 v[36:39], v[68:71], v[192:195], v[36:39]
    ds_read_b64_tr_b16 v[54:55], v11 offset:21504
    s_waitcnt lgkmcnt(15)
    v_mfma_f32_16x16x32_bf16 v[24:27], v[72:75], v[188:191], v[24:27]
    ds_read_b64_tr_b16 v[56:57], v12 offset:20480
    v_mfma_f32_16x16x32_bf16 v[40:43], v[72:75], v[192:195], v[40:43]
    ds_read_b64_tr_b16 v[58:59], v12 offset:21504
    s_waitcnt lgkmcnt(15)
    v_mfma_f32_16x16x32_bf16 v[28:31], v[76:79], v[188:191], v[28:31]
    ds_read_b64_tr_b16 v[60:61], v13 offset:20480
    v_mfma_f32_16x16x32_bf16 v[44:47], v[76:79], v[192:195], v[44:47]
    ds_read_b64_tr_b16 v[62:63], v13 offset:21504
    s_waitcnt lgkmcnt(15)
    v_mfma_f32_16x16x32_bf16 v[32:35], v[80:83], v[188:191], v[32:35]
    ds_read_b64_tr_b16 v[64:65], v14 offset:20480
    v_mfma_f32_16x16x32_bf16 v[48:51], v[80:83], v[192:195], v[48:51]
    ds_read_b64_tr_b16 v[66:67], v14 offset:21504
    s_waitcnt lgkmcnt(15)
    s_barrier
    s_waitcnt lgkmcnt(14)
    v_mfma_f32_16x16x32_bf16 v[20:23], v[228:231], v[196:199], v[20:23]
    ds_read_b128 v[212:215], v6 offset:0
    ds_read_b128 v[216:219], v6 offset:2048
    v_mfma_f32_16x16x32_bf16 v[36:39], v[228:231], v[200:203], v[36:39]
    ds_read_b128 v[220:223], v7 offset:0
    s_waitcnt lgkmcnt(15)
    v_mfma_f32_16x16x32_bf16 v[24:27], v[232:235], v[196:199], v[24:27]
    ds_read_b128 v[224:227], v7 offset:2048
    ds_read_b64_tr_b16 v[68:69], v11 offset:24576
    v_mfma_f32_16x16x32_bf16 v[40:43], v[232:235], v[200:203], v[40:43]
    ds_read_b64_tr_b16 v[70:71], v11 offset:25600
    s_waitcnt lgkmcnt(15)
    v_mfma_f32_16x16x32_bf16 v[28:31], v[236:239], v[196:199], v[28:31]
    ds_read_b64_tr_b16 v[72:73], v12 offset:24576
    ds_read_b64_tr_b16 v[74:75], v12 offset:25600
    v_mfma_f32_16x16x32_bf16 v[44:47], v[236:239], v[200:203], v[44:47]
    ds_read_b64_tr_b16 v[76:77], v13 offset:24576
    s_waitcnt lgkmcnt(15)
    v_mfma_f32_16x16x32_bf16 v[32:35], v[240:243], v[196:199], v[32:35]
    ds_read_b64_tr_b16 v[78:79], v13 offset:25600
    ds_read_b64_tr_b16 v[80:81], v14 offset:24576
    v_mfma_f32_16x16x32_bf16 v[48:51], v[240:243], v[200:203], v[48:51]
    ds_read_b64_tr_b16 v[82:83], v14 offset:25600
    s_waitcnt lgkmcnt(15)
    v_mfma_f32_16x16x32_bf16 v[20:23], v[52:55], v[204:207], v[20:23]
    v_mfma_f32_16x16x32_bf16 v[36:39], v[52:55], v[208:211], v[36:39]
    s_waitcnt lgkmcnt(15)
    v_mfma_f32_16x16x32_bf16 v[24:27], v[56:59], v[204:207], v[24:27]
    v_mfma_f32_16x16x32_bf16 v[40:43], v[56:59], v[208:211], v[40:43]
    s_waitcnt lgkmcnt(14)
    v_mfma_f32_16x16x32_bf16 v[28:31], v[60:63], v[204:207], v[28:31]
    v_mfma_f32_16x16x32_bf16 v[44:47], v[60:63], v[208:211], v[44:47]
    s_waitcnt lgkmcnt(12)
    v_mfma_f32_16x16x32_bf16 v[32:35], v[64:67], v[204:207], v[32:35]
    v_mfma_f32_16x16x32_bf16 v[48:51], v[64:67], v[208:211], v[48:51]
    s_waitcnt lgkmcnt(8)
    s_barrier
    s_waitcnt lgkmcnt(6)
    v_mfma_f32_16x16x32_bf16 v[20:23], v[68:71], v[212:215], v[20:23]
    ds_read_b128 v[228:231], v6 offset:16384
    ds_read_b128 v[232:235], v6 offset:18432
    ds_read_b128 v[236:239], v7 offset:16384
    v_mfma_f32_16x16x32_bf16 v[36:39], v[68:71], v[216:219], v[36:39]
    ds_read_b128 v[240:243], v7 offset:18432
    ds_read_b64_tr_b16 v[52:53], v11 offset:28672
    s_waitcnt lgkmcnt(9)
    v_mfma_f32_16x16x32_bf16 v[24:27], v[72:75], v[212:215], v[24:27]
    ds_read_b64_tr_b16 v[54:55], v11 offset:29696
    ds_read_b64_tr_b16 v[56:57], v12 offset:28672
    ds_read_b64_tr_b16 v[58:59], v12 offset:29696
    v_mfma_f32_16x16x32_bf16 v[40:43], v[72:75], v[216:219], v[40:43]
    ds_read_b64_tr_b16 v[60:61], v13 offset:28672
    ds_read_b64_tr_b16 v[62:63], v13 offset:29696
    s_waitcnt lgkmcnt(12)
    v_mfma_f32_16x16x32_bf16 v[28:31], v[76:79], v[212:215], v[28:31]
    ds_read_b64_tr_b16 v[64:65], v14 offset:28672
    ds_read_b64_tr_b16 v[66:67], v14 offset:29696
    v_mfma_f32_16x16x32_bf16 v[44:47], v[76:79], v[216:219], v[44:47]
    s_waitcnt lgkmcnt(12)
    v_mfma_f32_16x16x32_bf16 v[32:35], v[80:83], v[212:215], v[32:35]
    v_mfma_f32_16x16x32_bf16 v[48:51], v[80:83], v[216:219], v[48:51]
    s_waitcnt lgkmcnt(6)
    v_mfma_f32_16x16x32_bf16 v[20:23], v[52:55], v[220:223], v[20:23]
    ds_read_b64_tr_b16 v[68:69], v11 offset:32768
    ds_read_b64_tr_b16 v[70:71], v11 offset:33792
    v_mfma_f32_16x16x32_bf16 v[36:39], v[52:55], v[224:227], v[36:39]
    ds_read_b64_tr_b16 v[72:73], v12 offset:32768
    ds_read_b64_tr_b16 v[74:75], v12 offset:33792
    s_waitcnt lgkmcnt(8)
    v_mfma_f32_16x16x32_bf16 v[24:27], v[56:59], v[220:223], v[24:27]
    ds_read_b64_tr_b16 v[76:77], v13 offset:32768
    v_mfma_f32_16x16x32_bf16 v[40:43], v[56:59], v[224:227], v[40:43]
    ds_read_b64_tr_b16 v[78:79], v13 offset:33792
    ds_read_b64_tr_b16 v[80:81], v14 offset:32768
    s_waitcnt lgkmcnt(9)
    v_mfma_f32_16x16x32_bf16 v[28:31], v[60:63], v[220:223], v[28:31]
    ds_read_b64_tr_b16 v[82:83], v14 offset:33792
    v_mfma_f32_16x16x32_bf16 v[44:47], v[60:63], v[224:227], v[44:47]
    s_waitcnt lgkmcnt(8)
    v_mfma_f32_16x16x32_bf16 v[32:35], v[64:67], v[220:223], v[32:35]
    v_mfma_f32_16x16x32_bf16 v[48:51], v[64:67], v[224:227], v[48:51]
    s_barrier
    s_waitcnt lgkmcnt(6)
    v_mfma_f32_16x16x32_bf16 v[20:23], v[68:71], v[228:231], v[20:23]
    ds_read_b64_tr_b16 v[52:53], v11 offset:36864
    ds_read_b64_tr_b16 v[54:55], v11 offset:37888
    v_mfma_f32_16x16x32_bf16 v[36:39], v[68:71], v[232:235], v[36:39]
    ds_read_b64_tr_b16 v[56:57], v12 offset:36864
    ds_read_b64_tr_b16 v[58:59], v12 offset:37888
    s_waitcnt lgkmcnt(8)
    v_mfma_f32_16x16x32_bf16 v[24:27], v[72:75], v[228:231], v[24:27]
    ds_read_b64_tr_b16 v[60:61], v13 offset:36864
    v_mfma_f32_16x16x32_bf16 v[40:43], v[72:75], v[232:235], v[40:43]
    ds_read_b64_tr_b16 v[62:63], v13 offset:37888
    ds_read_b64_tr_b16 v[64:65], v14 offset:36864
    s_waitcnt lgkmcnt(9)
    v_mfma_f32_16x16x32_bf16 v[28:31], v[76:79], v[228:231], v[28:31]
    ds_read_b64_tr_b16 v[66:67], v14 offset:37888
    v_mfma_f32_16x16x32_bf16 v[44:47], v[76:79], v[232:235], v[44:47]
    s_waitcnt lgkmcnt(8)
    v_mfma_f32_16x16x32_bf16 v[32:35], v[80:83], v[228:231], v[32:35]
    v_mfma_f32_16x16x32_bf16 v[48:51], v[80:83], v[232:235], v[48:51]
    s_waitcnt lgkmcnt(6)
    v_mfma_f32_16x16x32_bf16 v[20:23], v[52:55], v[236:239], v[20:23]
    v_mfma_f32_16x16x32_bf16 v[36:39], v[52:55], v[240:243], v[36:39]
    s_waitcnt lgkmcnt(4)
    v_mfma_f32_16x16x32_bf16 v[24:27], v[56:59], v[236:239], v[24:27]
    v_mfma_f32_16x16x32_bf16 v[40:43], v[56:59], v[240:243], v[40:43]
    s_waitcnt lgkmcnt(2)
    v_mfma_f32_16x16x32_bf16 v[28:31], v[60:63], v[236:239], v[28:31]
    v_mfma_f32_16x16x32_bf16 v[44:47], v[60:63], v[240:243], v[44:47]
    s_waitcnt lgkmcnt(0)
    v_mfma_f32_16x16x32_bf16 v[32:35], v[64:67], v[236:239], v[32:35]
    v_mfma_f32_16x16x32_bf16 v[48:51], v[64:67], v[240:243], v[48:51]
    s_barrier
    s_nop 4
    ds_read_b128 v[52:55], v5 offset:0
    ds_read_b128 v[56:59], v5 offset:64
    ds_read_b128 v[60:63], v5 offset:128
    ds_read_b128 v[64:67], v5 offset:192
    s_waitcnt lgkmcnt(0)
    v_pk_fma_f32 v[20:21], v[52:53], v[16:17], v[20:21] op_sel_hi:[1,0,1] neg_lo:[0,1,0] neg_hi:[0,1,0]
    v_pk_fma_f32 v[22:23], v[54:55], v[16:17], v[22:23] op_sel_hi:[1,0,1] neg_lo:[0,1,0] neg_hi:[0,1,0]
    v_pk_mul_f32 v[20:21], v[20:21], v[16:17] op_sel:[0,1]
    v_pk_mul_f32 v[22:23], v[22:23], v[16:17] op_sel:[0,1]
    v_pk_fma_f32 v[24:25], v[56:57], v[16:17], v[24:25] op_sel_hi:[1,0,1] neg_lo:[0,1,0] neg_hi:[0,1,0]
    v_pk_fma_f32 v[26:27], v[58:59], v[16:17], v[26:27] op_sel_hi:[1,0,1] neg_lo:[0,1,0] neg_hi:[0,1,0]
    v_pk_mul_f32 v[24:25], v[24:25], v[16:17] op_sel:[0,1]
    v_pk_mul_f32 v[26:27], v[26:27], v[16:17] op_sel:[0,1]
    v_cvt_pk_bf16_f32 v68, v20, v21
    v_cvt_pk_bf16_f32 v70, v24, v25
    v_cvt_pk_bf16_f32 v69, v22, v23
    v_cvt_pk_bf16_f32 v71, v26, v27
    v_permlane16_swap_b32 v68, v70
    s_nop 0
    v_permlane16_swap_b32 v69, v71
    v_pk_max_i16 v68, v68, 0
    v_pk_max_i16 v70, v70, 0
    v_pk_max_i16 v69, v69, 0
    v_pk_max_i16 v71, v71, 0
    buffer_store_dwordx4 v[68:71], v3, s[40:43], 0 offen offset:0 sc1
    v_pk_fma_f32 v[28:29], v[60:61], v[16:17], v[28:29] op_sel_hi:[1,0,1] neg_lo:[0,1,0] neg_hi:[0,1,0]
    v_pk_fma_f32 v[30:31], v[62:63], v[16:17], v[30:31] op_sel_hi:[1,0,1] neg_lo:[0,1,0] neg_hi:[0,1,0]
    v_pk_mul_f32 v[28:29], v[28:29], v[16:17] op_sel:[0,1]
    v_pk_mul_f32 v[30:31], v[30:31], v[16:17] op_sel:[0,1]
    v_pk_fma_f32 v[32:33], v[64:65], v[16:17], v[32:33] op_sel_hi:[1,0,1] neg_lo:[0,1,0] neg_hi:[0,1,0]
    v_pk_fma_f32 v[34:35], v[66:67], v[16:17], v[34:35] op_sel_hi:[1,0,1] neg_lo:[0,1,0] neg_hi:[0,1,0]
    v_pk_mul_f32 v[32:33], v[32:33], v[16:17] op_sel:[0,1]
    v_pk_mul_f32 v[34:35], v[34:35], v[16:17] op_sel:[0,1]
    v_cvt_pk_bf16_f32 v72, v28, v29
    v_cvt_pk_bf16_f32 v74, v32, v33
    v_cvt_pk_bf16_f32 v73, v30, v31
    v_cvt_pk_bf16_f32 v75, v34, v35
    v_permlane16_swap_b32 v72, v74
    s_nop 0
    v_permlane16_swap_b32 v73, v75
    v_pk_max_i16 v72, v72, 0
    v_pk_max_i16 v74, v74, 0
    v_pk_max_i16 v73, v73, 0
    v_pk_max_i16 v75, v75, 0
    buffer_store_dwordx4 v[72:75], v3, s[40:43], 0 offen offset:64 sc1
    v_pk_fma_f32 v[36:37], v[52:53], v[18:19], v[36:37] op_sel_hi:[1,0,1] neg_lo:[0,1,0] neg_hi:[0,1,0]
    v_pk_fma_f32 v[38:39], v[54:55], v[18:19], v[38:39] op_sel_hi:[1,0,1] neg_lo:[0,1,0] neg_hi:[0,1,0]
    v_pk_mul_f32 v[36:37], v[36:37], v[18:19] op_sel:[0,1]
    v_pk_mul_f32 v[38:39], v[38:39], v[18:19] op_sel:[0,1]
    v_pk_fma_f32 v[40:41], v[56:57], v[18:19], v[40:41] op_sel_hi:[1,0,1] neg_lo:[0,1,0] neg_hi:[0,1,0]
    v_pk_fma_f32 v[42:43], v[58:59], v[18:19], v[42:43] op_sel_hi:[1,0,1] neg_lo:[0,1,0] neg_hi:[0,1,0]
    v_pk_mul_f32 v[40:41], v[40:41], v[18:19] op_sel:[0,1]
    v_pk_mul_f32 v[42:43], v[42:43], v[18:19] op_sel:[0,1]
    v_cvt_pk_bf16_f32 v76, v36, v37
    v_cvt_pk_bf16_f32 v78, v40, v41
    v_cvt_pk_bf16_f32 v77, v38, v39
    v_cvt_pk_bf16_f32 v79, v42, v43
    v_permlane16_swap_b32 v76, v78
    s_nop 0
    v_permlane16_swap_b32 v77, v79
    v_pk_max_i16 v76, v76, 0
    v_pk_max_i16 v78, v78, 0
    v_pk_max_i16 v77, v77, 0
    v_pk_max_i16 v79, v79, 0
    buffer_store_dwordx4 v[76:79], v3, s[40:43], s31 offen offset:0 sc1
    v_pk_fma_f32 v[44:45], v[60:61], v[18:19], v[44:45] op_sel_hi:[1,0,1] neg_lo:[0,1,0] neg_hi:[0,1,0]
    v_pk_fma_f32 v[46:47], v[62:63], v[18:19], v[46:47] op_sel_hi:[1,0,1] neg_lo:[0,1,0] neg_hi:[0,1,0]
    v_pk_mul_f32 v[44:45], v[44:45], v[18:19] op_sel:[0,1]
    v_pk_mul_f32 v[46:47], v[46:47], v[18:19] op_sel:[0,1]
    v_pk_fma_f32 v[48:49], v[64:65], v[18:19], v[48:49] op_sel_hi:[1,0,1] neg_lo:[0,1,0] neg_hi:[0,1,0]
    v_pk_fma_f32 v[50:51], v[66:67], v[18:19], v[50:51] op_sel_hi:[1,0,1] neg_lo:[0,1,0] neg_hi:[0,1,0]
    v_pk_mul_f32 v[48:49], v[48:49], v[18:19] op_sel:[0,1]
    v_pk_mul_f32 v[50:51], v[50:51], v[18:19] op_sel:[0,1]
    v_cvt_pk_bf16_f32 v80, v44, v45
    v_cvt_pk_bf16_f32 v82, v48, v49
    v_cvt_pk_bf16_f32 v81, v46, v47
    v_cvt_pk_bf16_f32 v83, v50, v51
    v_permlane16_swap_b32 v80, v82
    s_nop 0
    v_permlane16_swap_b32 v81, v83
    v_pk_max_i16 v80, v80, 0
    v_pk_max_i16 v82, v82, 0
    v_pk_max_i16 v81, v81, 0
    v_pk_max_i16 v83, v83, 0
    buffer_store_dwordx4 v[80:83], v3, s[40:43], s31 offen offset:64 sc1
sequential_preLN__linear_attn_block__dense_activation_relu__prompt_kernel_p3ns87:
    s_barrier
    v_add_u32 v11, 4294926336, v11
    v_add_u32 v12, 4294926336, v12
    v_add_u32 v13, 4294926336, v13
    v_add_u32 v14, 4294926336, v14
    ds_read_b64_tr_b16 v[52:53], v11 offset:0
    ds_read_b64_tr_b16 v[54:55], v11 offset:1024
    ds_read_b64_tr_b16 v[56:57], v12 offset:0
    ds_read_b64_tr_b16 v[58:59], v12 offset:1024
    ds_read_b64_tr_b16 v[60:61], v13 offset:0
    ds_read_b64_tr_b16 v[62:63], v13 offset:1024
    ds_read_b64_tr_b16 v[64:65], v14 offset:0
    ds_read_b64_tr_b16 v[66:67], v14 offset:1024
    ds_read_b64_tr_b16 v[68:69], v11 offset:4096
    ds_read_b64_tr_b16 v[70:71], v11 offset:5120
    ds_read_b64_tr_b16 v[72:73], v12 offset:4096
    ds_read_b64_tr_b16 v[74:75], v12 offset:5120
    ds_read_b64_tr_b16 v[76:77], v13 offset:4096
    ds_read_b64_tr_b16 v[78:79], v13 offset:5120
    ds_read_b64_tr_b16 v[80:81], v14 offset:4096
    ds_read_b64_tr_b16 v[82:83], v14 offset:5120
    s_waitcnt lgkmcnt(14)
    v_mfma_f32_16x16x32_bf16 v[20:23], v[52:55], v[84:87], 0
    v_mfma_f32_16x16x32_bf16 v[36:39], v[52:55], v[88:91], 0
    s_waitcnt lgkmcnt(12)
    v_mfma_f32_16x16x32_bf16 v[24:27], v[56:59], v[84:87], 0
    v_mfma_f32_16x16x32_bf16 v[40:43], v[56:59], v[88:91], 0
    s_waitcnt lgkmcnt(10)
    v_mfma_f32_16x16x32_bf16 v[28:31], v[60:63], v[84:87], 0
    v_mfma_f32_16x16x32_bf16 v[44:47], v[60:63], v[88:91], 0
    s_waitcnt lgkmcnt(8)
    v_mfma_f32_16x16x32_bf16 v[32:35], v[64:67], v[84:87], 0
    v_mfma_f32_16x16x32_bf16 v[48:51], v[64:67], v[88:91], 0
    s_waitcnt lgkmcnt(6)
    v_mfma_f32_16x16x32_bf16 v[20:23], v[68:71], v[92:95], v[20:23]
    ds_read_b64_tr_b16 v[52:53], v11 offset:8192
    v_mfma_f32_16x16x32_bf16 v[36:39], v[68:71], v[96:99], v[36:39]
    ds_read_b64_tr_b16 v[54:55], v11 offset:9216
    s_waitcnt lgkmcnt(6)
    v_mfma_f32_16x16x32_bf16 v[24:27], v[72:75], v[92:95], v[24:27]
    ds_read_b64_tr_b16 v[56:57], v12 offset:8192
    v_mfma_f32_16x16x32_bf16 v[40:43], v[72:75], v[96:99], v[40:43]
    ds_read_b64_tr_b16 v[58:59], v12 offset:9216
    s_waitcnt lgkmcnt(6)
    v_mfma_f32_16x16x32_bf16 v[28:31], v[76:79], v[92:95], v[28:31]
    ds_read_b64_tr_b16 v[60:61], v13 offset:8192
    v_mfma_f32_16x16x32_bf16 v[44:47], v[76:79], v[96:99], v[44:47]
    ds_read_b64_tr_b16 v[62:63], v13 offset:9216
    s_waitcnt lgkmcnt(6)
    v_mfma_f32_16x16x32_bf16 v[32:35], v[80:83], v[92:95], v[32:35]
    ds_read_b64_tr_b16 v[64:65], v14 offset:8192
    v_mfma_f32_16x16x32_bf16 v[48:51], v[80:83], v[96:99], v[48:51]
    ds_read_b64_tr_b16 v[66:67], v14 offset:9216
    s_waitcnt lgkmcnt(6)
    v_mfma_f32_16x16x32_bf16 v[20:23], v[52:55], v[100:103], v[20:23]
    ds_read_b64_tr_b16 v[68:69], v11 offset:12288
    ds_read_b64_tr_b16 v[70:71], v11 offset:13312
    v_mfma_f32_16x16x32_bf16 v[36:39], v[52:55], v[104:107], v[36:39]
    ds_read_b64_tr_b16 v[72:73], v12 offset:12288
    ds_read_b64_tr_b16 v[74:75], v12 offset:13312
    s_waitcnt lgkmcnt(8)
    v_mfma_f32_16x16x32_bf16 v[24:27], v[56:59], v[100:103], v[24:27]
    ds_read_b64_tr_b16 v[76:77], v13 offset:12288
    ds_read_b64_tr_b16 v[78:79], v13 offset:13312
    v_mfma_f32_16x16x32_bf16 v[40:43], v[56:59], v[104:107], v[40:43]
    ds_read_b64_tr_b16 v[80:81], v14 offset:12288
    ds_read_b64_tr_b16 v[82:83], v14 offset:13312
    s_waitcnt lgkmcnt(10)
    v_mfma_f32_16x16x32_bf16 v[28:31], v[60:63], v[100:103], v[28:31]
    ds_read_b64_tr_b16 v[84:85], v11 offset:16384
    ds_read_b64_tr_b16 v[86:87], v11 offset:17408
    v_mfma_f32_16x16x32_bf16 v[44:47], v[60:63], v[104:107], v[44:47]
    ds_read_b64_tr_b16 v[88:89], v12 offset:16384
    ds_read_b64_tr_b16 v[90:91], v12 offset:17408
    s_waitcnt lgkmcnt(12)
    v_mfma_f32_16x16x32_bf16 v[32:35], v[64:67], v[100:103], v[32:35]
    ds_read_b64_tr_b16 v[92:93], v13 offset:16384
    ds_read_b64_tr_b16 v[94:95], v13 offset:17408
    v_mfma_f32_16x16x32_bf16 v[48:51], v[64:67], v[104:107], v[48:51]
    ds_read_b64_tr_b16 v[96:97], v14 offset:16384
    ds_read_b64_tr_b16 v[98:99], v14 offset:17408
    s_waitcnt lgkmcnt(14)
    v_mfma_f32_16x16x32_bf16 v[20:23], v[68:71], v[108:111], v[20:23]
    ds_read_b64_tr_b16 v[52:53], v11 offset:20480
    v_mfma_f32_16x16x32_bf16 v[36:39], v[68:71], v[112:115], v[36:39]
    ds_read_b64_tr_b16 v[54:55], v11 offset:21504
    s_waitcnt lgkmcnt(14)
    v_mfma_f32_16x16x32_bf16 v[24:27], v[72:75], v[108:111], v[24:27]
    ds_read_b64_tr_b16 v[56:57], v12 offset:20480
    v_mfma_f32_16x16x32_bf16 v[40:43], v[72:75], v[112:115], v[40:43]
    ds_read_b64_tr_b16 v[58:59], v12 offset:21504
    s_waitcnt lgkmcnt(14)
    v_mfma_f32_16x16x32_bf16 v[28:31], v[76:79], v[108:111], v[28:31]
    ds_read_b64_tr_b16 v[60:61], v13 offset:20480
    v_mfma_f32_16x16x32_bf16 v[44:47], v[76:79], v[112:115], v[44:47]
    ds_read_b64_tr_b16 v[62:63], v13 offset:21504
    s_waitcnt lgkmcnt(14)
    v_mfma_f32_16x16x32_bf16 v[32:35], v[80:83], v[108:111], v[32:35]
    ds_read_b64_tr_b16 v[64:65], v14 offset:20480
    v_mfma_f32_16x16x32_bf16 v[48:51], v[80:83], v[112:115], v[48:51]
    ds_read_b64_tr_b16 v[66:67], v14 offset:21504
    s_waitcnt lgkmcnt(14)
    v_mfma_f32_16x16x32_bf16 v[20:23], v[84:87], v[116:119], v[20:23]
    ds_read_b64_tr_b16 v[68:69], v11 offset:24576
    v_mfma_f32_16x16x32_bf16 v[36:39], v[84:87], v[120:123], v[36:39]
    ds_read_b64_tr_b16 v[70:71], v11 offset:25600
    s_waitcnt lgkmcnt(14)
    v_mfma_f32_16x16x32_bf16 v[24:27], v[88:91], v[116:119], v[24:27]
    ds_read_b64_tr_b16 v[72:73], v12 offset:24576
    v_mfma_f32_16x16x32_bf16 v[40:43], v[88:91], v[120:123], v[40:43]
    ds_read_b64_tr_b16 v[74:75], v12 offset:25600
    s_waitcnt lgkmcnt(14)
    v_mfma_f32_16x16x32_bf16 v[28:31], v[92:95], v[116:119], v[28:31]
    ds_read_b64_tr_b16 v[76:77], v13 offset:24576
    v_mfma_f32_16x16x32_bf16 v[44:47], v[92:95], v[120:123], v[44:47]
    ds_read_b64_tr_b16 v[78:79], v13 offset:25600
    s_waitcnt lgkmcnt(14)
    v_mfma_f32_16x16x32_bf16 v[32:35], v[96:99], v[116:119], v[32:35]
    ds_read_b64_tr_b16 v[80:81], v14 offset:24576
    v_mfma_f32_16x16x32_bf16 v[48:51], v[96:99], v[120:123], v[48:51]
    ds_read_b64_tr_b16 v[82:83], v14 offset:25600
    s_waitcnt lgkmcnt(14)
    v_mfma_f32_16x16x32_bf16 v[20:23], v[52:55], v[124:127], v[20:23]
    ds_read_b64_tr_b16 v[84:85], v11 offset:28672
    v_mfma_f32_16x16x32_bf16 v[36:39], v[52:55], v[128:131], v[36:39]
    ds_read_b64_tr_b16 v[86:87], v11 offset:29696
    s_waitcnt lgkmcnt(14)
    v_mfma_f32_16x16x32_bf16 v[24:27], v[56:59], v[124:127], v[24:27]
    ds_read_b64_tr_b16 v[88:89], v12 offset:28672
    v_mfma_f32_16x16x32_bf16 v[40:43], v[56:59], v[128:131], v[40:43]
    ds_read_b64_tr_b16 v[90:91], v12 offset:29696
    s_waitcnt lgkmcnt(14)
    v_mfma_f32_16x16x32_bf16 v[28:31], v[60:63], v[124:127], v[28:31]
    ds_read_b64_tr_b16 v[92:93], v13 offset:28672
    v_mfma_f32_16x16x32_bf16 v[44:47], v[60:63], v[128:131], v[44:47]
    ds_read_b64_tr_b16 v[94:95], v13 offset:29696
    s_waitcnt lgkmcnt(14)
    v_mfma_f32_16x16x32_bf16 v[32:35], v[64:67], v[124:127], v[32:35]
    ds_read_b64_tr_b16 v[96:97], v14 offset:28672
    v_mfma_f32_16x16x32_bf16 v[48:51], v[64:67], v[128:131], v[48:51]
    ds_read_b64_tr_b16 v[98:99], v14 offset:29696
    s_waitcnt lgkmcnt(14)
    v_mfma_f32_16x16x32_bf16 v[20:23], v[68:71], v[132:135], v[20:23]
    ds_read_b64_tr_b16 v[52:53], v11 offset:32768
    v_mfma_f32_16x16x32_bf16 v[36:39], v[68:71], v[136:139], v[36:39]
    ds_read_b64_tr_b16 v[54:55], v11 offset:33792
    s_waitcnt lgkmcnt(14)
    v_mfma_f32_16x16x32_bf16 v[24:27], v[72:75], v[132:135], v[24:27]
    ds_read_b64_tr_b16 v[56:57], v12 offset:32768
    v_mfma_f32_16x16x32_bf16 v[40:43], v[72:75], v[136:139], v[40:43]
    ds_read_b64_tr_b16 v[58:59], v12 offset:33792
    s_waitcnt lgkmcnt(14)
    v_mfma_f32_16x16x32_bf16 v[28:31], v[76:79], v[132:135], v[28:31]
    ds_read_b64_tr_b16 v[60:61], v13 offset:32768
    v_mfma_f32_16x16x32_bf16 v[44:47], v[76:79], v[136:139], v[44:47]
    ds_read_b64_tr_b16 v[62:63], v13 offset:33792
    s_waitcnt lgkmcnt(14)
    v_mfma_f32_16x16x32_bf16 v[32:35], v[80:83], v[132:135], v[32:35]
    ds_read_b64_tr_b16 v[64:65], v14 offset:32768
    v_mfma_f32_16x16x32_bf16 v[48:51], v[80:83], v[136:139], v[48:51]
    ds_read_b64_tr_b16 v[66:67], v14 offset:33792
    s_waitcnt vmcnt(0)
    s_barrier
    s_waitcnt lgkmcnt(14)
    v_mfma_f32_16x16x32_bf16 v[20:23], v[84:87], v[140:143], v[20:23]
    ds_read_b64_tr_b16 v[68:69], v11 offset:36864
    v_mfma_f32_16x16x32_bf16 v[36:39], v[84:87], v[144:147], v[36:39]
    ds_read_b64_tr_b16 v[70:71], v11 offset:37888
    s_waitcnt lgkmcnt(14)
    v_mfma_f32_16x16x32_bf16 v[24:27], v[88:91], v[140:143], v[24:27]
    ds_read_b64_tr_b16 v[72:73], v12 offset:36864
    v_mfma_f32_16x16x32_bf16 v[40:43], v[88:91], v[144:147], v[40:43]
    ds_read_b64_tr_b16 v[74:75], v12 offset:37888
    s_waitcnt lgkmcnt(14)
    v_mfma_f32_16x16x32_bf16 v[28:31], v[92:95], v[140:143], v[28:31]
    ds_read_b64_tr_b16 v[76:77], v13 offset:36864
    v_mfma_f32_16x16x32_bf16 v[44:47], v[92:95], v[144:147], v[44:47]
    ds_read_b64_tr_b16 v[78:79], v13 offset:37888
    s_waitcnt lgkmcnt(14)
    v_mfma_f32_16x16x32_bf16 v[32:35], v[96:99], v[140:143], v[32:35]
    ds_read_b64_tr_b16 v[80:81], v14 offset:36864
    v_mfma_f32_16x16x32_bf16 v[48:51], v[96:99], v[144:147], v[48:51]
    ds_read_b64_tr_b16 v[82:83], v14 offset:37888
    s_waitcnt lgkmcnt(14)
    v_mfma_f32_16x16x32_bf16 v[20:23], v[52:55], v[148:151], v[20:23]
    v_add_u32 v11, 40960, v11
    v_add_u32 v12, 40960, v12
    v_mfma_f32_16x16x32_bf16 v[36:39], v[52:55], v[152:155], v[36:39]
    v_add_u32 v13, 40960, v13
    s_waitcnt lgkmcnt(12)
    v_mfma_f32_16x16x32_bf16 v[24:27], v[56:59], v[148:151], v[24:27]
    v_add_u32 v14, 40960, v14
    ds_read_b64_tr_b16 v[84:85], v11 offset:0
    v_mfma_f32_16x16x32_bf16 v[40:43], v[56:59], v[152:155], v[40:43]
    ds_read_b64_tr_b16 v[86:87], v11 offset:1024
    s_waitcnt lgkmcnt(12)
    v_mfma_f32_16x16x32_bf16 v[28:31], v[60:63], v[148:151], v[28:31]
    ds_read_b64_tr_b16 v[88:89], v12 offset:0
    ds_read_b64_tr_b16 v[90:91], v12 offset:1024
    v_mfma_f32_16x16x32_bf16 v[44:47], v[60:63], v[152:155], v[44:47]
    ds_read_b64_tr_b16 v[92:93], v13 offset:0
    s_waitcnt lgkmcnt(13)
    v_mfma_f32_16x16x32_bf16 v[32:35], v[64:67], v[148:151], v[32:35]
    ds_read_b64_tr_b16 v[94:95], v13 offset:1024
    ds_read_b64_tr_b16 v[96:97], v14 offset:0
    v_mfma_f32_16x16x32_bf16 v[48:51], v[64:67], v[152:155], v[48:51]
    ds_read_b64_tr_b16 v[98:99], v14 offset:1024
    s_waitcnt lgkmcnt(14)
    v_mfma_f32_16x16x32_bf16 v[20:23], v[68:71], v[156:159], v[20:23]
    ds_read_b64_tr_b16 v[52:53], v11 offset:4096
    v_mfma_f32_16x16x32_bf16 v[36:39], v[68:71], v[160:163], v[36:39]
    ds_read_b64_tr_b16 v[54:55], v11 offset:5120
    s_waitcnt lgkmcnt(14)
    v_mfma_f32_16x16x32_bf16 v[24:27], v[72:75], v[156:159], v[24:27]
    ds_read_b64_tr_b16 v[56:57], v12 offset:4096
    v_mfma_f32_16x16x32_bf16 v[40:43], v[72:75], v[160:163], v[40:43]
    ds_read_b64_tr_b16 v[58:59], v12 offset:5120
    s_waitcnt lgkmcnt(14)
    v_mfma_f32_16x16x32_bf16 v[28:31], v[76:79], v[156:159], v[28:31]
    ds_read_b64_tr_b16 v[60:61], v13 offset:4096
    v_mfma_f32_16x16x32_bf16 v[44:47], v[76:79], v[160:163], v[44:47]
    ds_read_b64_tr_b16 v[62:63], v13 offset:5120
    s_waitcnt lgkmcnt(14)
    v_mfma_f32_16x16x32_bf16 v[32:35], v[80:83], v[156:159], v[32:35]
    ds_read_b64_tr_b16 v[64:65], v14 offset:4096
    v_mfma_f32_16x16x32_bf16 v[48:51], v[80:83], v[160:163], v[48:51]
    ds_read_b64_tr_b16 v[66:67], v14 offset:5120
    s_waitcnt lgkmcnt(14)
    v_mfma_f32_16x16x32_bf16 v[20:23], v[84:87], v[164:167], v[20:23]
    ds_read_b64_tr_b16 v[68:69], v11 offset:8192
    v_mfma_f32_16x16x32_bf16 v[36:39], v[84:87], v[168:171], v[36:39]
    ds_read_b64_tr_b16 v[70:71], v11 offset:9216
    s_waitcnt lgkmcnt(14)
    v_mfma_f32_16x16x32_bf16 v[24:27], v[88:91], v[164:167], v[24:27]
    ds_read_b64_tr_b16 v[72:73], v12 offset:8192
    v_mfma_f32_16x16x32_bf16 v[40:43], v[88:91], v[168:171], v[40:43]
    ds_read_b64_tr_b16 v[74:75], v12 offset:9216
    s_waitcnt lgkmcnt(14)
    v_mfma_f32_16x16x32_bf16 v[28:31], v[92:95], v[164:167], v[28:31]
    ds_read_b64_tr_b16 v[76:77], v13 offset:8192
    v_mfma_f32_16x16x32_bf16 v[44:47], v[92:95], v[168:171], v[44:47]
    ds_read_b64_tr_b16 v[78:79], v13 offset:9216
    s_waitcnt lgkmcnt(14)
    v_mfma_f32_16x16x32_bf16 v[32:35], v[96:99], v[164:167], v[32:35]
    ds_read_b64_tr_b16 v[80:81], v14 offset:8192
    v_mfma_f32_16x16x32_bf16 v[48:51], v[96:99], v[168:171], v[48:51]
    ds_read_b64_tr_b16 v[82:83], v14 offset:9216
    s_waitcnt lgkmcnt(14)
    v_mfma_f32_16x16x32_bf16 v[20:23], v[52:55], v[172:175], v[20:23]
    ds_read_b64_tr_b16 v[84:85], v11 offset:12288
    v_mfma_f32_16x16x32_bf16 v[36:39], v[52:55], v[176:179], v[36:39]
    ds_read_b64_tr_b16 v[86:87], v11 offset:13312
    s_waitcnt lgkmcnt(14)
    v_mfma_f32_16x16x32_bf16 v[24:27], v[56:59], v[172:175], v[24:27]
    ds_read_b64_tr_b16 v[88:89], v12 offset:12288
    v_mfma_f32_16x16x32_bf16 v[40:43], v[56:59], v[176:179], v[40:43]
    ds_read_b64_tr_b16 v[90:91], v12 offset:13312
    s_waitcnt lgkmcnt(14)
    v_mfma_f32_16x16x32_bf16 v[28:31], v[60:63], v[172:175], v[28:31]
    ds_read_b64_tr_b16 v[92:93], v13 offset:12288
    v_mfma_f32_16x16x32_bf16 v[44:47], v[60:63], v[176:179], v[44:47]
    ds_read_b64_tr_b16 v[94:95], v13 offset:13312
    s_waitcnt lgkmcnt(14)
    v_mfma_f32_16x16x32_bf16 v[32:35], v[64:67], v[172:175], v[32:35]
    ds_read_b64_tr_b16 v[96:97], v14 offset:12288
    v_mfma_f32_16x16x32_bf16 v[48:51], v[64:67], v[176:179], v[48:51]
    ds_read_b64_tr_b16 v[98:99], v14 offset:13312
    s_waitcnt lgkmcnt(14)
    v_mfma_f32_16x16x32_bf16 v[20:23], v[68:71], v[180:183], v[20:23]
    ds_read_b64_tr_b16 v[52:53], v11 offset:16384
    v_mfma_f32_16x16x32_bf16 v[36:39], v[68:71], v[184:187], v[36:39]
    ds_read_b64_tr_b16 v[54:55], v11 offset:17408
    s_waitcnt lgkmcnt(14)
    v_mfma_f32_16x16x32_bf16 v[24:27], v[72:75], v[180:183], v[24:27]
    ds_read_b64_tr_b16 v[56:57], v12 offset:16384
    v_mfma_f32_16x16x32_bf16 v[40:43], v[72:75], v[184:187], v[40:43]
    ds_read_b64_tr_b16 v[58:59], v12 offset:17408
    s_waitcnt lgkmcnt(14)
    v_mfma_f32_16x16x32_bf16 v[28:31], v[76:79], v[180:183], v[28:31]
    ds_read_b64_tr_b16 v[60:61], v13 offset:16384
    v_mfma_f32_16x16x32_bf16 v[44:47], v[76:79], v[184:187], v[44:47]
    ds_read_b64_tr_b16 v[62:63], v13 offset:17408
    s_waitcnt lgkmcnt(14)
    v_mfma_f32_16x16x32_bf16 v[32:35], v[80:83], v[180:183], v[32:35]
    ds_read_b64_tr_b16 v[64:65], v14 offset:16384
    v_mfma_f32_16x16x32_bf16 v[48:51], v[80:83], v[184:187], v[48:51]
    ds_read_b64_tr_b16 v[66:67], v14 offset:17408
    s_waitcnt lgkmcnt(14)
    v_mfma_f32_16x16x32_bf16 v[20:23], v[84:87], v[188:191], v[20:23]
    ds_read_b64_tr_b16 v[68:69], v11 offset:20480
    v_mfma_f32_16x16x32_bf16 v[36:39], v[84:87], v[192:195], v[36:39]
    ds_read_b64_tr_b16 v[70:71], v11 offset:21504
    s_waitcnt lgkmcnt(14)
    v_mfma_f32_16x16x32_bf16 v[24:27], v[88:91], v[188:191], v[24:27]
    ds_read_b64_tr_b16 v[72:73], v12 offset:20480
    v_mfma_f32_16x16x32_bf16 v[40:43], v[88:91], v[192:195], v[40:43]
    ds_read_b64_tr_b16 v[74:75], v12 offset:21504
    s_waitcnt lgkmcnt(14)
    v_mfma_f32_16x16x32_bf16 v[28:31], v[92:95], v[188:191], v[28:31]
    ds_read_b64_tr_b16 v[76:77], v13 offset:20480
    v_mfma_f32_16x16x32_bf16 v[44:47], v[92:95], v[192:195], v[44:47]
    ds_read_b64_tr_b16 v[78:79], v13 offset:21504
    s_waitcnt lgkmcnt(14)
    v_mfma_f32_16x16x32_bf16 v[32:35], v[96:99], v[188:191], v[32:35]
    ds_read_b64_tr_b16 v[80:81], v14 offset:20480
    v_mfma_f32_16x16x32_bf16 v[48:51], v[96:99], v[192:195], v[48:51]
    ds_read_b64_tr_b16 v[82:83], v14 offset:21504
    s_waitcnt lgkmcnt(14)
    v_mfma_f32_16x16x32_bf16 v[20:23], v[52:55], v[196:199], v[20:23]
    ds_read_b64_tr_b16 v[84:85], v11 offset:24576
    v_mfma_f32_16x16x32_bf16 v[36:39], v[52:55], v[200:203], v[36:39]
    ds_read_b64_tr_b16 v[86:87], v11 offset:25600
    s_waitcnt lgkmcnt(14)
    v_mfma_f32_16x16x32_bf16 v[24:27], v[56:59], v[196:199], v[24:27]
    ds_read_b64_tr_b16 v[88:89], v12 offset:24576
    v_mfma_f32_16x16x32_bf16 v[40:43], v[56:59], v[200:203], v[40:43]
    ds_read_b64_tr_b16 v[90:91], v12 offset:25600
    s_waitcnt lgkmcnt(14)
    v_mfma_f32_16x16x32_bf16 v[28:31], v[60:63], v[196:199], v[28:31]
    ds_read_b64_tr_b16 v[92:93], v13 offset:24576
    v_mfma_f32_16x16x32_bf16 v[44:47], v[60:63], v[200:203], v[44:47]
    ds_read_b64_tr_b16 v[94:95], v13 offset:25600
    s_waitcnt lgkmcnt(14)
    v_mfma_f32_16x16x32_bf16 v[32:35], v[64:67], v[196:199], v[32:35]
    ds_read_b64_tr_b16 v[96:97], v14 offset:24576
    v_mfma_f32_16x16x32_bf16 v[48:51], v[64:67], v[200:203], v[48:51]
    ds_read_b64_tr_b16 v[98:99], v14 offset:25600
    s_waitcnt lgkmcnt(14)
    v_mfma_f32_16x16x32_bf16 v[20:23], v[68:71], v[204:207], v[20:23]
    ds_read_b64_tr_b16 v[52:53], v11 offset:28672
    v_mfma_f32_16x16x32_bf16 v[36:39], v[68:71], v[208:211], v[36:39]
    ds_read_b64_tr_b16 v[54:55], v11 offset:29696
    s_waitcnt lgkmcnt(14)
    v_mfma_f32_16x16x32_bf16 v[24:27], v[72:75], v[204:207], v[24:27]
    ds_read_b64_tr_b16 v[56:57], v12 offset:28672
    v_mfma_f32_16x16x32_bf16 v[40:43], v[72:75], v[208:211], v[40:43]
    ds_read_b64_tr_b16 v[58:59], v12 offset:29696
    s_waitcnt lgkmcnt(14)
    v_mfma_f32_16x16x32_bf16 v[28:31], v[76:79], v[204:207], v[28:31]
    ds_read_b64_tr_b16 v[60:61], v13 offset:28672
    v_mfma_f32_16x16x32_bf16 v[44:47], v[76:79], v[208:211], v[44:47]
    ds_read_b64_tr_b16 v[62:63], v13 offset:29696
    s_waitcnt lgkmcnt(14)
    v_mfma_f32_16x16x32_bf16 v[32:35], v[80:83], v[204:207], v[32:35]
    ds_read_b64_tr_b16 v[64:65], v14 offset:28672
    v_mfma_f32_16x16x32_bf16 v[48:51], v[80:83], v[208:211], v[48:51]
    ds_read_b64_tr_b16 v[66:67], v14 offset:29696
    s_waitcnt lgkmcnt(14)
    v_mfma_f32_16x16x32_bf16 v[20:23], v[84:87], v[212:215], v[20:23]
    ds_read_b64_tr_b16 v[68:69], v11 offset:32768
    v_mfma_f32_16x16x32_bf16 v[36:39], v[84:87], v[216:219], v[36:39]
    ds_read_b64_tr_b16 v[70:71], v11 offset:33792
    s_waitcnt lgkmcnt(14)
    v_mfma_f32_16x16x32_bf16 v[24:27], v[88:91], v[212:215], v[24:27]
    ds_read_b64_tr_b16 v[72:73], v12 offset:32768
    v_mfma_f32_16x16x32_bf16 v[40:43], v[88:91], v[216:219], v[40:43]
    ds_read_b64_tr_b16 v[74:75], v12 offset:33792
    s_waitcnt lgkmcnt(14)
    v_mfma_f32_16x16x32_bf16 v[28:31], v[92:95], v[212:215], v[28:31]
    ds_read_b64_tr_b16 v[76:77], v13 offset:32768
    v_mfma_f32_16x16x32_bf16 v[44:47], v[92:95], v[216:219], v[44:47]
    ds_read_b64_tr_b16 v[78:79], v13 offset:33792
    s_waitcnt lgkmcnt(14)
    v_mfma_f32_16x16x32_bf16 v[32:35], v[96:99], v[212:215], v[32:35]
    ds_read_b64_tr_b16 v[80:81], v14 offset:32768
    v_mfma_f32_16x16x32_bf16 v[48:51], v[96:99], v[216:219], v[48:51]
    ds_read_b64_tr_b16 v[82:83], v14 offset:33792
    s_waitcnt lgkmcnt(14)
    v_mfma_f32_16x16x32_bf16 v[20:23], v[52:55], v[220:223], v[20:23]
    ds_read_b64_tr_b16 v[84:85], v11 offset:36864
    v_mfma_f32_16x16x32_bf16 v[36:39], v[52:55], v[224:227], v[36:39]
    ds_read_b64_tr_b16 v[86:87], v11 offset:37888
    s_waitcnt lgkmcnt(14)
    v_mfma_f32_16x16x32_bf16 v[24:27], v[56:59], v[220:223], v[24:27]
    ds_read_b64_tr_b16 v[88:89], v12 offset:36864
    v_mfma_f32_16x16x32_bf16 v[40:43], v[56:59], v[224:227], v[40:43]
    ds_read_b64_tr_b16 v[90:91], v12 offset:37888
    s_waitcnt lgkmcnt(14)
    v_mfma_f32_16x16x32_bf16 v[28:31], v[60:63], v[220:223], v[28:31]
    ds_read_b64_tr_b16 v[92:93], v13 offset:36864
    v_mfma_f32_16x16x32_bf16 v[44:47], v[60:63], v[224:227], v[44:47]
    ds_read_b64_tr_b16 v[94:95], v13 offset:37888
    s_waitcnt lgkmcnt(14)
    v_mfma_f32_16x16x32_bf16 v[32:35], v[64:67], v[220:223], v[32:35]
    ds_read_b64_tr_b16 v[96:97], v14 offset:36864
    v_mfma_f32_16x16x32_bf16 v[48:51], v[64:67], v[224:227], v[48:51]
    ds_read_b64_tr_b16 v[98:99], v14 offset:37888
    s_waitcnt lgkmcnt(0)
    s_barrier
    s_waitcnt lgkmcnt(14)
    v_mfma_f32_16x16x32_bf16 v[20:23], v[68:71], v[228:231], v[20:23]
    v_mfma_f32_16x16x32_bf16 v[36:39], v[68:71], v[232:235], v[36:39]
    s_waitcnt lgkmcnt(12)
    v_mfma_f32_16x16x32_bf16 v[24:27], v[72:75], v[228:231], v[24:27]
    v_mfma_f32_16x16x32_bf16 v[40:43], v[72:75], v[232:235], v[40:43]
    s_waitcnt lgkmcnt(10)
    v_mfma_f32_16x16x32_bf16 v[28:31], v[76:79], v[228:231], v[28:31]
    v_mfma_f32_16x16x32_bf16 v[44:47], v[76:79], v[232:235], v[44:47]
    s_waitcnt lgkmcnt(8)
    v_mfma_f32_16x16x32_bf16 v[32:35], v[80:83], v[228:231], v[32:35]
    v_mfma_f32_16x16x32_bf16 v[48:51], v[80:83], v[232:235], v[48:51]
    s_waitcnt lgkmcnt(6)
    v_mfma_f32_16x16x32_bf16 v[20:23], v[84:87], v[236:239], v[20:23]
    v_mfma_f32_16x16x32_bf16 v[36:39], v[84:87], v[240:243], v[36:39]
    s_waitcnt lgkmcnt(4)
    v_mfma_f32_16x16x32_bf16 v[24:27], v[88:91], v[236:239], v[24:27]
    v_mfma_f32_16x16x32_bf16 v[40:43], v[88:91], v[240:243], v[40:43]
    s_waitcnt lgkmcnt(2)
    v_mfma_f32_16x16x32_bf16 v[28:31], v[92:95], v[236:239], v[28:31]
    v_mfma_f32_16x16x32_bf16 v[44:47], v[92:95], v[240:243], v[44:47]
    s_waitcnt lgkmcnt(0)
    v_mfma_f32_16x16x32_bf16 v[32:35], v[96:99], v[236:239], v[32:35]
    v_mfma_f32_16x16x32_bf16 v[48:51], v[96:99], v[240:243], v[48:51]
    s_nop 4
    ds_read_b128 v[52:55], v5 offset:256
    ds_read_b128 v[56:59], v5 offset:320
    ds_read_b128 v[60:63], v5 offset:384
    ds_read_b128 v[64:67], v5 offset:448
    s_waitcnt lgkmcnt(0)
    s_cmp_eq_u32 s49, 13
    s_cbranch_scc1 sequential_preLN__linear_attn_block__dense_activation_relu__prompt_kernel_p3ns88
    v_pk_fma_f32 v[20:21], v[52:53], v[16:17], v[20:21] op_sel_hi:[1,0,1] neg_lo:[0,1,0] neg_hi:[0,1,0]
    v_pk_fma_f32 v[22:23], v[54:55], v[16:17], v[22:23] op_sel_hi:[1,0,1] neg_lo:[0,1,0] neg_hi:[0,1,0]
    v_pk_mul_f32 v[20:21], v[20:21], v[16:17] op_sel:[0,1]
    v_pk_mul_f32 v[22:23], v[22:23], v[16:17] op_sel:[0,1]
    v_pk_fma_f32 v[24:25], v[56:57], v[16:17], v[24:25] op_sel_hi:[1,0,1] neg_lo:[0,1,0] neg_hi:[0,1,0]
    v_pk_fma_f32 v[26:27], v[58:59], v[16:17], v[26:27] op_sel_hi:[1,0,1] neg_lo:[0,1,0] neg_hi:[0,1,0]
    v_pk_mul_f32 v[24:25], v[24:25], v[16:17] op_sel:[0,1]
    v_pk_mul_f32 v[26:27], v[26:27], v[16:17] op_sel:[0,1]
    v_cvt_pk_bf16_f32 v68, v20, v21
    v_cvt_pk_bf16_f32 v70, v24, v25
    v_cvt_pk_bf16_f32 v69, v22, v23
    v_cvt_pk_bf16_f32 v71, v26, v27
    v_permlane16_swap_b32 v68, v70
    s_nop 0
    v_permlane16_swap_b32 v69, v71
    v_pk_max_i16 v68, v68, 0
    v_pk_max_i16 v70, v70, 0
    v_pk_max_i16 v69, v69, 0
    v_pk_max_i16 v71, v71, 0
    buffer_store_dwordx4 v[68:71], v3, s[40:43], 0 offen offset:128 sc1
    v_pk_fma_f32 v[28:29], v[60:61], v[16:17], v[28:29] op_sel_hi:[1,0,1] neg_lo:[0,1,0] neg_hi:[0,1,0]
    v_pk_fma_f32 v[30:31], v[62:63], v[16:17], v[30:31] op_sel_hi:[1,0,1] neg_lo:[0,1,0] neg_hi:[0,1,0]
    v_pk_mul_f32 v[28:29], v[28:29], v[16:17] op_sel:[0,1]
    v_pk_mul_f32 v[30:31], v[30:31], v[16:17] op_sel:[0,1]
    v_pk_fma_f32 v[32:33], v[64:65], v[16:17], v[32:33] op_sel_hi:[1,0,1] neg_lo:[0,1,0] neg_hi:[0,1,0]
    v_pk_fma_f32 v[34:35], v[66:67], v[16:17], v[34:35] op_sel_hi:[1,0,1] neg_lo:[0,1,0] neg_hi:[0,1,0]
    v_pk_mul_f32 v[32:33], v[32:33], v[16:17] op_sel:[0,1]
    v_pk_mul_f32 v[34:35], v[34:35], v[16:17] op_sel:[0,1]
    v_cvt_pk_bf16_f32 v72, v28, v29
    v_cvt_pk_bf16_f32 v74, v32, v33
    v_cvt_pk_bf16_f32 v73, v30, v31
    v_cvt_pk_bf16_f32 v75, v34, v35
    v_permlane16_swap_b32 v72, v74
    s_nop 0
    v_permlane16_swap_b32 v73, v75
    v_pk_max_i16 v72, v72, 0
    v_pk_max_i16 v74, v74, 0
    v_pk_max_i16 v73, v73, 0
    v_pk_max_i16 v75, v75, 0
    buffer_store_dwordx4 v[72:75], v3, s[40:43], 0 offen offset:192 sc1
    v_pk_fma_f32 v[36:37], v[52:53], v[18:19], v[36:37] op_sel_hi:[1,0,1] neg_lo:[0,1,0] neg_hi:[0,1,0]
    v_pk_fma_f32 v[38:39], v[54:55], v[18:19], v[38:39] op_sel_hi:[1,0,1] neg_lo:[0,1,0] neg_hi:[0,1,0]
    v_pk_mul_f32 v[36:37], v[36:37], v[18:19] op_sel:[0,1]
    v_pk_mul_f32 v[38:39], v[38:39], v[18:19] op_sel:[0,1]
    v_pk_fma_f32 v[40:41], v[56:57], v[18:19], v[40:41] op_sel_hi:[1,0,1] neg_lo:[0,1,0] neg_hi:[0,1,0]
    v_pk_fma_f32 v[42:43], v[58:59], v[18:19], v[42:43] op_sel_hi:[1,0,1] neg_lo:[0,1,0] neg_hi:[0,1,0]
    v_pk_mul_f32 v[40:41], v[40:41], v[18:19] op_sel:[0,1]
    v_pk_mul_f32 v[42:43], v[42:43], v[18:19] op_sel:[0,1]
    v_cvt_pk_bf16_f32 v76, v36, v37
    v_cvt_pk_bf16_f32 v78, v40, v41
    v_cvt_pk_bf16_f32 v77, v38, v39
    v_cvt_pk_bf16_f32 v79, v42, v43
    v_permlane16_swap_b32 v76, v78
    s_nop 0
    v_permlane16_swap_b32 v77, v79
    v_pk_max_i16 v76, v76, 0
    v_pk_max_i16 v78, v78, 0
    v_pk_max_i16 v77, v77, 0
    v_pk_max_i16 v79, v79, 0
    buffer_store_dwordx4 v[76:79], v3, s[40:43], s31 offen offset:128 sc1
    v_pk_fma_f32 v[44:45], v[60:61], v[18:19], v[44:45] op_sel_hi:[1,0,1] neg_lo:[0,1,0] neg_hi:[0,1,0]
    v_pk_fma_f32 v[46:47], v[62:63], v[18:19], v[46:47] op_sel_hi:[1,0,1] neg_lo:[0,1,0] neg_hi:[0,1,0]
    v_pk_mul_f32 v[44:45], v[44:45], v[18:19] op_sel:[0,1]
    v_pk_mul_f32 v[46:47], v[46:47], v[18:19] op_sel:[0,1]
    v_pk_fma_f32 v[48:49], v[64:65], v[18:19], v[48:49] op_sel_hi:[1,0,1] neg_lo:[0,1,0] neg_hi:[0,1,0]
    v_pk_fma_f32 v[50:51], v[66:67], v[18:19], v[50:51] op_sel_hi:[1,0,1] neg_lo:[0,1,0] neg_hi:[0,1,0]
    v_pk_mul_f32 v[48:49], v[48:49], v[18:19] op_sel:[0,1]
    v_pk_mul_f32 v[50:51], v[50:51], v[18:19] op_sel:[0,1]
    v_cvt_pk_bf16_f32 v80, v44, v45
    v_cvt_pk_bf16_f32 v82, v48, v49
    v_cvt_pk_bf16_f32 v81, v46, v47
    v_cvt_pk_bf16_f32 v83, v50, v51
    v_permlane16_swap_b32 v80, v82
    s_nop 0
    v_permlane16_swap_b32 v81, v83
    v_pk_max_i16 v80, v80, 0
    v_pk_max_i16 v82, v82, 0
    v_pk_max_i16 v81, v81, 0
    v_pk_max_i16 v83, v83, 0
    buffer_store_dwordx4 v[80:83], v3, s[40:43], s31 offen offset:192 sc1
sequential_preLN__linear_attn_block__dense_activation_relu__prompt_kernel_p3ns88:
sequential_preLN__linear_attn_block__dense_activation_relu__prompt_kernel_p4c86:
    s_and_b32 s48, s23, 7
    s_lshl_b32 s3, s24, 3
    s_add_u32 s48, s48, s3
    s_lshr_b32 s49, s23, 3
    s_lshl_b32 s3, s25, 2
    s_add_u32 s49, s49, s3
    s_add_u32 s40, s20, 4194304
    s_addc_u32 s41, s21, 0
    s_mov_b32 s42, 2621440
    s_mov_b32 s43, 0x20000
    s_mov_b64 s[44:45], s[16:17]
    s_mov_b32 s46, 2621440
    s_mov_b32 s47, 0x20000
    s_lshl_b32 s30, s48, 6
    s_lshl_b32 s31, s29, 5
    s_add_u32 s30, s30, s31
    v_and_b32 v5, 15, v1
    v_add_u32 v5, s30, v5
    v_mul_u32_u24 v3, 1280, v5
    s_mul_i32 s30, s49, 160
    s_lshl_b32 s31, s28, 6
    s_add_u32 s30, s30, s31
    v_add_u32 v3, s30, v3
    v_lshrrev_b32 v6, 4, v1
    v_lshl_add_u32 v4, v6, 3, v3
    v_bfe_u32 v5, v1, 4, 1
    v_lshl_add_u32 v3, v5, 5, v3
    v_lshrrev_b32 v5, 5, v1
    v_lshl_add_u32 v3, v5, 4, v3
    s_movk_i32 s31, 20480
    s_mov_b32 s55, 4294893568
    s_mov_b32 s56, 4294895616
    v_and_b32 v88, 15, v1
    v_lshrrev_b32 v89, 4, v1
    v_and_b32 v90, 6, v88
    v_xor_b32 v90, v90, v89
    v_lshlrev_b32 v90, 4, v90
    v_lshl_add_u32 v91, v88, 7, v90
    s_mul_i32 s50, s29, 4096
    s_add_u32 s50, s50, 0
    v_add_u32 v91, s50, v91
    v_xor_b32 v92, 64, v91
    v_bfe_u32 v88, v1, 2, 3
    v_lshrrev_b32 v89, 5, v1
    v_mul_u32_u24 v89, 2560, v89
    v_mul_u32_u24 v90, 160, v88
    v_add_u32 v93, v89, v90
    v_and_b32 v90, 3, v1
    v_lshl_add_u32 v93, v90, 3, v93
    v_add_u32 v93, 81920, v93
    s_mul_i32 s50, s28, 64
    v_add_u32 v93, s50, v93
    v_mov_b64 v[24:25], 0
    v_mov_b64 v[26:27], 0
    v_mov_b64 v[28:29], 0
    v_mov_b64 v[30:31], 0
    v_mov_b64 v[32:33], 0
    v_mov_b64 v[34:35], 0
    v_mov_b64 v[36:37], 0
    v_mov_b64 v[38:39], 0
    v_mov_b64 v[40:41], 0
    v_mov_b64 v[42:43], 0
    v_mov_b64 v[44:45], 0
    v_mov_b64 v[46:47], 0
    s_mov_b32 s52, 0
    s_mov_b32 s53, 0
    s_mov_b32 s54, 0
    buffer_load_dwordx4 v[8:11], v3, s[40:43], 0 offen sc1
    buffer_load_dwordx2 v[12:13], v4, s[40:43], 0 offen offset:64 sc1
    buffer_load_dwordx4 v[16:19], v3, s[40:43], s31 offen sc1
    buffer_load_dwordx2 v[20:21], v4, s[40:43], s31 offen offset:64 sc1
    s_barrier
    ds_read_b128 v[48:51], v91 offset:0
    ds_read_b128 v[52:55], v91 offset:2048
    ds_read_b64_tr_b16 v[64:65], v93 offset:0
    ds_read_b64_tr_b16 v[66:67], v93 offset:1280
    ds_read_b64_tr_b16 v[68:69], v93 offset:32
    ds_read_b64_tr_b16 v[70:71], v93 offset:1312
    ds_read_b64_tr_b16 v[72:73], v93 offset:64
    ds_read_b64_tr_b16 v[74:75], v93 offset:1344
sequential_preLN__linear_attn_block__dense_activation_relu__prompt_kernel_mm90:
    ds_read_b128 v[56:59], v92 offset:0
    s_waitcnt lgkmcnt(3)
    v_mfma_f32_16x16x32_bf16 v[24:27], v[64:67], v[48:51], v[24:27]
    ds_read_b128 v[60:63], v92 offset:2048
    ds_read_b64_tr_b16 v[76:77], v93 offset:5120
    s_add_u32 s53, s53, 1
    s_cmp_eq_u32 s53, 10
    s_cselect_b32 s50, s55, 8192
    s_cselect_b32 s53, 0, s53
    v_add_u32 v91, s50, v91
    v_mfma_f32_16x16x32_bf16 v[36:39], v[64:67], v[52:55], v[36:39]
    ds_read_b64_tr_b16 v[78:79], v93 offset:6400
    v_mfma_f32_16x16x32_bf16 v[28:31], v[68:71], v[48:51], v[28:31]
    ds_read_b64_tr_b16 v[80:81], v93 offset:5152
    v_mfma_f32_16x16x32_bf16 v[40:43], v[68:71], v[52:55], v[40:43]
    s_add_u32 s54, s54, 1
    s_cmp_eq_u32 s54, 8
    s_cselect_b32 s51, s56, 10240
    s_cselect_b32 s54, 0, s54
    ds_read_b64_tr_b16 v[82:83], v93 offset:6432
    ds_read_b64_tr_b16 v[84:85], v93 offset:5184
    s_waitcnt lgkmcnt(7)
    v_mfma_f32_16x16x32_bf16 v[32:35], v[72:75], v[48:51], v[32:35]
    ds_read_b64_tr_b16 v[86:87], v93 offset:6464
    v_mfma_f32_16x16x32_bf16 v[44:47], v[72:75], v[52:55], v[44:47]
    s_waitcnt vmcnt(0)
    s_barrier
    v_add_u32 v93, s51, v93
    ds_read_b128 v[48:51], v91 offset:0
    s_waitcnt lgkmcnt(3)
    v_mfma_f32_16x16x32_bf16 v[24:27], v[76:79], v[56:59], v[24:27]
    ds_read_b128 v[52:55], v91 offset:2048
    ds_read_b64_tr_b16 v[64:65], v93 offset:0
    v_mfma_f32_16x16x32_bf16 v[36:39], v[76:79], v[60:63], v[36:39]
    ds_read_b64_tr_b16 v[66:67], v93 offset:1280
    v_add_u32 v92, s50, v92
    s_add_u32 s52, s52, 1
    s_cmp_lt_u32 s52, 27
    v_mfma_f32_16x16x32_bf16 v[28:31], v[80:83], v[56:59], v[28:31]
    ds_read_b64_tr_b16 v[68:69], v93 offset:32
    v_mfma_f32_16x16x32_bf16 v[40:43], v[80:83], v[60:63], v[40:43]
    ds_read_b64_tr_b16 v[70:71], v93 offset:1312
    ds_read_b64_tr_b16 v[72:73], v93 offset:64
    s_waitcnt lgkmcnt(7)
    v_mfma_f32_16x16x32_bf16 v[32:35], v[84:87], v[56:59], v[32:35]
    ds_read_b64_tr_b16 v[74:75], v93 offset:1344
    v_mfma_f32_16x16x32_bf16 v[44:47], v[84:87], v[60:63], v[44:47]
    s_cbranch_scc1 sequential_preLN__linear_attn_block__dense_activation_relu__prompt_kernel_mm90
sequential_preLN__linear_attn_block__dense_activation_relu__prompt_kernel_mmdone91:
    s_waitcnt lgkmcnt(0)
    s_nop 7
    v_cvt_pk_bf16_f32 v48, v24, v25
    v_cvt_pk_bf16_f32 v49, v26, v27
    v_cvt_pk_bf16_f32 v50, v28, v29
    v_cvt_pk_bf16_f32 v51, v30, v31
    v_cvt_pk_bf16_f32 v52, v32, v33
    v_cvt_pk_bf16_f32 v53, v34, v35
    v_cvt_pk_bf16_f32 v56, v36, v37
    v_cvt_pk_bf16_f32 v57, v38, v39
    v_cvt_pk_bf16_f32 v58, v40, v41
    v_cvt_pk_bf16_f32 v59, v42, v43
    v_cvt_pk_bf16_f32 v60, v44, v45
    v_cvt_pk_bf16_f32 v61, v46, v47
    s_waitcnt vmcnt(0)
    v_permlane16_swap_b32 v48, v50
    v_permlane16_swap_b32 v49, v51
    v_permlane16_swap_b32 v56, v58
    v_permlane16_swap_b32 v57, v59
    v_lshlrev_b32 v64, 16, v48
    v_and_b32 v65, 0xffff0000, v48
    v_lshlrev_b32 v66, 16, v8
    v_and_b32 v67, 0xffff0000, v8
    v_pk_add_f32 v[64:65], v[64:65], v[66:67]
    v_cvt_pk_bf16_f32 v48, v64, v65
    v_lshlrev_b32 v64, 16, v49
    v_and_b32 v65, 0xffff0000, v49
    v_lshlrev_b32 v66, 16, v9
    v_and_b32 v67, 0xffff0000, v9
    v_pk_add_f32 v[64:65], v[64:65], v[66:67]
    v_cvt_pk_bf16_f32 v49, v64, v65
    v_lshlrev_b32 v64, 16, v50
    v_and_b32 v65, 0xffff0000, v50
    v_lshlrev_b32 v66, 16, v10
    v_and_b32 v67, 0xffff0000, v10
    v_pk_add_f32 v[64:65], v[64:65], v[66:67]
    v_cvt_pk_bf16_f32 v50, v64, v65
    v_lshlrev_b32 v64, 16, v51
    v_and_b32 v65, 0xffff0000, v51
    v_lshlrev_b32 v66, 16, v11
    v_and_b32 v67, 0xffff0000, v11
    v_pk_add_f32 v[64:65], v[64:65], v[66:67]
    v_cvt_pk_bf16_f32 v51, v64, v65
    buffer_store_dwordx4 v[48:51], v3, s[44:47], 0 offen
    v_lshlrev_b32 v64, 16, v56
    v_and_b32 v65, 0xffff0000, v56
    v_lshlrev_b32 v66, 16, v16
    v_and_b32 v67, 0xffff0000, v16
    v_pk_add_f32 v[64:65], v[64:65], v[66:67]
    v_cvt_pk_bf16_f32 v56, v64, v65
    v_lshlrev_b32 v64, 16, v57
    v_and_b32 v65, 0xffff0000, v57
    v_lshlrev_b32 v66, 16, v17
    v_and_b32 v67, 0xffff0000, v17
    v_pk_add_f32 v[64:65], v[64:65], v[66:67]
    v_cvt_pk_bf16_f32 v57, v64, v65
    v_lshlrev_b32 v64, 16, v58
    v_and_b32 v65, 0xffff0000, v58
    v_lshlrev_b32 v66, 16, v18
    v_and_b32 v67, 0xffff0000, v18
    v_pk_add_f32 v[64:65], v[64:65], v[66:67]
    v_cvt_pk_bf16_f32 v58, v64, v65
    v_lshlrev_b32 v64, 16, v59
    v_and_b32 v65, 0xffff0000, v59
    v_lshlrev_b32 v66, 16, v19
    v_and_b32 v67, 0xffff0000, v19
    v_pk_add_f32 v[64:65], v[64:65], v[66:67]
    v_cvt_pk_bf16_f32 v59, v64, v65
    buffer_store_dwordx4 v[56:59], v3, s[44:47], s31 offen
    s_cmp_eq_u32 s28, 0
    s_cbranch_scc1 sequential_preLN__linear_attn_block__dense_activation_relu__prompt_kernel_p4n92
    v_lshlrev_b32 v64, 16, v52
    v_and_b32 v65, 0xffff0000, v52
    v_lshlrev_b32 v66, 16, v12
    v_and_b32 v67, 0xffff0000, v12
    v_pk_add_f32 v[64:65], v[64:65], v[66:67]
    v_cvt_pk_bf16_f32 v52, v64, v65
    v_lshlrev_b32 v64, 16, v53
    v_and_b32 v65, 0xffff0000, v53
    v_lshlrev_b32 v66, 16, v13
    v_and_b32 v67, 0xffff0000, v13
    v_pk_add_f32 v[64:65], v[64:65], v[66:67]
    v_cvt_pk_bf16_f32 v53, v64, v65
    buffer_store_dwordx2 v[52:53], v4, s[44:47], 0 offen offset:64
    v_lshlrev_b32 v64, 16, v60
    v_and_b32 v65, 0xffff0000, v60
    v_lshlrev_b32 v66, 16, v20
    v_and_b32 v67, 0xffff0000, v20
    v_pk_add_f32 v[64:65], v[64:65], v[66:67]
    v_cvt_pk_bf16_f32 v60, v64, v65
    v_lshlrev_b32 v64, 16, v61
    v_and_b32 v65, 0xffff0000, v61
    v_lshlrev_b32 v66, 16, v21
    v_and_b32 v67, 0xffff0000, v21
    v_pk_add_f32 v[64:65], v[64:65], v[66:67]
    v_cvt_pk_bf16_f32 v61, v64, v65
    buffer_store_dwordx2 v[60:61], v4, s[44:47], s31 offen offset:64
sequential_preLN__linear_attn_block__dense_activation_relu__prompt_kernel_p4n92:
sequential_preLN__linear_attn_block__dense_activation_relu__prompt_kernel_cend89:
    s_endpgm
sequential_preLN__linear_attn_block__dense_activation_relu__prompt_kernel_end1:
sequential_preLN__linear_attn_block__dense_activation_relu__prompt_kernel_last:
    s_endpgm
.section .rodata,"a"
.p2align 6
.amdhsa_kernel sequential_preLN__linear_attn_block__dense_activation_relu__prompt_kernel
  .amdhsa_next_free_vgpr 248
  .amdhsa_next_free_sgpr 68
  .amdhsa_accum_offset 248
  .amdhsa_group_segment_fixed_size 0
  .amdhsa_kernarg_size 72
  .amdhsa_user_sgpr_count 2
  .amdhsa_user_sgpr_kernarg_segment_ptr 1
  .amdhsa_system_sgpr_workgroup_id_x 1
  .amdhsa_float_denorm_mode_32 3
.end_amdhsa_kernel
```
